```python
import torch

def _softmax(x, axis=-1):
    return torch.softmax(x, dim=axis)
def _gelu(x):
    return torch.nn.functional.gelu(x, approximate="tanh")
def _silu(x):
    return torch.nn.functional.silu(x)
def _sigmoid(x):
    return torch.sigmoid(x)
def _layernorm(x, axis=-1, eps=1e-5):
    m = x.mean(dim=axis, keepdim=True)
    v = x.var(dim=axis, keepdim=True, unbiased=False)
    return (x - m) / torch.sqrt(v + eps)
def _scatter_add(tgt, idx, src, axis=0):
    return tgt.clone().index_add_(axis, idx, src)
def _segment_sum(src, seg, n):
    out = torch.zeros((n,) + src.shape[1:], dtype=src.dtype)
    return out.index_add_(0, seg, src)
def _pad(x, pw):
    flat = tuple(v for pair in reversed(pw) for v in pair)
    return torch.nn.functional.pad(x, flat)

kernel_name = 'sequential_preLN__ssm_conv_s4d__mixer_token_mlp__prompt'

def setup_inputs():

    _w = (lambda a: (lambda t: t.to(torch.bfloat16) if t.is_floating_point() else t)(torch.as_tensor(a)))
    def _A_setup():
        Bsz, L, D, N = 1, 2048, 448, 256
        return {
            "u": _w((lambda *s: torch.randn(*s, dtype=torch.bfloat16) * 0.05)(Bsz, L, D)),
            "log_A_real": _w((lambda *s: torch.randn(*s, dtype=torch.bfloat16) * 6.4)(D, N) * 0.5),
            "A_imag": _w((lambda *s: torch.randn(*s, dtype=torch.bfloat16) * 0.05)(D, N) * 3.14),
            "C_real": _w((lambda *s: torch.randn(*s, dtype=torch.bfloat16) * 0.05)(D, N) / N ** 0.5),
            "C_imag": _w((lambda *s: torch.randn(*s, dtype=torch.bfloat16) * 0.05)(D, N) / N ** 0.5),
            "log_dt": _w((lambda *s: torch.randn(*s, dtype=torch.bfloat16) * 0.05)(D) * 0.5 - 4.0),
            "D_skip": _w((lambda *s: torch.randn(*s, dtype=torch.bfloat16) * 0.05)(D)),
        }
    _A_in = _A_setup()

    def _B_setup():
        B, S, D, F = 1, 2048, 448, 1792
        return {
            "x": _w((lambda *s: torch.randn(*s, dtype=torch.bfloat16) * 0.05)(B, S, D)),
            "w1": _w((lambda *s: torch.randn(*s, dtype=torch.bfloat16) * 0.4)(S, F) * (S ** -0.5)),
            "b1": _w((lambda *s: torch.randn(*s, dtype=torch.bfloat16) * 12.8)(F) * 0.02),
            "w2": _w((lambda *s: torch.randn(*s, dtype=torch.bfloat16) * 0.2)(F, S) * (F ** -0.5)),
            "b2": _w((lambda *s: torch.randn(*s, dtype=torch.bfloat16) * 3.2)(S) * 0.02),
        }
    _B_in = _B_setup()

    return {
        "A_u": _A_in["u"],
        "A_log_A_real": _A_in["log_A_real"],
        "A_A_imag": _A_in["A_imag"],
        "A_C_real": _A_in["C_real"],
        "A_C_imag": _A_in["C_imag"],
        "A_log_dt": _A_in["log_dt"],
        "A_D_skip": _A_in["D_skip"],
        "B_x": _B_in["x"],
        "B_w1": _B_in["w1"],
        "B_b1": _B_in["b1"],
        "B_w2": _B_in["w2"],
        "B_b2": _B_in["b2"],
    }

def reference(A_u, A_log_A_real, A_A_imag, A_C_real, A_C_imag, A_log_dt, A_D_skip, B_x, B_w1, B_b1, B_w2, B_b2):
    def _A_ref(u, log_A_real, A_imag, C_real, C_imag, log_dt, D_skip):
        L = u.shape[1]
        dt = torch.exp(log_dt)
        A = -torch.exp(log_A_real) + 1j * A_imag
        C = (C_real + 1j * C_imag) * dt[:, None]
        pos = (lambda x, dt: x.to(dt))(torch.arange(L), log_dt.dtype)
        P = torch.exp((A * dt[:, None])[:, :, None] * pos[None, None, :])
        K = 2.0 * torch.einsum("dn,dnl->dl", C, P).real
        L2 = 2 * L
        u_t = (lambda x, *d: x.permute(*d))(u, 0, 2, 1)
        Kf = (lambda x, *a, **k: torch.fft.rfft(x.float(), *a, **k))(K, L2)
        Uf = (lambda x, *a, **k: torch.fft.rfft(x.float(), *a, **k))(u_t, L2)
        y = (lambda x, *a, **k: torch.fft.irfft(x, *a, **k).to(torch.bfloat16))(Uf * Kf[None, :, :], L2)[:, :, :L]
        y = (lambda x, *d: x.permute(*d))(y, 0, 2, 1)
        return y + u * D_skip[None, None, :]

    def _B_ref(x, w1, b1, w2, b2):
        B, S, D = x.shape
        h = _layernorm(x, axis=-1)
        u = torch.einsum("bsd,sf->bdf", h, w1) + b1
        u = _gelu(u)
        y = torch.einsum("bdf,fs->bds", u, w2) + b2
        return (lambda x, *d: x.permute(*d))(y, 0, 2, 1)

    x = A_u
    h = x + _A_ref(_layernorm(x, axis=-1), A_log_A_real, A_A_imag, A_C_real, A_C_imag, A_log_dt, A_D_skip)
    h2 = h + _B_ref(_layernorm(h, axis=-1), B_w1, B_b1, B_w2, B_b2)
    return h2
```

```asm
; @launch grid=(256,1,1) block=(256,1,1) lds=163840
.amdgcn_target "amdgcn-amd-amdhsa--gfx950"
.text
.globl sequential_preLN__ssm_conv_s4d__mixer_token_mlp__prompt_kernel
.p2align 8
.type sequential_preLN__ssm_conv_s4d__mixer_token_mlp__prompt_kernel,@function
sequential_preLN__ssm_conv_s4d__mixer_token_mlp__prompt_kernel:
    s_cmp_ge_u32 s2, 256
    s_cbranch_scc1 end_1
    s_load_dwordx16 s[36:51], s[0:1], 0
    s_load_dwordx8 s[52:59], s[0:1], 64
    s_load_dwordx4 s[60:63], s[0:1], 96
    s_load_dwordx2 s[64:65], s[0:1], 112
    v_and_b32 v1, 63, v0
    v_lshrrev_b32 v2, 6, v0
    s_and_b32 s29, s2, 7
    v_readfirstlane_b32 s28, v2
    s_lshr_b32 s30, s2, 3
    s_lshl_b32 s31, s29, 5
    s_add_u32 s31, s31, s30
    s_mul_i32 s32, s29, 28
    s_add_u32 s32, s32, s30
    s_and_b32 s33, s29, 1
    s_lshl_b32 s33, s33, 2
    s_and_b32 s3, s30, 3
    s_add_u32 s33, s33, s3
    s_lshr_b32 s3, s29, 1
    s_lshr_b32 s66, s30, 2
    s_mul_i32 s34, s3, 7
    s_add_u32 s34, s34, s66
    s_lshl_b32 s35, s3, 3
    s_add_u32 s35, s35, s66
    s_waitcnt lgkmcnt(0)
    s_mov_b32 s8, s36
    s_and_b32 s9, s37, 0xffff
    s_mov_b32 s10, 1835008
    s_mov_b32 s11, 0x00020000
    s_mov_b32 s4, s64
    s_nop 0
    s_and_b32 s5, s65, 0xffff
    s_mov_b32 s6, 16777216
    s_mov_b32 s7, 0x00020000
    s_mul_i32 s66, s28, 224
    s_mul_i32 s67, s31, 7168
    s_add_u32 s66, s66, s67
    v_lshl_add_u32 v2, v1, 2, s66
    v_mov_b32_e64 v3, 1073741824
    v_cmp_gt_u32 vcc, 56, v1
    s_nop 1
    v_cndmask_b32 v2, v3, v2, vcc
    v_add_u32 v3, 4480, v2
    buffer_load_dword v8, v2, s[8:11], 0 offen offset:0
    buffer_load_dword v9, v2, s[8:11], 0 offen offset:896
    buffer_load_dword v10, v2, s[8:11], 0 offen offset:1792
    buffer_load_dword v11, v2, s[8:11], 0 offen offset:2688
    buffer_load_dword v12, v2, s[8:11], 0 offen offset:3584
    buffer_load_dword v13, v3, s[8:11], 0 offen offset:0
    buffer_load_dword v14, v3, s[8:11], 0 offen offset:896
    buffer_load_dword v15, v3, s[8:11], 0 offen offset:1792
    s_add_u32 s66, s64, 36864
    s_addc_u32 s67, s65, 0
    s_load_dword s99, s[66:67], 0
    v_mov_b32 v216, -1
    v_mov_b32 v217, -1
    v_mov_b32 v218, -1
    v_mov_b32 v219, -1
    s_cmp_ge_u32 s30, 28
    s_cbranch_scc1 noconv_2
    s_mov_b32 s12, s38
    s_and_b32 s13, s39, 0xffff
    s_mov_b32 s14, 229376
    s_mov_b32 s15, 0x00020000
    s_mov_b32 s16, s40
    s_and_b32 s17, s41, 0xffff
    s_mov_b32 s18, 229376
    s_mov_b32 s19, 0x00020000
    s_mov_b32 s20, s42
    s_and_b32 s21, s43, 0xffff
    s_mov_b32 s22, 229376
    s_mov_b32 s23, 0x00020000
    s_mov_b32 s24, s44
    s_and_b32 s25, s45, 0xffff
    s_mov_b32 s26, 229376
    s_mov_b32 s27, 0x00020000
    s_lshl_b32 s66, s32, 10
    s_lshl_b32 s67, s28, 7
    s_add_u32 s66, s66, s67
    v_lshl_add_u32 v235, v1, 1, s66
    s_lshl_b32 s66, s32, 2
    s_nop 0
    s_load_dword s68, s[46:47], s66
    s_load_dword s69, s[48:49], s66
    buffer_load_ushort v40, v235, s[12:15], 0 offen offset:0
    buffer_load_ushort v41, v235, s[16:19], 0 offen offset:0
    buffer_load_ushort v42, v235, s[20:23], 0 offen offset:0
    buffer_load_ushort v43, v235, s[24:27], 0 offen offset:0
    buffer_load_ushort v44, v235, s[12:15], 0 offen offset:512
    buffer_load_ushort v45, v235, s[16:19], 0 offen offset:512
    buffer_load_ushort v46, v235, s[20:23], 0 offen offset:512
    buffer_load_ushort v47, v235, s[24:27], 0 offen offset:512
    s_getpc_b64 s[70:71]
pc_7:
    s_add_u32 s70, s70, ktab_idx-pc_7
    s_addc_u32 s71, s71, 0
    v_lshlrev_b32_e64 v2, 5, v0
    global_load_dwordx4 v[160:163], v2, s[70:71]
    global_load_dwordx4 v[164:167], v2, s[70:71] offset:16
    s_mov_b32 s12, s52
    s_and_b32 s13, s53, 0xffff
    s_mov_b32 s14, 7340032
    s_mov_b32 s15, 0x00020000
    s_mov_b32 s16, s56
    s_and_b32 s17, s57, 0xffff
    s_mov_b32 s18, 7340032
    s_mov_b32 s19, 0x00020000
    v_lshrrev_b32_e64 v4, 3, v1
    v_bfe_u32 v5, v1, 4, 1
    v_lshlrev_b32 v5, 1, v5
    v_and_b32 v6, 7, v1
    v_xor_b32 v6, v6, v5
    v_xor_b32 v7, 4, v6
    s_mov_b32 s66, 3584
    v_mul_lo_u32 v5, v4, s66
    s_mul_i32 s67, s28, 1835008
    s_lshl_b32 s66, s34, 7
    s_add_u32 s67, s67, s66
    v_add_u32_e64 v5, s67, v5
    v_lshl_add_u32 v224, v6, 4, v5
    v_lshl_add_u32 v225, v7, 4, v5
    v_add_u32 v225, 27648, v225
    v_lshl_add_u32 v226, v6, 4, v5
    v_add_u32 v226, 55296, v226
    v_lshl_add_u32 v227, v7, 4, v5
    v_add_u32 v227, 82944, v227
    s_mov_b32 s66, 4096
    v_mul_lo_u32 v5, v4, s66
    s_mul_i32 s67, s28, 1835008
    s_lshl_b32 s66, s35, 7
    s_add_u32 s67, s67, s66
    v_add_u32_e64 v5, s67, v5
    v_lshl_add_u32 v228, v6, 4, v5
    v_lshl_add_u32 v229, v7, 4, v5
    v_add_u32 v229, 31744, v229
    v_lshl_add_u32 v230, v6, 4, v5
    v_add_u32 v230, 63488, v230
    v_lshl_add_u32 v231, v7, 4, v5
    v_add_u32 v231, 95232, v231
    v_lshlrev_b32 v5, 12, v4
    v_and_b32 v6, 7, v1
    v_lshl_add_u32 v232, v6, 4, v5
    s_and_b32 s66, s30, 3
    s_mul_i32 s66, s66, 448
    s_mul_i32 s67, s28, 32
    s_add_u32 s67, s67, 320
    s_add_u32 s66, s66, s67
    s_lshl_b32 s66, s66, 12
    s_lshl_b32 s67, s35, 7
    s_add_u32 s42, s66, s67
    v_lshrrev_b32_e64 v4, 4, v1
    v_bfe_u32 v5, v1, 2, 2
    v_lshl_add_u32 v5, v4, 3, v5
    v_lshlrev_b32 v5, 7, v5
    v_and_b32 v6, 1, v1
    v_lshl_add_u32 v5, v6, 3, v5
    v_bfe_u32 v6, v1, 1, 1
    v_lshl_add_u32 v5, v6, 4, v5
    v_bfe_u32 v6, v1, 3, 1
    v_and_b32_e64 v4, 1, v4
    v_lshl_add_u32 v6, v4, 1, v6
    s_and_b32 s66, s30, 3
    s_lshr_b32 s67, s30, 2
    s_lshl_b32 s67, s67, 1
    s_lshl_b32 s70, s66, 2
    s_add_u32 s70, s70, s67
    s_and_b32 s70, s70, 15
    s_mul_i32 s38, s70, 114688
    s_mul_i32 s39, s70, 28672
    s_mul_i32 s66, s66, 7
    s_lshr_b32 s66, s66, 1
    s_add_u32 s66, s66, s67
    s_cmp_ge_u32 s66, 14
    s_cselect_b32 s67, 14, 0
    s_sub_u32 s66, s66, s67
    s_cmp_ge_u32 s66, 14
    s_cselect_b32 s67, 14, 0
    s_sub_u32 s66, s66, s67
    s_mul_i32 s40, s66, 131072
    s_mul_i32 s41, s66, 28672
    s_lshl_b32 s50, s28, 14
    s_add_u32 s50, s50, 13056
    s_mul_i32 s51, s28, 20480
    s_add_u32 s51, s51, 78592
    s_lshl_b32 s44, s28, 13
    s_add_u32 s44, s44, 123904
    v_xor_b32 v4, 0, v6
    v_lshl_add_u32 v4, v4, 5, v5
    v_add_u32 v244, s50, v4
    v_add_u32 v248, s51, v4
    v_add_u32 v236, s44, v4
    v_xor_b32 v4, 1, v6
    v_lshl_add_u32 v4, v4, 5, v5
    v_add_u32 v245, s50, v4
    v_add_u32 v249, s51, v4
    v_add_u32 v237, s44, v4
    v_xor_b32 v4, 2, v6
    v_lshl_add_u32 v4, v4, 5, v5
    v_add_u32 v246, s50, v4
    v_add_u32 v250, s51, v4
    v_add_u32 v238, s44, v4
    v_xor_b32 v4, 3, v6
    v_lshl_add_u32 v4, v4, 5, v5
    v_add_u32 v247, s50, v4
    v_add_u32 v251, s51, v4
    v_add_u32 v239, s44, v4
    v_lshlrev_b32 v233, 6, v0
    v_add_u32 v233, 16384, v233
    s_waitcnt lgkmcnt(0)
    s_add_u32 s96, s99, 0x9e3779b9
    s_waitcnt vmcnt(10)
    s_mul_i32 s66, s31, 7168
    s_add_u32 s66, s66, 4194304
    v_lshl_add_u32 v4, v0, 4, s66
    v_add_u32 v5, 4096, v4
    v_mov_b32_e64 v6, 1073741824
    v_cmp_gt_u32 vcc, 192, v0
    s_nop 1
    v_cndmask_b32 v5, v6, v5, vcc
    buffer_store_dwordx4 v[216:219], v4, s[4:7], 0 offen sc1
    buffer_store_dwordx4 v[216:219], v5, s[4:7], 0 offen sc1
    s_mul_i32 s66, s32, 8448
    s_add_u32 s66, s66, 65536
    v_lshl_add_u32 v4, v0, 4, s66
    v_add_u32 v5, 4096, v4
    buffer_store_dwordx4 v[216:219], v4, s[4:7], 0 offen sc1
    buffer_store_dwordx4 v[216:219], v5, s[4:7], 0 offen sc1
    s_mov_b32 s66, 0x3f803f80
    v_dot2_f32_bf16 v16, v8, s66, 0
    v_dot2_f32_bf16 v24, v8, v8, 0
    v_dot2_f32_bf16 v17, v9, s66, 0
    v_dot2_f32_bf16 v25, v9, v9, 0
    v_dot2_f32_bf16 v18, v10, s66, 0
    v_dot2_f32_bf16 v26, v10, v10, 0
    v_dot2_f32_bf16 v19, v11, s66, 0
    v_dot2_f32_bf16 v27, v11, v11, 0
    v_dot2_f32_bf16 v20, v12, s66, 0
    v_dot2_f32_bf16 v28, v12, v12, 0
    v_dot2_f32_bf16 v21, v13, s66, 0
    v_dot2_f32_bf16 v29, v13, v13, 0
    v_dot2_f32_bf16 v22, v14, s66, 0
    v_dot2_f32_bf16 v30, v14, v14, 0
    v_dot2_f32_bf16 v23, v15, s66, 0
    v_dot2_f32_bf16 v31, v15, v15, 0
    v_lshlrev_b32_e64 v5, 2, v1
    v_and_b32 v5, 0xf0, v5
    s_lshl_b32 s66, s28, 2
    v_add_u32 v5, s66, v5
    v_permlane32_swap_b32 v16, v24
    v_permlane32_swap_b32 v17, v25
    v_permlane32_swap_b32 v18, v26
    v_permlane32_swap_b32 v19, v27
    v_permlane32_swap_b32 v20, v28
    v_permlane32_swap_b32 v21, v29
    v_permlane32_swap_b32 v22, v30
    v_permlane32_swap_b32 v23, v31
    v_add_f32 v16, v16, v24
    v_add_f32 v17, v17, v25
    v_add_f32 v18, v18, v26
    v_add_f32 v19, v19, v27
    v_add_f32 v20, v20, v28
    v_add_f32 v21, v21, v29
    v_add_f32 v22, v22, v30
    v_add_f32 v23, v23, v31
    v_permlane16_swap_b32 v16, v20
    v_permlane16_swap_b32 v17, v21
    v_permlane16_swap_b32 v18, v22
    v_permlane16_swap_b32 v19, v23
    v_add_f32 v16, v16, v20
    v_add_f32 v17, v17, v21
    v_add_f32 v18, v18, v22
    v_add_f32 v19, v19, v23
    v_add_f32_dpp v16, v16, v16 row_ror:8 row_mask:0xf bank_mask:0x3
    v_add_f32_dpp v17, v17, v17 row_ror:8 row_mask:0xf bank_mask:0x3
    s_nop 0
    v_add_f32_dpp v16, v18, v18 row_ror:8 row_mask:0xf bank_mask:0xc
    v_add_f32_dpp v17, v19, v19 row_ror:8 row_mask:0xf bank_mask:0xc
    s_nop 0
    v_add_f32_dpp v16, v16, v16 row_half_mirror row_mask:0xf bank_mask:0x5
    s_nop 1
    v_add_f32_dpp v16, v17, v17 row_half_mirror row_mask:0xf bank_mask:0xa
    s_nop 1
    v_add_f32_dpp v16, v16, v16 quad_perm:[1,0,3,2] row_mask:0xf bank_mask:0xf
    s_nop 1
    v_add_f32_dpp v16, v16, v16 quad_perm:[2,3,0,1] row_mask:0xf bank_mask:0xf
    s_mov_b32 exec_lo, 0x11111111
    s_mov_b32 exec_hi, 0x11111111
    ds_write_b32 v5, v16 offset:0
    s_mov_b64 exec, -1
    v_and_b32 v5, 7, v1
    v_lshlrev_b32 v5, 4, v5
    s_waitcnt lgkmcnt(0)
    s_barrier
    ds_read_b128 v[16:19], v5 offset:0
    ds_read_b128 v[20:23], v5 offset:128
    s_waitcnt lgkmcnt(1)
    v_pk_add_f32 v[16:17], v[16:17], v[18:19]
    s_waitcnt lgkmcnt(0)
    v_pk_add_f32 v[20:21], v[20:21], v[22:23]
    v_add_f32 v16, v16, v17
    v_add_f32 v20, v20, v21
    v_mul_f32 v16, 0x3b124925, v16
    v_mul_f32 v20, 0x3b124925, v20
    v_fma_f32 v20, -v16, v16, v20
    v_max_f32_e64 v20, 0, v20
    v_cvt_pk_bf16_f32 v20, v20, v20
    v_lshlrev_b32_e64 v20, 16, v20
    v_add_f32 v20, 0x3727c5ac, v20
    v_cvt_pk_bf16_f32 v20, v20, v20
    v_lshlrev_b32 v20, 16, v20
    v_sqrt_f32_e64 v20, v20
    s_nop 0
    v_cvt_pk_bf16_f32 v16, v16, v20
    v_lshlrev_b32_e64 v17, 16, v16
    v_and_b32 v18, 0xffff0000, v16
    v_rcp_f32_e64 v18, v18
    v_readlane_b32 s72, v17, 0
    v_readlane_b32 s74, v17, 1
    v_readlane_b32 s76, v17, 2
    v_readlane_b32 s78, v17, 3
    v_readlane_b32 s80, v17, 4
    v_readlane_b32 s82, v17, 5
    v_readlane_b32 s84, v17, 6
    v_readlane_b32 s86, v17, 7
    v_readlane_b32 s73, v18, 0
    v_readlane_b32 s75, v18, 1
    v_readlane_b32 s77, v18, 2
    v_readlane_b32 s79, v18, 3
    v_readlane_b32 s81, v18, 4
    v_readlane_b32 s83, v18, 5
    v_readlane_b32 s85, v18, 6
    v_readlane_b32 s87, v18, 7
    v_lshlrev_b32_e64 v64, 16, v8
    v_and_b32 v65, 0xffff0000, v8
    v_pk_add_f32 v[64:65], v[64:65], s[72:73] op_sel:[0,0] op_sel_hi:[1,0] neg_lo:[0,1] neg_hi:[0,1]
    v_cvt_pk_bf16_f32 v48, v64, v65
    v_lshlrev_b32_e64 v64, 16, v48
    v_and_b32 v65, 0xffff0000, v48
    v_pk_mul_f32 v[64:65], v[64:65], s[72:73] op_sel:[0,1] op_sel_hi:[1,1]
    v_cvt_pk_bf16_f32 v48, v64, v65
    v_lshlrev_b32_e64 v64, 16, v48
    v_and_b32 v65, 0xffff0000, v48
    v_lshlrev_b32_e64 v66, 16, v9
    v_and_b32 v67, 0xffff0000, v9
    v_pk_add_f32 v[66:67], v[66:67], s[74:75] op_sel:[0,0] op_sel_hi:[1,0] neg_lo:[0,1] neg_hi:[0,1]
    v_cvt_pk_bf16_f32 v49, v66, v67
    v_lshlrev_b32_e64 v66, 16, v49
    v_and_b32 v67, 0xffff0000, v49
    v_pk_mul_f32 v[66:67], v[66:67], s[74:75] op_sel:[0,1] op_sel_hi:[1,1]
    v_cvt_pk_bf16_f32 v49, v66, v67
    v_lshlrev_b32_e64 v66, 16, v49
    v_and_b32 v67, 0xffff0000, v49
    v_lshlrev_b32_e64 v68, 16, v10
    v_and_b32 v69, 0xffff0000, v10
    v_pk_add_f32 v[68:69], v[68:69], s[76:77] op_sel:[0,0] op_sel_hi:[1,0] neg_lo:[0,1] neg_hi:[0,1]
    v_cvt_pk_bf16_f32 v50, v68, v69
    v_lshlrev_b32_e64 v68, 16, v50
    v_and_b32 v69, 0xffff0000, v50
    v_pk_mul_f32 v[68:69], v[68:69], s[76:77] op_sel:[0,1] op_sel_hi:[1,1]
    v_cvt_pk_bf16_f32 v50, v68, v69
    v_lshlrev_b32_e64 v68, 16, v50
    v_and_b32 v69, 0xffff0000, v50
    v_lshlrev_b32_e64 v70, 16, v11
    v_and_b32 v71, 0xffff0000, v11
    v_pk_add_f32 v[70:71], v[70:71], s[78:79] op_sel:[0,0] op_sel_hi:[1,0] neg_lo:[0,1] neg_hi:[0,1]
    v_cvt_pk_bf16_f32 v51, v70, v71
    v_lshlrev_b32_e64 v70, 16, v51
    v_and_b32 v71, 0xffff0000, v51
    v_pk_mul_f32 v[70:71], v[70:71], s[78:79] op_sel:[0,1] op_sel_hi:[1,1]
    v_cvt_pk_bf16_f32 v51, v70, v71
    v_lshlrev_b32_e64 v70, 16, v51
    v_and_b32 v71, 0xffff0000, v51
    v_lshlrev_b32_e64 v72, 16, v12
    v_and_b32 v73, 0xffff0000, v12
    v_pk_add_f32 v[72:73], v[72:73], s[80:81] op_sel:[0,0] op_sel_hi:[1,0] neg_lo:[0,1] neg_hi:[0,1]
    v_cvt_pk_bf16_f32 v52, v72, v73
    v_lshlrev_b32_e64 v72, 16, v52
    v_and_b32 v73, 0xffff0000, v52
    v_pk_mul_f32 v[72:73], v[72:73], s[80:81] op_sel:[0,1] op_sel_hi:[1,1]
    v_cvt_pk_bf16_f32 v52, v72, v73
    v_lshlrev_b32_e64 v72, 16, v52
    v_and_b32 v73, 0xffff0000, v52
    v_lshlrev_b32_e64 v74, 16, v13
    v_and_b32 v75, 0xffff0000, v13
    v_pk_add_f32 v[74:75], v[74:75], s[82:83] op_sel:[0,0] op_sel_hi:[1,0] neg_lo:[0,1] neg_hi:[0,1]
    v_cvt_pk_bf16_f32 v53, v74, v75
    v_lshlrev_b32_e64 v74, 16, v53
    v_and_b32 v75, 0xffff0000, v53
    v_pk_mul_f32 v[74:75], v[74:75], s[82:83] op_sel:[0,1] op_sel_hi:[1,1]
    v_cvt_pk_bf16_f32 v53, v74, v75
    v_lshlrev_b32_e64 v74, 16, v53
    v_and_b32 v75, 0xffff0000, v53
    v_lshlrev_b32_e64 v76, 16, v14
    v_and_b32 v77, 0xffff0000, v14
    v_pk_add_f32 v[76:77], v[76:77], s[84:85] op_sel:[0,0] op_sel_hi:[1,0] neg_lo:[0,1] neg_hi:[0,1]
    v_cvt_pk_bf16_f32 v54, v76, v77
    v_lshlrev_b32_e64 v76, 16, v54
    v_and_b32 v77, 0xffff0000, v54
    v_pk_mul_f32 v[76:77], v[76:77], s[84:85] op_sel:[0,1] op_sel_hi:[1,1]
    v_cvt_pk_bf16_f32 v54, v76, v77
    v_lshlrev_b32_e64 v76, 16, v54
    v_and_b32 v77, 0xffff0000, v54
    v_lshlrev_b32_e64 v78, 16, v15
    v_and_b32 v79, 0xffff0000, v15
    v_pk_add_f32 v[78:79], v[78:79], s[86:87] op_sel:[0,0] op_sel_hi:[1,0] neg_lo:[0,1] neg_hi:[0,1]
    v_cvt_pk_bf16_f32 v55, v78, v79
    v_lshlrev_b32_e64 v78, 16, v55
    v_and_b32 v79, 0xffff0000, v55
    v_pk_mul_f32 v[78:79], v[78:79], s[86:87] op_sel:[0,1] op_sel_hi:[1,1]
    v_cvt_pk_bf16_f32 v55, v78, v79
    v_lshlrev_b32_e64 v78, 16, v55
    v_and_b32 v79, 0xffff0000, v55
    v_cvt_pk_f16_f32 v80, v64, v66
    v_cvt_pk_f16_f32 v84, v65, v67
    v_cvt_pk_f16_f32 v81, v68, v70
    v_cvt_pk_f16_f32 v85, v69, v71
    v_cvt_pk_f16_f32 v82, v72, v74
    v_cvt_pk_f16_f32 v86, v73, v75
    v_cvt_pk_f16_f32 v83, v76, v78
    v_cvt_pk_f16_f32 v87, v77, v79
    s_mul_i32 s66, s28, 896
    s_mul_i32 s67, s31, 7168
    s_add_u32 s66, s66, s67
    s_add_u32 s66, s66, 10485760
    v_lshl_add_u32 v4, v1, 4, s66
    v_mov_b32_e64 v5, 1073741824
    v_cmp_gt_u32 vcc, 56, v1
    s_nop 1
    v_cndmask_b32 v4, v5, v4, vcc
    v_add_u32 v5, 3584, v4
    buffer_store_dwordx4 v[80:83], v4, s[4:7], 0 offen sc1
    buffer_store_dwordx4 v[84:87], v5, s[4:7], 0 offen sc1
    s_waitcnt vmcnt(8)
    v_lshlrev_b32 v40, 16, v40
    v_lshlrev_b32 v41, 16, v41
    v_lshlrev_b32 v42, 16, v42
    v_lshlrev_b32 v43, 16, v43
    s_lshl_b32 s66, s68, 16
    v_mov_b32_e64 v93, s66
    v_mul_f32 v92, 0x3fb8aa00, v93
    v_exp_f32_e64 v92, v92
    v_mul_f32 v54, 0x36a407db, v93
    v_fma_f32 v54, v92, v54, v92
    v_cvt_pk_bf16_f32 v54, v54, v54
    v_lshlrev_b32_e64 v54, 16, v54
    v_add_f32 v52, abs(v42), abs(v43)
    v_mul_f32 v92, 0x3fb8aa00, v40
    v_exp_f32_e64 v92, v92
    v_mul_f32 v56, 0x36a407db, v40
    v_fma_f32 v56, v92, v56, v92
    v_cvt_pk_bf16_f32 v56, v56, v56
    v_lshlrev_b32_e64 v56, 16, v56
    v_add_f32_dpp v52, v52, v52 quad_perm:[1,0,3,2] row_mask:0xf bank_mask:0xf
    v_mul_f32 v56, v56, v54
    v_mul_f32 v57, v41, v54
    v_add_f32_dpp v52, v52, v52 quad_perm:[2,3,0,1] row_mask:0xf bank_mask:0xf
    v_mul_f32 v56, 0xbfb8aa3b, v56
    v_mul_f32_e64 v57, 0x3e22f983, v57
    v_add_f32_dpp v52, v52, v52 row_half_mirror row_mask:0xf bank_mask:0xf
    v_exp_f32 v82, v56
    v_fract_f32 v92, v57
    v_add_f32_dpp v52, v52, v52 row_ror:8 row_mask:0xf bank_mask:0xf
    v_cos_f32 v58, v92
    v_sin_f32 v59, v92
    v_mov_b32_e64 v93, v52
    v_mul_f32 v84, 0x43000000, v56
    v_mul_f32 v92, 0x43000000, v57
    v_permlane16_swap_b32 v52, v93
    v_pk_mul_f32 v[58:59], v[58:59], v[82:83] op_sel:[0,0] op_sel_hi:[1,0]
    v_add_f32 v52, v52, v93
    v_exp_f32 v84, v84
    v_fract_f32 v92, v92
    v_mov_b32 v93, v52
    v_cos_f32 v66, v92
    v_sin_f32 v67, v92
    v_permlane32_swap_b32 v52, v93
    v_pk_mul_f32 v[60:61], v[58:59], v[58:59] op_sel:[0,0] op_sel_hi:[1,0]
    v_pk_fma_f32 v[60:61], v[58:59], v[58:59], v[60:61] op_sel:[1,1,0] op_sel_hi:[0,1,1] neg_lo:[1,0,0]
    v_add_f32_e64 v52, v52, v93
    v_pk_mul_f32 v[66:67], v[66:67], v[84:85] op_sel:[0,0] op_sel_hi:[1,0]
    v_add_f32 v52, 0x0da24260, v52
    v_pk_mul_f32 v[62:63], v[60:61], v[60:61] op_sel:[0,0] op_sel_hi:[1,0]
    v_pk_fma_f32 v[62:63], v[60:61], v[60:61], v[62:63] op_sel:[1,1,0] op_sel_hi:[0,1,1] neg_lo:[1,0,0]
    v_rcp_f32_e64 v92, v52
    v_pk_mul_f32 v[68:69], v[66:67], v[66:67] op_sel:[0,0] op_sel_hi:[1,0]
    v_pk_fma_f32 v[68:69], v[66:67], v[66:67], v[68:69] op_sel:[1,1,0] op_sel_hi:[0,1,1] neg_lo:[1,0,0]
    v_pk_mul_f32 v[64:65], v[62:63], v[62:63] op_sel:[0,0] op_sel_hi:[1,0]
    v_pk_fma_f32 v[64:65], v[62:63], v[62:63], v[64:65] op_sel:[1,1,0] op_sel_hi:[0,1,1] neg_lo:[1,0,0]
    v_mul_f32 v74, v42, v92
    v_mul_f32 v75, v43, v92
    v_pk_mul_f32 v[70:71], v[68:69], v[68:69] op_sel:[0,0] op_sel_hi:[1,0]
    v_pk_fma_f32 v[70:71], v[68:69], v[68:69], v[70:71] op_sel:[1,1,0] op_sel_hi:[0,1,1] neg_lo:[1,0,0]
    s_mul_i32 s66, s28, 15504
    s_add_u32 s66, s66, 13056
    s_mov_b32 m0, s66
    v_pk_mul_f32 v[72:73], v[70:71], v[70:71] op_sel:[0,0] op_sel_hi:[1,0]
    v_pk_fma_f32 v[72:73], v[70:71], v[70:71], v[72:73] op_sel:[1,1,0] op_sel_hi:[0,1,1] neg_lo:[1,0,0]
    v_and_b32 v92, 15, v1
    v_mul_u32_u24 v92, 272, v92
    v_lshrrev_b32_e64 v93, 4, v1
    v_lshl_add_u32 v92, v93, 4, v92
    v_add_u32_e64 v91, s66, v92
    v_mov_b32 v90, 0x00003c00
    v_cvt_pk_f16_f32 v168, v64, v65
    v_cvt_pk_f16_f32 v169, v74, -v75
    v_pk_mul_f32 v[82:83], v[74:75], v[66:67] op_sel:[0,0] op_sel_hi:[1,0]
    v_pk_fma_f32 v[82:83], v[74:75], v[66:67], v[82:83] op_sel:[1,1,0] op_sel_hi:[0,1,1] neg_lo:[1,0,0]
    v_cvt_pk_f16_f32 v170, v82, -v83
    ds_write_addtid_b32 v90 offset:11152
    ds_write_addtid_b32 v168 offset:11424
    ds_write_addtid_b32 v169 offset:0
    v_pk_mul_f32 v[76:77], v[74:75], v[58:59] op_sel:[0,0] op_sel_hi:[1,0]
    v_pk_fma_f32 v[76:77], v[74:75], v[58:59], v[76:77] op_sel:[1,1,0] op_sel_hi:[0,1,1] neg_lo:[1,0,0]
    v_pk_mul_f32 v[80:81], v[64:65], v[64:65] op_sel:[0,0] op_sel_hi:[1,0]
    v_pk_fma_f32 v[80:81], v[64:65], v[64:65], v[80:81] op_sel:[1,1,0] op_sel_hi:[0,1,1] neg_lo:[1,0,0]
    v_cvt_pk_f16_f32 v171, v80, v81
    v_cvt_pk_f16_f32 v172, v76, -v77
    v_pk_mul_f32 v[82:83], v[76:77], v[66:67] op_sel:[0,0] op_sel_hi:[1,0]
    v_pk_fma_f32 v[82:83], v[76:77], v[66:67], v[82:83] op_sel:[1,1,0] op_sel_hi:[0,1,1] neg_lo:[1,0,0]
    v_cvt_pk_f16_f32 v173, v82, -v83
    ds_write_addtid_b32 v170 offset:2176
    ds_write_addtid_b32 v171 offset:11696
    ds_write_addtid_b32 v172 offset:272
    v_pk_mul_f32 v[78:79], v[76:77], v[58:59] op_sel:[0,0] op_sel_hi:[1,0]
    v_pk_fma_f32 v[78:79], v[76:77], v[58:59], v[78:79] op_sel:[1,1,0] op_sel_hi:[0,1,1] neg_lo:[1,0,0]
    v_pk_mul_f32 v[94:95], v[80:81], v[64:65] op_sel:[0,0] op_sel_hi:[1,0]
    v_pk_fma_f32 v[94:95], v[80:81], v[64:65], v[94:95] op_sel:[1,1,0] op_sel_hi:[0,1,1] neg_lo:[1,0,0]
    v_cvt_pk_f16_f32 v174, v94, v95
    v_cvt_pk_f16_f32 v175, v78, -v79
    v_pk_mul_f32 v[82:83], v[78:79], v[66:67] op_sel:[0,0] op_sel_hi:[1,0]
    v_pk_fma_f32 v[82:83], v[78:79], v[66:67], v[82:83] op_sel:[1,1,0] op_sel_hi:[0,1,1] neg_lo:[1,0,0]
    v_cvt_pk_f16_f32 v168, v82, -v83
    ds_write_addtid_b32 v173 offset:2448
    ds_write_addtid_b32 v174 offset:11968
    ds_write_addtid_b32 v175 offset:544
    v_pk_mul_f32 v[76:77], v[78:79], v[58:59] op_sel:[0,0] op_sel_hi:[1,0]
    v_pk_fma_f32 v[76:77], v[78:79], v[58:59], v[76:77] op_sel:[1,1,0] op_sel_hi:[0,1,1] neg_lo:[1,0,0]
    v_pk_mul_f32 v[80:81], v[94:95], v[64:65] op_sel:[0,0] op_sel_hi:[1,0]
    v_pk_fma_f32 v[80:81], v[94:95], v[64:65], v[80:81] op_sel:[1,1,0] op_sel_hi:[0,1,1] neg_lo:[1,0,0]
    v_cvt_pk_f16_f32 v169, v80, v81
    v_cvt_pk_f16_f32 v170, v76, -v77
    v_pk_mul_f32 v[82:83], v[76:77], v[66:67] op_sel:[0,0] op_sel_hi:[1,0]
    v_pk_fma_f32 v[82:83], v[76:77], v[66:67], v[82:83] op_sel:[1,1,0] op_sel_hi:[0,1,1] neg_lo:[1,0,0]
    v_cvt_pk_f16_f32 v171, v82, -v83
    ds_write_addtid_b32 v168 offset:2720
    ds_write_addtid_b32 v169 offset:12240
    ds_write_addtid_b32 v170 offset:816
    v_pk_mul_f32 v[78:79], v[76:77], v[58:59] op_sel:[0,0] op_sel_hi:[1,0]
    v_pk_fma_f32 v[78:79], v[76:77], v[58:59], v[78:79] op_sel:[1,1,0] op_sel_hi:[0,1,1] neg_lo:[1,0,0]
    v_pk_mul_f32 v[94:95], v[80:81], v[64:65] op_sel:[0,0] op_sel_hi:[1,0]
    v_pk_fma_f32 v[94:95], v[80:81], v[64:65], v[94:95] op_sel:[1,1,0] op_sel_hi:[0,1,1] neg_lo:[1,0,0]
    v_cvt_pk_f16_f32 v172, v94, v95
    v_cvt_pk_f16_f32 v173, v78, -v79
    v_pk_mul_f32 v[82:83], v[78:79], v[66:67] op_sel:[0,0] op_sel_hi:[1,0]
    v_pk_fma_f32 v[82:83], v[78:79], v[66:67], v[82:83] op_sel:[1,1,0] op_sel_hi:[0,1,1] neg_lo:[1,0,0]
    v_cvt_pk_f16_f32 v174, v82, -v83
    ds_write_addtid_b32 v171 offset:2992
    ds_write_addtid_b32 v172 offset:12512
    ds_write_addtid_b32 v173 offset:1088
    v_pk_mul_f32 v[76:77], v[78:79], v[58:59] op_sel:[0,0] op_sel_hi:[1,0]
    v_pk_fma_f32 v[76:77], v[78:79], v[58:59], v[76:77] op_sel:[1,1,0] op_sel_hi:[0,1,1] neg_lo:[1,0,0]
    v_pk_mul_f32 v[80:81], v[94:95], v[64:65] op_sel:[0,0] op_sel_hi:[1,0]
    v_pk_fma_f32 v[80:81], v[94:95], v[64:65], v[80:81] op_sel:[1,1,0] op_sel_hi:[0,1,1] neg_lo:[1,0,0]
    v_cvt_pk_f16_f32 v175, v80, v81
    v_cvt_pk_f16_f32 v168, v76, -v77
    v_pk_mul_f32 v[82:83], v[76:77], v[66:67] op_sel:[0,0] op_sel_hi:[1,0]
    v_pk_fma_f32 v[82:83], v[76:77], v[66:67], v[82:83] op_sel:[1,1,0] op_sel_hi:[0,1,1] neg_lo:[1,0,0]
    v_cvt_pk_f16_f32 v169, v82, -v83
    ds_write_addtid_b32 v174 offset:3264
    ds_write_addtid_b32 v175 offset:12784
    ds_write_addtid_b32 v168 offset:1360
    v_pk_mul_f32 v[78:79], v[76:77], v[58:59] op_sel:[0,0] op_sel_hi:[1,0]
    v_pk_fma_f32 v[78:79], v[76:77], v[58:59], v[78:79] op_sel:[1,1,0] op_sel_hi:[0,1,1] neg_lo:[1,0,0]
    v_pk_mul_f32 v[94:95], v[80:81], v[64:65] op_sel:[0,0] op_sel_hi:[1,0]
    v_pk_fma_f32 v[94:95], v[80:81], v[64:65], v[94:95] op_sel:[1,1,0] op_sel_hi:[0,1,1] neg_lo:[1,0,0]
    v_cvt_pk_f16_f32 v170, v94, v95
    v_cvt_pk_f16_f32 v171, v78, -v79
    v_pk_mul_f32 v[82:83], v[78:79], v[66:67] op_sel:[0,0] op_sel_hi:[1,0]
    v_pk_fma_f32 v[82:83], v[78:79], v[66:67], v[82:83] op_sel:[1,1,0] op_sel_hi:[0,1,1] neg_lo:[1,0,0]
    v_cvt_pk_f16_f32 v172, v82, -v83
    ds_write_addtid_b32 v169 offset:3536
    ds_write_addtid_b32 v170 offset:13056
    ds_write_addtid_b32 v171 offset:1632
    v_pk_mul_f32 v[76:77], v[78:79], v[58:59] op_sel:[0,0] op_sel_hi:[1,0]
    v_pk_fma_f32 v[76:77], v[78:79], v[58:59], v[76:77] op_sel:[1,1,0] op_sel_hi:[0,1,1] neg_lo:[1,0,0]
    v_pk_mul_f32 v[80:81], v[94:95], v[64:65] op_sel:[0,0] op_sel_hi:[1,0]
    v_pk_fma_f32 v[80:81], v[94:95], v[64:65], v[80:81] op_sel:[1,1,0] op_sel_hi:[0,1,1] neg_lo:[1,0,0]
    v_cvt_pk_f16_f32 v173, v80, v81
    v_cvt_pk_f16_f32 v174, v76, -v77
    v_pk_mul_f32 v[82:83], v[76:77], v[66:67] op_sel:[0,0] op_sel_hi:[1,0]
    v_pk_fma_f32 v[82:83], v[76:77], v[66:67], v[82:83] op_sel:[1,1,0] op_sel_hi:[0,1,1] neg_lo:[1,0,0]
    v_cvt_pk_f16_f32 v175, v82, -v83
    ds_write_addtid_b32 v172 offset:3808
    ds_write_addtid_b32 v173 offset:13328
    ds_write_addtid_b32 v174 offset:1904
    v_pk_mul_f32 v[76:77], v[74:75], v[68:69] op_sel:[0,0] op_sel_hi:[1,0]
    v_pk_fma_f32 v[76:77], v[74:75], v[68:69], v[76:77] op_sel:[1,1,0] op_sel_hi:[0,1,1] neg_lo:[1,0,0]
    v_pk_mul_f32 v[94:95], v[80:81], v[64:65] op_sel:[0,0] op_sel_hi:[1,0]
    v_pk_fma_f32 v[94:95], v[80:81], v[64:65], v[94:95] op_sel:[1,1,0] op_sel_hi:[0,1,1] neg_lo:[1,0,0]
    v_cvt_pk_f16_f32 v168, v94, v95
    v_cvt_pk_f16_f32 v169, v76, -v77
    v_pk_mul_f32 v[82:83], v[76:77], v[66:67] op_sel:[0,0] op_sel_hi:[1,0]
    v_pk_fma_f32 v[82:83], v[76:77], v[66:67], v[82:83] op_sel:[1,1,0] op_sel_hi:[0,1,1] neg_lo:[1,0,0]
    v_cvt_pk_f16_f32 v170, v82, -v83
    ds_write_addtid_b32 v175 offset:4080
    ds_write_addtid_b32 v168 offset:13600
    ds_write_addtid_b32 v169 offset:4352
    v_pk_mul_f32 v[78:79], v[76:77], v[60:61] op_sel:[0,0] op_sel_hi:[1,0]
    v_pk_fma_f32 v[78:79], v[76:77], v[60:61], v[78:79] op_sel:[1,1,0] op_sel_hi:[0,1,1] neg_lo:[1,0,0]
    v_pk_mul_f32 v[80:81], v[94:95], v[64:65] op_sel:[0,0] op_sel_hi:[1,0]
    v_pk_fma_f32 v[80:81], v[94:95], v[64:65], v[80:81] op_sel:[1,1,0] op_sel_hi:[0,1,1] neg_lo:[1,0,0]
    v_cvt_pk_f16_f32 v171, v80, v81
    v_cvt_pk_f16_f32 v172, v78, -v79
    v_pk_mul_f32 v[82:83], v[78:79], v[66:67] op_sel:[0,0] op_sel_hi:[1,0]
    v_pk_fma_f32 v[82:83], v[78:79], v[66:67], v[82:83] op_sel:[1,1,0] op_sel_hi:[0,1,1] neg_lo:[1,0,0]
    v_cvt_pk_f16_f32 v173, v82, -v83
    ds_write_addtid_b32 v170 offset:5440
    ds_write_addtid_b32 v171 offset:13872
    ds_write_addtid_b32 v172 offset:4624
    v_pk_mul_f32 v[76:77], v[78:79], v[60:61] op_sel:[0,0] op_sel_hi:[1,0]
    v_pk_fma_f32 v[76:77], v[78:79], v[60:61], v[76:77] op_sel:[1,1,0] op_sel_hi:[0,1,1] neg_lo:[1,0,0]
    v_pk_mul_f32 v[94:95], v[80:81], v[64:65] op_sel:[0,0] op_sel_hi:[1,0]
    v_pk_fma_f32 v[94:95], v[80:81], v[64:65], v[94:95] op_sel:[1,1,0] op_sel_hi:[0,1,1] neg_lo:[1,0,0]
    v_cvt_pk_f16_f32 v174, v94, v95
    v_cvt_pk_f16_f32 v175, v76, -v77
    v_pk_mul_f32 v[82:83], v[76:77], v[66:67] op_sel:[0,0] op_sel_hi:[1,0]
    v_pk_fma_f32 v[82:83], v[76:77], v[66:67], v[82:83] op_sel:[1,1,0] op_sel_hi:[0,1,1] neg_lo:[1,0,0]
    v_cvt_pk_f16_f32 v168, v82, -v83
    ds_write_addtid_b32 v173 offset:5712
    ds_write_addtid_b32 v174 offset:14144
    ds_write_addtid_b32 v175 offset:4896
    v_pk_mul_f32 v[78:79], v[76:77], v[60:61] op_sel:[0,0] op_sel_hi:[1,0]
    v_pk_fma_f32 v[78:79], v[76:77], v[60:61], v[78:79] op_sel:[1,1,0] op_sel_hi:[0,1,1] neg_lo:[1,0,0]
    v_pk_mul_f32 v[80:81], v[94:95], v[64:65] op_sel:[0,0] op_sel_hi:[1,0]
    v_pk_fma_f32 v[80:81], v[94:95], v[64:65], v[80:81] op_sel:[1,1,0] op_sel_hi:[0,1,1] neg_lo:[1,0,0]
    v_cvt_pk_f16_f32 v169, v80, v81
    v_cvt_pk_f16_f32 v170, v78, -v79
    v_pk_mul_f32 v[82:83], v[78:79], v[66:67] op_sel:[0,0] op_sel_hi:[1,0]
    v_pk_fma_f32 v[82:83], v[78:79], v[66:67], v[82:83] op_sel:[1,1,0] op_sel_hi:[0,1,1] neg_lo:[1,0,0]
    v_cvt_pk_f16_f32 v171, v82, -v83
    ds_write_addtid_b32 v168 offset:5984
    ds_write_addtid_b32 v169 offset:14416
    ds_write_addtid_b32 v170 offset:5168
    v_pk_mul_f32 v[76:77], v[74:75], v[70:71] op_sel:[0,0] op_sel_hi:[1,0]
    v_pk_fma_f32 v[76:77], v[74:75], v[70:71], v[76:77] op_sel:[1,1,0] op_sel_hi:[0,1,1] neg_lo:[1,0,0]
    v_pk_mul_f32 v[94:95], v[80:81], v[64:65] op_sel:[0,0] op_sel_hi:[1,0]
    v_pk_fma_f32 v[94:95], v[80:81], v[64:65], v[94:95] op_sel:[1,1,0] op_sel_hi:[0,1,1] neg_lo:[1,0,0]
    v_cvt_pk_f16_f32 v172, v94, v95
    v_cvt_pk_f16_f32 v173, v76, -v77
    v_pk_mul_f32 v[78:79], v[76:77], v[62:63] op_sel:[0,0] op_sel_hi:[1,0]
    v_pk_fma_f32 v[78:79], v[76:77], v[62:63], v[78:79] op_sel:[1,1,0] op_sel_hi:[0,1,1] neg_lo:[1,0,0]
    v_pk_mul_f32 v[80:81], v[94:95], v[64:65] op_sel:[0,0] op_sel_hi:[1,0]
    v_pk_fma_f32 v[80:81], v[94:95], v[64:65], v[80:81] op_sel:[1,1,0] op_sel_hi:[0,1,1] neg_lo:[1,0,0]
    v_cvt_pk_f16_f32 v174, v80, v81
    ds_write_addtid_b32 v171 offset:6256
    ds_write_addtid_b32 v172 offset:14688
    ds_write_addtid_b32 v173 offset:6528
    v_cvt_pk_f16_f32 v175, v78, -v79
    v_pk_mul_f32 v[82:83], v[76:77], v[66:67] op_sel:[0,0] op_sel_hi:[1,0]
    v_pk_fma_f32 v[82:83], v[76:77], v[66:67], v[82:83] op_sel:[1,1,0] op_sel_hi:[0,1,1] neg_lo:[1,0,0]
    v_pk_mul_f32 v[84:85], v[78:79], v[66:67] op_sel:[0,0] op_sel_hi:[1,0]
    v_pk_fma_f32 v[84:85], v[78:79], v[66:67], v[84:85] op_sel:[1,1,0] op_sel_hi:[0,1,1] neg_lo:[1,0,0]
    v_pk_mul_f32 v[94:95], v[80:81], v[64:65] op_sel:[0,0] op_sel_hi:[1,0]
    v_pk_fma_f32 v[94:95], v[80:81], v[64:65], v[94:95] op_sel:[1,1,0] op_sel_hi:[0,1,1] neg_lo:[1,0,0]
    v_cvt_pk_f16_f32 v168, v94, v95
    v_cvt_pk_f16_f32 v169, v82, -v83
    ds_write_addtid_b32 v174 offset:14960
    ds_write_addtid_b32 v175 offset:6800
    ds_write_addtid_b32 v168 offset:15232
    v_cvt_pk_f16_f32 v170, v84, -v85
    v_pk_mul_f32 v[76:77], v[82:83], v[66:67] op_sel:[0,0] op_sel_hi:[1,0]
    v_pk_fma_f32 v[76:77], v[82:83], v[66:67], v[76:77] op_sel:[1,1,0] op_sel_hi:[0,1,1] neg_lo:[1,0,0]
    v_pk_mul_f32 v[78:79], v[84:85], v[66:67] op_sel:[0,0] op_sel_hi:[1,0]
    v_pk_fma_f32 v[78:79], v[84:85], v[66:67], v[78:79] op_sel:[1,1,0] op_sel_hi:[0,1,1] neg_lo:[1,0,0]
    v_cvt_pk_f16_f32 v171, v76, -v77
    v_cvt_pk_f16_f32 v172, v78, -v79
    ds_write_addtid_b32 v169 offset:7072
    ds_write_addtid_b32 v170 offset:7344
    ds_write_addtid_b32 v171 offset:7616
    v_pk_mul_f32 v[82:83], v[76:77], v[66:67] op_sel:[0,0] op_sel_hi:[1,0]
    v_pk_fma_f32 v[82:83], v[76:77], v[66:67], v[82:83] op_sel:[1,1,0] op_sel_hi:[0,1,1] neg_lo:[1,0,0]
    v_pk_mul_f32 v[84:85], v[78:79], v[66:67] op_sel:[0,0] op_sel_hi:[1,0]
    v_pk_fma_f32 v[84:85], v[78:79], v[66:67], v[84:85] op_sel:[1,1,0] op_sel_hi:[0,1,1] neg_lo:[1,0,0]
    v_cvt_pk_f16_f32 v173, v82, -v83
    v_cvt_pk_f16_f32 v174, v84, -v85
    v_pk_mul_f32 v[76:77], v[74:75], v[72:73] op_sel:[0,0] op_sel_hi:[1,0]
    v_pk_fma_f32 v[76:77], v[74:75], v[72:73], v[76:77] op_sel:[1,1,0] op_sel_hi:[0,1,1] neg_lo:[1,0,0]
    v_cvt_pk_f16_f32 v175, v76, -v77
    ds_write_addtid_b32 v172 offset:7888
    ds_write_addtid_b32 v173 offset:8160
    ds_write_addtid_b32 v174 offset:8432
    v_pk_mul_f32 v[78:79], v[76:77], v[66:67] op_sel:[0,0] op_sel_hi:[1,0]
    v_pk_fma_f32 v[78:79], v[76:77], v[66:67], v[78:79] op_sel:[1,1,0] op_sel_hi:[0,1,1] neg_lo:[1,0,0]
    v_cvt_pk_f16_f32 v168, v78, -v79
    v_pk_mul_f32 v[76:77], v[78:79], v[66:67] op_sel:[0,0] op_sel_hi:[1,0]
    v_pk_fma_f32 v[76:77], v[78:79], v[66:67], v[76:77] op_sel:[1,1,0] op_sel_hi:[0,1,1] neg_lo:[1,0,0]
    v_cvt_pk_f16_f32 v169, v76, -v77
    v_pk_mul_f32 v[78:79], v[76:77], v[66:67] op_sel:[0,0] op_sel_hi:[1,0]
    v_pk_fma_f32 v[78:79], v[76:77], v[66:67], v[78:79] op_sel:[1,1,0] op_sel_hi:[0,1,1] neg_lo:[1,0,0]
    v_cvt_pk_f16_f32 v170, v78, -v79
    ds_write_addtid_b32 v175 offset:8704
    ds_write_addtid_b32 v168 offset:8976
    ds_write_addtid_b32 v169 offset:9248
    v_pk_mul_f32 v[76:77], v[78:79], v[66:67] op_sel:[0,0] op_sel_hi:[1,0]
    v_pk_fma_f32 v[76:77], v[78:79], v[66:67], v[76:77] op_sel:[1,1,0] op_sel_hi:[0,1,1] neg_lo:[1,0,0]
    v_cvt_pk_f16_f32 v171, v76, -v77
    v_pk_mul_f32 v[78:79], v[76:77], v[66:67] op_sel:[0,0] op_sel_hi:[1,0]
    v_pk_fma_f32 v[78:79], v[76:77], v[66:67], v[78:79] op_sel:[1,1,0] op_sel_hi:[0,1,1] neg_lo:[1,0,0]
    v_cvt_pk_f16_f32 v172, v78, -v79
    v_pk_mul_f32 v[76:77], v[78:79], v[66:67] op_sel:[0,0] op_sel_hi:[1,0]
    v_pk_fma_f32 v[76:77], v[78:79], v[66:67], v[76:77] op_sel:[1,1,0] op_sel_hi:[0,1,1] neg_lo:[1,0,0]
    v_cvt_pk_f16_f32 v173, v76, -v77
    ds_write_addtid_b32 v170 offset:9520
    ds_write_addtid_b32 v171 offset:9792
    ds_write_addtid_b32 v172 offset:10064
    v_pk_mul_f32 v[78:79], v[76:77], v[66:67] op_sel:[0,0] op_sel_hi:[1,0]
    v_pk_fma_f32 v[78:79], v[76:77], v[66:67], v[78:79] op_sel:[1,1,0] op_sel_hi:[0,1,1] neg_lo:[1,0,0]
    v_cvt_pk_f16_f32 v174, v78, -v79
    v_pk_mul_f32 v[76:77], v[78:79], v[66:67] op_sel:[0,0] op_sel_hi:[1,0]
    v_pk_fma_f32 v[76:77], v[78:79], v[66:67], v[76:77] op_sel:[1,1,0] op_sel_hi:[0,1,1] neg_lo:[1,0,0]
    v_cvt_pk_f16_f32 v175, v76, -v77
    ds_write_addtid_b32 v173 offset:10336
    ds_write_addtid_b32 v174 offset:10608
    ds_write_addtid_b32 v175 offset:10880
    ds_read_b128 v[144:147], v91 offset:11152
    ds_read_b128 v[96:99], v91 offset:0
    ds_read_b128 v[112:115], v91 offset:4352
    ds_read_b128 v[128:131], v91 offset:8704
    ds_read_b128 v[148:151], v91 offset:11216
    ds_read_b128 v[100:103], v91 offset:64
    ds_read_b128 v[116:119], v91 offset:4416
    ds_read_b128 v[132:135], v91 offset:8768
    ds_read_b128 v[152:155], v91 offset:11280
    ds_read_b128 v[104:107], v91 offset:128
    ds_read_b128 v[120:123], v91 offset:4480
    ds_read_b128 v[136:139], v91 offset:8832
    ds_read_b128 v[156:159], v91 offset:11344
    ds_read_b128 v[108:111], v91 offset:192
    ds_read_b128 v[124:127], v91 offset:4544
    ds_read_b128 v[140:143], v91 offset:8896
    s_waitcnt vmcnt(0)
    s_barrier
    s_cmp_lg_u32 s28, 0
    s_cbranch_scc1 noflag_8
    s_lshl_b32 s66, s31, 6
    s_add_u32 s66, s66, 16384
    v_mov_b32 v2, s66
    v_mov_b32 v3, s96
    s_mov_b64 exec, 1
    buffer_store_dword v3, v2, s[4:7], 0 offen sc1
    s_mov_b64 exec, -1
noflag_8:
    s_add_u32 s70, s38, 0
    s_cmp_ge_u32 s70, 1835008
    s_cselect_b32 s71, 1835008, 0
    s_sub_u32 s70, s70, s71
    s_add_u32 m0, s44, 0
    s_nop 0
    s_nop 0
    buffer_load_dwordx4 v224, s[12:15], s70 offen offset:0 lds
    buffer_load_dwordx4 v225, s[12:15], s70 offen offset:1024 lds
    buffer_load_dwordx4 v226, s[12:15], s70 offen offset:2048 lds
    buffer_load_dwordx4 v227, s[12:15], s70 offen offset:3072 lds
    s_add_u32 s70, s38, 114688
    s_cmp_ge_u32 s70, 1835008
    s_cselect_b32 s71, 1835008, 0
    s_sub_u32 s70, s70, s71
    s_add_u32 m0, s44, 4096
    s_nop 0
    buffer_load_dwordx4 v224, s[12:15], s70 offen offset:0 lds
    buffer_load_dwordx4 v225, s[12:15], s70 offen offset:1024 lds
    buffer_load_dwordx4 v226, s[12:15], s70 offen offset:2048 lds
    buffer_load_dwordx4 v227, s[12:15], s70 offen offset:3072 lds
    v_lshlrev_b32 v44, 16, v44
    v_lshlrev_b32 v45, 16, v45
    v_lshlrev_b32 v46, 16, v46
    v_lshlrev_b32 v47, 16, v47
    s_and_b32 s66, s68, 0xffff0000
    v_mov_b32_e64 v93, s66
    v_mul_f32 v92, 0x3fb8aa00, v93
    v_exp_f32_e64 v92, v92
    v_mul_f32 v55, 0x36a407db, v93
    v_fma_f32 v55, v92, v55, v92
    v_cvt_pk_bf16_f32 v55, v55, v55
    v_lshlrev_b32_e64 v55, 16, v55
    v_add_f32 v53, abs(v46), abs(v47)
    v_mul_f32 v92, 0x3fb8aa00, v44
    v_exp_f32_e64 v92, v92
    v_mul_f32 v56, 0x36a407db, v44
    v_fma_f32 v56, v92, v56, v92
    v_cvt_pk_bf16_f32 v56, v56, v56
    v_lshlrev_b32_e64 v56, 16, v56
    v_add_f32_dpp v53, v53, v53 quad_perm:[1,0,3,2] row_mask:0xf bank_mask:0xf
    v_mul_f32 v56, v56, v55
    v_mul_f32 v57, v45, v55
    v_add_f32_dpp v53, v53, v53 quad_perm:[2,3,0,1] row_mask:0xf bank_mask:0xf
    v_mul_f32 v56, 0xbfb8aa3b, v56
    v_mul_f32_e64 v57, 0x3e22f983, v57
    v_add_f32_dpp v53, v53, v53 row_half_mirror row_mask:0xf bank_mask:0xf
    v_exp_f32 v82, v56
    v_fract_f32 v92, v57
    v_add_f32_dpp v53, v53, v53 row_ror:8 row_mask:0xf bank_mask:0xf
    v_cos_f32 v58, v92
    v_sin_f32 v59, v92
    v_mov_b32_e64 v93, v53
    v_mul_f32 v84, 0x43000000, v56
    v_mul_f32 v92, 0x43000000, v57
    v_permlane16_swap_b32 v53, v93
    v_pk_mul_f32 v[58:59], v[58:59], v[82:83] op_sel:[0,0] op_sel_hi:[1,0]
    v_add_f32 v53, v53, v93
    v_exp_f32 v84, v84
    v_fract_f32 v92, v92
    v_mov_b32 v93, v53
    v_cos_f32 v66, v92
    v_sin_f32 v67, v92
    v_permlane32_swap_b32 v53, v93
    v_pk_mul_f32 v[60:61], v[58:59], v[58:59] op_sel:[0,0] op_sel_hi:[1,0]
    v_pk_fma_f32 v[60:61], v[58:59], v[58:59], v[60:61] op_sel:[1,1,0] op_sel_hi:[0,1,1] neg_lo:[1,0,0]
    v_add_f32_e64 v53, v53, v93
    v_pk_mul_f32 v[66:67], v[66:67], v[84:85] op_sel:[0,0] op_sel_hi:[1,0]
    v_add_f32 v53, 0x0da24260, v53
    v_pk_mul_f32 v[62:63], v[60:61], v[60:61] op_sel:[0,0] op_sel_hi:[1,0]
    v_pk_fma_f32 v[62:63], v[60:61], v[60:61], v[62:63] op_sel:[1,1,0] op_sel_hi:[0,1,1] neg_lo:[1,0,0]
    v_rcp_f32_e64 v92, v53
    v_pk_mul_f32 v[68:69], v[66:67], v[66:67] op_sel:[0,0] op_sel_hi:[1,0]
    v_pk_fma_f32 v[68:69], v[66:67], v[66:67], v[68:69] op_sel:[1,1,0] op_sel_hi:[0,1,1] neg_lo:[1,0,0]
    v_pk_mul_f32 v[64:65], v[62:63], v[62:63] op_sel:[0,0] op_sel_hi:[1,0]
    v_pk_fma_f32 v[64:65], v[62:63], v[62:63], v[64:65] op_sel:[1,1,0] op_sel_hi:[0,1,1] neg_lo:[1,0,0]
    v_mul_f32 v74, v46, v92
    v_mul_f32 v75, v47, v92
    v_pk_mul_f32 v[70:71], v[68:69], v[68:69] op_sel:[0,0] op_sel_hi:[1,0]
    v_pk_fma_f32 v[70:71], v[68:69], v[68:69], v[70:71] op_sel:[1,1,0] op_sel_hi:[0,1,1] neg_lo:[1,0,0]
    s_mul_i32 s66, s28, 15504
    s_add_u32 s66, s66, 13056
    s_mov_b32 m0, s66
    v_pk_mul_f32 v[72:73], v[70:71], v[70:71] op_sel:[0,0] op_sel_hi:[1,0]
    v_pk_fma_f32 v[72:73], v[70:71], v[70:71], v[72:73] op_sel:[1,1,0] op_sel_hi:[0,1,1] neg_lo:[1,0,0]
    v_and_b32 v92, 15, v1
    v_mul_u32_u24 v92, 272, v92
    v_lshrrev_b32_e64 v93, 4, v1
    v_lshl_add_u32 v92, v93, 4, v92
    v_add_u32 v91, s66, v92
    s_waitcnt lgkmcnt(0)
    v_mfma_f32_16x16x32_f16 v[16:19], v[96:99], v[144:147], 0
    v_mfma_f32_16x16x32_f16 v[20:23], v[112:115], v[144:147], 0
    v_mfma_f32_16x16x32_f16 v[24:27], v[128:131], v[144:147], 0
    v_mfma_f32_16x16x32_f16 v[16:19], v[100:103], v[148:151], v[16:19]
    v_mfma_f32_16x16x32_f16 v[20:23], v[116:119], v[148:151], v[20:23]
    v_mfma_f32_16x16x32_f16 v[24:27], v[132:135], v[148:151], v[24:27]
    v_mfma_f32_16x16x32_f16 v[16:19], v[104:107], v[152:155], v[16:19]
    v_mfma_f32_16x16x32_f16 v[20:23], v[120:123], v[152:155], v[20:23]
    v_mfma_f32_16x16x32_f16 v[24:27], v[136:139], v[152:155], v[24:27]
    v_mfma_f32_16x16x32_f16 v[16:19], v[108:111], v[156:159], v[16:19]
    v_mfma_f32_16x16x32_f16 v[20:23], v[124:127], v[156:159], v[20:23]
    v_mfma_f32_16x16x32_f16 v[24:27], v[140:143], v[156:159], v[24:27]
    v_mov_b32 v90, 0x00003c00
    v_cvt_pk_f16_f32 v168, v64, v65
    v_cvt_pk_f16_f32 v169, v74, -v75
    v_pk_mul_f32 v[82:83], v[74:75], v[66:67] op_sel:[0,0] op_sel_hi:[1,0]
    v_pk_fma_f32 v[82:83], v[74:75], v[66:67], v[82:83] op_sel:[1,1,0] op_sel_hi:[0,1,1] neg_lo:[1,0,0]
    v_cvt_pk_f16_f32 v170, v82, -v83
    ds_write_addtid_b32 v90 offset:11152
    ds_write_addtid_b32 v168 offset:11424
    ds_write_addtid_b32 v169 offset:0
    v_pk_mul_f32 v[76:77], v[74:75], v[58:59] op_sel:[0,0] op_sel_hi:[1,0]
    v_pk_fma_f32 v[76:77], v[74:75], v[58:59], v[76:77] op_sel:[1,1,0] op_sel_hi:[0,1,1] neg_lo:[1,0,0]
    v_pk_mul_f32 v[80:81], v[64:65], v[64:65] op_sel:[0,0] op_sel_hi:[1,0]
    v_pk_fma_f32 v[80:81], v[64:65], v[64:65], v[80:81] op_sel:[1,1,0] op_sel_hi:[0,1,1] neg_lo:[1,0,0]
    v_cvt_pk_f16_f32 v171, v80, v81
    v_cvt_pk_f16_f32 v172, v76, -v77
    v_pk_mul_f32 v[82:83], v[76:77], v[66:67] op_sel:[0,0] op_sel_hi:[1,0]
    v_pk_fma_f32 v[82:83], v[76:77], v[66:67], v[82:83] op_sel:[1,1,0] op_sel_hi:[0,1,1] neg_lo:[1,0,0]
    v_cvt_pk_f16_f32 v173, v82, -v83
    ds_write_addtid_b32 v170 offset:2176
    ds_write_addtid_b32 v171 offset:11696
    ds_write_addtid_b32 v172 offset:272
    v_pk_mul_f32 v[78:79], v[76:77], v[58:59] op_sel:[0,0] op_sel_hi:[1,0]
    v_pk_fma_f32 v[78:79], v[76:77], v[58:59], v[78:79] op_sel:[1,1,0] op_sel_hi:[0,1,1] neg_lo:[1,0,0]
    v_pk_mul_f32 v[94:95], v[80:81], v[64:65] op_sel:[0,0] op_sel_hi:[1,0]
    v_pk_fma_f32 v[94:95], v[80:81], v[64:65], v[94:95] op_sel:[1,1,0] op_sel_hi:[0,1,1] neg_lo:[1,0,0]
    v_cvt_pk_f16_f32 v174, v94, v95
    v_cvt_pk_f16_f32 v175, v78, -v79
    v_pk_mul_f32 v[82:83], v[78:79], v[66:67] op_sel:[0,0] op_sel_hi:[1,0]
    v_pk_fma_f32 v[82:83], v[78:79], v[66:67], v[82:83] op_sel:[1,1,0] op_sel_hi:[0,1,1] neg_lo:[1,0,0]
    v_cvt_pk_f16_f32 v168, v82, -v83
    ds_write_addtid_b32 v173 offset:2448
    ds_write_addtid_b32 v174 offset:11968
    ds_write_addtid_b32 v175 offset:544
    v_pk_mul_f32 v[76:77], v[78:79], v[58:59] op_sel:[0,0] op_sel_hi:[1,0]
    v_pk_fma_f32 v[76:77], v[78:79], v[58:59], v[76:77] op_sel:[1,1,0] op_sel_hi:[0,1,1] neg_lo:[1,0,0]
    v_pk_mul_f32 v[80:81], v[94:95], v[64:65] op_sel:[0,0] op_sel_hi:[1,0]
    v_pk_fma_f32 v[80:81], v[94:95], v[64:65], v[80:81] op_sel:[1,1,0] op_sel_hi:[0,1,1] neg_lo:[1,0,0]
    v_cvt_pk_f16_f32 v169, v80, v81
    v_cvt_pk_f16_f32 v170, v76, -v77
    v_pk_mul_f32 v[82:83], v[76:77], v[66:67] op_sel:[0,0] op_sel_hi:[1,0]
    v_pk_fma_f32 v[82:83], v[76:77], v[66:67], v[82:83] op_sel:[1,1,0] op_sel_hi:[0,1,1] neg_lo:[1,0,0]
    v_cvt_pk_f16_f32 v171, v82, -v83
    ds_write_addtid_b32 v168 offset:2720
    ds_write_addtid_b32 v169 offset:12240
    ds_write_addtid_b32 v170 offset:816
    v_pk_mul_f32 v[78:79], v[76:77], v[58:59] op_sel:[0,0] op_sel_hi:[1,0]
    v_pk_fma_f32 v[78:79], v[76:77], v[58:59], v[78:79] op_sel:[1,1,0] op_sel_hi:[0,1,1] neg_lo:[1,0,0]
    v_pk_mul_f32 v[94:95], v[80:81], v[64:65] op_sel:[0,0] op_sel_hi:[1,0]
    v_pk_fma_f32 v[94:95], v[80:81], v[64:65], v[94:95] op_sel:[1,1,0] op_sel_hi:[0,1,1] neg_lo:[1,0,0]
    v_cvt_pk_f16_f32 v172, v94, v95
    v_cvt_pk_f16_f32 v173, v78, -v79
    v_pk_mul_f32 v[82:83], v[78:79], v[66:67] op_sel:[0,0] op_sel_hi:[1,0]
    v_pk_fma_f32 v[82:83], v[78:79], v[66:67], v[82:83] op_sel:[1,1,0] op_sel_hi:[0,1,1] neg_lo:[1,0,0]
    v_cvt_pk_f16_f32 v174, v82, -v83
    ds_write_addtid_b32 v171 offset:2992
    ds_write_addtid_b32 v172 offset:12512
    ds_write_addtid_b32 v173 offset:1088
    v_pk_mul_f32 v[76:77], v[78:79], v[58:59] op_sel:[0,0] op_sel_hi:[1,0]
    v_pk_fma_f32 v[76:77], v[78:79], v[58:59], v[76:77] op_sel:[1,1,0] op_sel_hi:[0,1,1] neg_lo:[1,0,0]
    v_pk_mul_f32 v[80:81], v[94:95], v[64:65] op_sel:[0,0] op_sel_hi:[1,0]
    v_pk_fma_f32 v[80:81], v[94:95], v[64:65], v[80:81] op_sel:[1,1,0] op_sel_hi:[0,1,1] neg_lo:[1,0,0]
    v_cvt_pk_f16_f32 v175, v80, v81
    v_cvt_pk_f16_f32 v168, v76, -v77
    v_pk_mul_f32 v[82:83], v[76:77], v[66:67] op_sel:[0,0] op_sel_hi:[1,0]
    v_pk_fma_f32 v[82:83], v[76:77], v[66:67], v[82:83] op_sel:[1,1,0] op_sel_hi:[0,1,1] neg_lo:[1,0,0]
    v_cvt_pk_f16_f32 v169, v82, -v83
    ds_write_addtid_b32 v174 offset:3264
    ds_write_addtid_b32 v175 offset:12784
    ds_write_addtid_b32 v168 offset:1360
    v_pk_mul_f32 v[78:79], v[76:77], v[58:59] op_sel:[0,0] op_sel_hi:[1,0]
    v_pk_fma_f32 v[78:79], v[76:77], v[58:59], v[78:79] op_sel:[1,1,0] op_sel_hi:[0,1,1] neg_lo:[1,0,0]
    v_pk_mul_f32 v[94:95], v[80:81], v[64:65] op_sel:[0,0] op_sel_hi:[1,0]
    v_pk_fma_f32 v[94:95], v[80:81], v[64:65], v[94:95] op_sel:[1,1,0] op_sel_hi:[0,1,1] neg_lo:[1,0,0]
    v_cvt_pk_f16_f32 v170, v94, v95
    v_cvt_pk_f16_f32 v171, v78, -v79
    v_pk_mul_f32 v[82:83], v[78:79], v[66:67] op_sel:[0,0] op_sel_hi:[1,0]
    v_pk_fma_f32 v[82:83], v[78:79], v[66:67], v[82:83] op_sel:[1,1,0] op_sel_hi:[0,1,1] neg_lo:[1,0,0]
    v_cvt_pk_f16_f32 v172, v82, -v83
    ds_write_addtid_b32 v169 offset:3536
    ds_write_addtid_b32 v170 offset:13056
    ds_write_addtid_b32 v171 offset:1632
    v_pk_mul_f32 v[76:77], v[78:79], v[58:59] op_sel:[0,0] op_sel_hi:[1,0]
    v_pk_fma_f32 v[76:77], v[78:79], v[58:59], v[76:77] op_sel:[1,1,0] op_sel_hi:[0,1,1] neg_lo:[1,0,0]
    v_pk_mul_f32 v[80:81], v[94:95], v[64:65] op_sel:[0,0] op_sel_hi:[1,0]
    v_pk_fma_f32 v[80:81], v[94:95], v[64:65], v[80:81] op_sel:[1,1,0] op_sel_hi:[0,1,1] neg_lo:[1,0,0]
    v_cvt_pk_f16_f32 v173, v80, v81
    v_cvt_pk_f16_f32 v174, v76, -v77
    v_pk_mul_f32 v[82:83], v[76:77], v[66:67] op_sel:[0,0] op_sel_hi:[1,0]
    v_pk_fma_f32 v[82:83], v[76:77], v[66:67], v[82:83] op_sel:[1,1,0] op_sel_hi:[0,1,1] neg_lo:[1,0,0]
    v_cvt_pk_f16_f32 v175, v82, -v83
    ds_write_addtid_b32 v172 offset:3808
    ds_write_addtid_b32 v173 offset:13328
    ds_write_addtid_b32 v174 offset:1904
    v_pk_mul_f32 v[76:77], v[74:75], v[68:69] op_sel:[0,0] op_sel_hi:[1,0]
    v_pk_fma_f32 v[76:77], v[74:75], v[68:69], v[76:77] op_sel:[1,1,0] op_sel_hi:[0,1,1] neg_lo:[1,0,0]
    v_pk_mul_f32 v[94:95], v[80:81], v[64:65] op_sel:[0,0] op_sel_hi:[1,0]
    v_pk_fma_f32 v[94:95], v[80:81], v[64:65], v[94:95] op_sel:[1,1,0] op_sel_hi:[0,1,1] neg_lo:[1,0,0]
    v_cvt_pk_f16_f32 v168, v94, v95
    v_cvt_pk_f16_f32 v169, v76, -v77
    v_pk_mul_f32 v[82:83], v[76:77], v[66:67] op_sel:[0,0] op_sel_hi:[1,0]
    v_pk_fma_f32 v[82:83], v[76:77], v[66:67], v[82:83] op_sel:[1,1,0] op_sel_hi:[0,1,1] neg_lo:[1,0,0]
    v_cvt_pk_f16_f32 v170, v82, -v83
    ds_write_addtid_b32 v175 offset:4080
    ds_write_addtid_b32 v168 offset:13600
    ds_write_addtid_b32 v169 offset:4352
    v_pk_mul_f32 v[78:79], v[76:77], v[60:61] op_sel:[0,0] op_sel_hi:[1,0]
    v_pk_fma_f32 v[78:79], v[76:77], v[60:61], v[78:79] op_sel:[1,1,0] op_sel_hi:[0,1,1] neg_lo:[1,0,0]
    v_pk_mul_f32 v[80:81], v[94:95], v[64:65] op_sel:[0,0] op_sel_hi:[1,0]
    v_pk_fma_f32 v[80:81], v[94:95], v[64:65], v[80:81] op_sel:[1,1,0] op_sel_hi:[0,1,1] neg_lo:[1,0,0]
    v_cvt_pk_f16_f32 v171, v80, v81
    v_cvt_pk_f16_f32 v172, v78, -v79
    v_pk_mul_f32 v[82:83], v[78:79], v[66:67] op_sel:[0,0] op_sel_hi:[1,0]
    v_pk_fma_f32 v[82:83], v[78:79], v[66:67], v[82:83] op_sel:[1,1,0] op_sel_hi:[0,1,1] neg_lo:[1,0,0]
    v_cvt_pk_f16_f32 v173, v82, -v83
    ds_write_addtid_b32 v170 offset:5440
    ds_write_addtid_b32 v171 offset:13872
    ds_write_addtid_b32 v172 offset:4624
    v_pk_mul_f32 v[76:77], v[78:79], v[60:61] op_sel:[0,0] op_sel_hi:[1,0]
    v_pk_fma_f32 v[76:77], v[78:79], v[60:61], v[76:77] op_sel:[1,1,0] op_sel_hi:[0,1,1] neg_lo:[1,0,0]
    v_pk_mul_f32 v[94:95], v[80:81], v[64:65] op_sel:[0,0] op_sel_hi:[1,0]
    v_pk_fma_f32 v[94:95], v[80:81], v[64:65], v[94:95] op_sel:[1,1,0] op_sel_hi:[0,1,1] neg_lo:[1,0,0]
    v_cvt_pk_f16_f32 v174, v94, v95
    v_cvt_pk_f16_f32 v175, v76, -v77
    v_pk_mul_f32 v[82:83], v[76:77], v[66:67] op_sel:[0,0] op_sel_hi:[1,0]
    v_pk_fma_f32 v[82:83], v[76:77], v[66:67], v[82:83] op_sel:[1,1,0] op_sel_hi:[0,1,1] neg_lo:[1,0,0]
    v_cvt_pk_f16_f32 v168, v82, -v83
    ds_write_addtid_b32 v173 offset:5712
    ds_write_addtid_b32 v174 offset:14144
    ds_write_addtid_b32 v175 offset:4896
    v_pk_mul_f32 v[78:79], v[76:77], v[60:61] op_sel:[0,0] op_sel_hi:[1,0]
    v_pk_fma_f32 v[78:79], v[76:77], v[60:61], v[78:79] op_sel:[1,1,0] op_sel_hi:[0,1,1] neg_lo:[1,0,0]
    v_pk_mul_f32 v[80:81], v[94:95], v[64:65] op_sel:[0,0] op_sel_hi:[1,0]
    v_pk_fma_f32 v[80:81], v[94:95], v[64:65], v[80:81] op_sel:[1,1,0] op_sel_hi:[0,1,1] neg_lo:[1,0,0]
    v_cvt_pk_f16_f32 v169, v80, v81
    v_cvt_pk_f16_f32 v170, v78, -v79
    v_pk_mul_f32 v[82:83], v[78:79], v[66:67] op_sel:[0,0] op_sel_hi:[1,0]
    v_pk_fma_f32 v[82:83], v[78:79], v[66:67], v[82:83] op_sel:[1,1,0] op_sel_hi:[0,1,1] neg_lo:[1,0,0]
    v_cvt_pk_f16_f32 v171, v82, -v83
    ds_write_addtid_b32 v168 offset:5984
    ds_write_addtid_b32 v169 offset:14416
    ds_write_addtid_b32 v170 offset:5168
    v_pk_mul_f32 v[76:77], v[74:75], v[70:71] op_sel:[0,0] op_sel_hi:[1,0]
    v_pk_fma_f32 v[76:77], v[74:75], v[70:71], v[76:77] op_sel:[1,1,0] op_sel_hi:[0,1,1] neg_lo:[1,0,0]
    v_pk_mul_f32 v[94:95], v[80:81], v[64:65] op_sel:[0,0] op_sel_hi:[1,0]
    v_pk_fma_f32 v[94:95], v[80:81], v[64:65], v[94:95] op_sel:[1,1,0] op_sel_hi:[0,1,1] neg_lo:[1,0,0]
    v_cvt_pk_f16_f32 v172, v94, v95
    v_cvt_pk_f16_f32 v173, v76, -v77
    v_pk_mul_f32 v[78:79], v[76:77], v[62:63] op_sel:[0,0] op_sel_hi:[1,0]
    v_pk_fma_f32 v[78:79], v[76:77], v[62:63], v[78:79] op_sel:[1,1,0] op_sel_hi:[0,1,1] neg_lo:[1,0,0]
    v_pk_mul_f32 v[80:81], v[94:95], v[64:65] op_sel:[0,0] op_sel_hi:[1,0]
    v_pk_fma_f32 v[80:81], v[94:95], v[64:65], v[80:81] op_sel:[1,1,0] op_sel_hi:[0,1,1] neg_lo:[1,0,0]
    v_cvt_pk_f16_f32 v174, v80, v81
    ds_write_addtid_b32 v171 offset:6256
    ds_write_addtid_b32 v172 offset:14688
    ds_write_addtid_b32 v173 offset:6528
    v_cvt_pk_f16_f32 v175, v78, -v79
    v_pk_mul_f32 v[82:83], v[76:77], v[66:67] op_sel:[0,0] op_sel_hi:[1,0]
    v_pk_fma_f32 v[82:83], v[76:77], v[66:67], v[82:83] op_sel:[1,1,0] op_sel_hi:[0,1,1] neg_lo:[1,0,0]
    v_pk_mul_f32 v[84:85], v[78:79], v[66:67] op_sel:[0,0] op_sel_hi:[1,0]
    v_pk_fma_f32 v[84:85], v[78:79], v[66:67], v[84:85] op_sel:[1,1,0] op_sel_hi:[0,1,1] neg_lo:[1,0,0]
    v_pk_mul_f32 v[94:95], v[80:81], v[64:65] op_sel:[0,0] op_sel_hi:[1,0]
    v_pk_fma_f32 v[94:95], v[80:81], v[64:65], v[94:95] op_sel:[1,1,0] op_sel_hi:[0,1,1] neg_lo:[1,0,0]
    v_cvt_pk_f16_f32 v168, v94, v95
    v_cvt_pk_f16_f32 v169, v82, -v83
    ds_write_addtid_b32 v174 offset:14960
    ds_write_addtid_b32 v175 offset:6800
    ds_write_addtid_b32 v168 offset:15232
    v_cvt_pk_f16_f32 v170, v84, -v85
    v_pk_mul_f32 v[76:77], v[82:83], v[66:67] op_sel:[0,0] op_sel_hi:[1,0]
    v_pk_fma_f32 v[76:77], v[82:83], v[66:67], v[76:77] op_sel:[1,1,0] op_sel_hi:[0,1,1] neg_lo:[1,0,0]
    v_pk_mul_f32 v[78:79], v[84:85], v[66:67] op_sel:[0,0] op_sel_hi:[1,0]
    v_pk_fma_f32 v[78:79], v[84:85], v[66:67], v[78:79] op_sel:[1,1,0] op_sel_hi:[0,1,1] neg_lo:[1,0,0]
    v_cvt_pk_f16_f32 v171, v76, -v77
    v_cvt_pk_f16_f32 v172, v78, -v79
    ds_write_addtid_b32 v169 offset:7072
    ds_write_addtid_b32 v170 offset:7344
    ds_write_addtid_b32 v171 offset:7616
    v_pk_mul_f32 v[82:83], v[76:77], v[66:67] op_sel:[0,0] op_sel_hi:[1,0]
    v_pk_fma_f32 v[82:83], v[76:77], v[66:67], v[82:83] op_sel:[1,1,0] op_sel_hi:[0,1,1] neg_lo:[1,0,0]
    v_pk_mul_f32 v[84:85], v[78:79], v[66:67] op_sel:[0,0] op_sel_hi:[1,0]
    v_pk_fma_f32 v[84:85], v[78:79], v[66:67], v[84:85] op_sel:[1,1,0] op_sel_hi:[0,1,1] neg_lo:[1,0,0]
    v_cvt_pk_f16_f32 v173, v82, -v83
    v_cvt_pk_f16_f32 v174, v84, -v85
    v_pk_mul_f32 v[76:77], v[74:75], v[72:73] op_sel:[0,0] op_sel_hi:[1,0]
    v_pk_fma_f32 v[76:77], v[74:75], v[72:73], v[76:77] op_sel:[1,1,0] op_sel_hi:[0,1,1] neg_lo:[1,0,0]
    v_cvt_pk_f16_f32 v175, v76, -v77
    ds_write_addtid_b32 v172 offset:7888
    ds_write_addtid_b32 v173 offset:8160
    ds_write_addtid_b32 v174 offset:8432
    v_pk_mul_f32 v[78:79], v[76:77], v[66:67] op_sel:[0,0] op_sel_hi:[1,0]
    v_pk_fma_f32 v[78:79], v[76:77], v[66:67], v[78:79] op_sel:[1,1,0] op_sel_hi:[0,1,1] neg_lo:[1,0,0]
    v_cvt_pk_f16_f32 v168, v78, -v79
    v_pk_mul_f32 v[76:77], v[78:79], v[66:67] op_sel:[0,0] op_sel_hi:[1,0]
    v_pk_fma_f32 v[76:77], v[78:79], v[66:67], v[76:77] op_sel:[1,1,0] op_sel_hi:[0,1,1] neg_lo:[1,0,0]
    v_cvt_pk_f16_f32 v169, v76, -v77
    v_pk_mul_f32 v[78:79], v[76:77], v[66:67] op_sel:[0,0] op_sel_hi:[1,0]
    v_pk_fma_f32 v[78:79], v[76:77], v[66:67], v[78:79] op_sel:[1,1,0] op_sel_hi:[0,1,1] neg_lo:[1,0,0]
    v_cvt_pk_f16_f32 v170, v78, -v79
    ds_write_addtid_b32 v175 offset:8704
    ds_write_addtid_b32 v168 offset:8976
    ds_write_addtid_b32 v169 offset:9248
    v_pk_mul_f32 v[76:77], v[78:79], v[66:67] op_sel:[0,0] op_sel_hi:[1,0]
    v_pk_fma_f32 v[76:77], v[78:79], v[66:67], v[76:77] op_sel:[1,1,0] op_sel_hi:[0,1,1] neg_lo:[1,0,0]
    v_cvt_pk_f16_f32 v171, v76, -v77
    v_pk_mul_f32 v[78:79], v[76:77], v[66:67] op_sel:[0,0] op_sel_hi:[1,0]
    v_pk_fma_f32 v[78:79], v[76:77], v[66:67], v[78:79] op_sel:[1,1,0] op_sel_hi:[0,1,1] neg_lo:[1,0,0]
    v_cvt_pk_f16_f32 v172, v78, -v79
    v_pk_mul_f32 v[76:77], v[78:79], v[66:67] op_sel:[0,0] op_sel_hi:[1,0]
    v_pk_fma_f32 v[76:77], v[78:79], v[66:67], v[76:77] op_sel:[1,1,0] op_sel_hi:[0,1,1] neg_lo:[1,0,0]
    v_cvt_pk_f16_f32 v173, v76, -v77
    ds_write_addtid_b32 v170 offset:9520
    ds_write_addtid_b32 v171 offset:9792
    ds_write_addtid_b32 v172 offset:10064
    v_pk_mul_f32 v[78:79], v[76:77], v[66:67] op_sel:[0,0] op_sel_hi:[1,0]
    v_pk_fma_f32 v[78:79], v[76:77], v[66:67], v[78:79] op_sel:[1,1,0] op_sel_hi:[0,1,1] neg_lo:[1,0,0]
    v_cvt_pk_f16_f32 v174, v78, -v79
    v_pk_mul_f32 v[76:77], v[78:79], v[66:67] op_sel:[0,0] op_sel_hi:[1,0]
    v_pk_fma_f32 v[76:77], v[78:79], v[66:67], v[76:77] op_sel:[1,1,0] op_sel_hi:[0,1,1] neg_lo:[1,0,0]
    v_cvt_pk_f16_f32 v175, v76, -v77
    ds_write_addtid_b32 v173 offset:10336
    ds_write_addtid_b32 v174 offset:10608
    ds_write_addtid_b32 v175 offset:10880
    ds_read_b128 v[144:147], v91 offset:11152
    ds_read_b128 v[96:99], v91 offset:0
    ds_read_b128 v[112:115], v91 offset:4352
    ds_read_b128 v[128:131], v91 offset:8704
    ds_read_b128 v[148:151], v91 offset:11216
    ds_read_b128 v[100:103], v91 offset:64
    ds_read_b128 v[116:119], v91 offset:4416
    ds_read_b128 v[132:135], v91 offset:8768
    ds_read_b128 v[152:155], v91 offset:11280
    ds_read_b128 v[104:107], v91 offset:128
    ds_read_b128 v[120:123], v91 offset:4480
    ds_read_b128 v[136:139], v91 offset:8832
    ds_read_b128 v[156:159], v91 offset:11344
    ds_read_b128 v[108:111], v91 offset:192
    ds_read_b128 v[124:127], v91 offset:4544
    ds_read_b128 v[140:143], v91 offset:8896
    s_waitcnt lgkmcnt(12)
    v_mfma_f32_16x16x32_f16 v[28:31], v[96:99], v[144:147], 0
    v_mfma_f32_16x16x32_f16 v[32:35], v[112:115], v[144:147], 0
    v_mfma_f32_16x16x32_f16 v[36:39], v[128:131], v[144:147], 0
    s_waitcnt lgkmcnt(8)
    v_mfma_f32_16x16x32_f16 v[28:31], v[100:103], v[148:151], v[28:31]
    v_mfma_f32_16x16x32_f16 v[32:35], v[116:119], v[148:151], v[32:35]
    v_mfma_f32_16x16x32_f16 v[36:39], v[132:135], v[148:151], v[36:39]
    s_waitcnt lgkmcnt(4)
    v_mfma_f32_16x16x32_f16 v[28:31], v[104:107], v[152:155], v[28:31]
    v_mfma_f32_16x16x32_f16 v[32:35], v[120:123], v[152:155], v[32:35]
    v_mfma_f32_16x16x32_f16 v[36:39], v[136:139], v[152:155], v[36:39]
    s_waitcnt lgkmcnt(0)
    v_mfma_f32_16x16x32_f16 v[28:31], v[108:111], v[156:159], v[28:31]
    v_mfma_f32_16x16x32_f16 v[32:35], v[124:127], v[156:159], v[32:35]
    v_mfma_f32_16x16x32_f16 v[36:39], v[140:143], v[156:159], v[36:39]
    buffer_load_dword v234, v233, s[4:7], 0 offen sc1
    buffer_load_dwordx4 v[220:223], v232, s[16:19], s42 offen
    s_add_u32 s42, s42, 32768
    buffer_load_dwordx4 v[220:223], v232, s[16:19], s42 offen
    s_add_u32 s42, s42, 32768
    buffer_load_dwordx4 v[220:223], v232, s[16:19], s42 offen
    s_add_u32 s42, s42, 32768
    buffer_load_dwordx4 v[220:223], v232, s[16:19], s42 offen
    s_add_u32 s42, s42, 32768
    s_mul_i32 s66, s28, 15504
    s_add_u32 s66, s66, 13056
    v_lshl_add_u32 v90, v1, 4, s66
    s_lshl_b32 s67, s28, 2
    s_add_u32 s67, s67, 512
    v_mov_b32_e64 v91, s67
    s_mov_b64 exec, 1
    ds_write_b32 v91, v52
    ds_write_b32 v91, v53 offset:16
    s_mov_b64 exec, -1
    s_nop 0
    v_pk_mul_f32 v[16:17], v[16:17], v[52:53] op_sel:[0,0] op_sel_hi:[1,0]
    v_pk_mul_f32 v[18:19], v[18:19], v[52:53] op_sel:[0,0] op_sel_hi:[1,0]
    ds_write_b128 v90, v[16:19] offset:0
    v_pk_mul_f32 v[20:21], v[20:21], v[52:53] op_sel:[0,0] op_sel_hi:[1,0]
    v_pk_mul_f32 v[22:23], v[22:23], v[52:53] op_sel:[0,0] op_sel_hi:[1,0]
    ds_write_b128 v90, v[20:23] offset:1024
    v_pk_mul_f32 v[24:25], v[24:25], v[52:53] op_sel:[0,0] op_sel_hi:[1,0]
    v_pk_mul_f32 v[26:27], v[26:27], v[52:53] op_sel:[0,0] op_sel_hi:[1,0]
    ds_write_b128 v90, v[24:27] offset:2048
    v_pk_mul_f32 v[28:29], v[28:29], v[52:53] op_sel:[0,1] op_sel_hi:[1,1]
    v_pk_mul_f32 v[30:31], v[30:31], v[52:53] op_sel:[0,1] op_sel_hi:[1,1]
    ds_write_b128 v90, v[28:31] offset:3072
    v_pk_mul_f32 v[32:33], v[32:33], v[52:53] op_sel:[0,1] op_sel_hi:[1,1]
    v_pk_mul_f32 v[34:35], v[34:35], v[52:53] op_sel:[0,1] op_sel_hi:[1,1]
    ds_write_b128 v90, v[32:35] offset:4096
    v_pk_mul_f32 v[36:37], v[36:37], v[52:53] op_sel:[0,1] op_sel_hi:[1,1]
    v_pk_mul_f32 v[38:39], v[38:39], v[52:53] op_sel:[0,1] op_sel_hi:[1,1]
    ds_write_b128 v90, v[36:39] offset:5120
    v_mov_b32 v96, 0
    v_mov_b32 v97, 0
    v_mov_b32 v98, 0
    v_mov_b32 v99, 0
    v_mov_b32 v92, 2176
    ds_write_b32 v92, v96
    ds_write_b32 v92, v96 offset:1600
    v_lshlrev_b32_e64 v92, 3, v1
    ds_write_b64 v92, v[96:97] offset:3840
    ds_write_b64 v92, v[96:97] offset:8448
    s_waitcnt lgkmcnt(0)
    s_barrier
    s_mov_b32 s43, 0
    s_waitcnt vmcnt(4)
    v_cmp_ne_u32 vcc, s96, v234
    s_nop 3
    s_cbranch_vccnz notearly_9
    s_lshl_b32 s66, s32, 4
    s_add_u32 s66, s66, 10485760
    v_mul_u32_u24 v2, 7168, v0
    v_add_u32_e64 v2, s66, v2
    v_add_u32 v3, 3584, v2
    buffer_load_dwordx4 v[176:179], v2, s[4:7], 0 offen sc1
    buffer_load_dwordx4 v[180:183], v3, s[4:7], 0 offen sc1
    s_mov_b32 s43, 1
notearly_9:
    v_mov_b32 v91, 512
    ds_read_b128 v[44:47], v91
    ds_read_b128 v[48:51], v91 offset:16
    s_and_b32 s67, s28, 1
    s_lshr_b32 s70, s28, 1
    s_mul_i32 s71, s67, 3072
    s_lshl_b32 s72, s70, 10
    s_add_u32 s72, s72, s71
    s_nop 0
    s_add_u32 s72, s72, 13056
    s_add_u32 s71, s71, 15104
    v_lshl_add_u32 v90, v1, 4, s72
    v_lshl_add_u32 v91, v1, 4, s71
    ds_read_b128 v[96:99], v90 offset:0
    ds_read_b128 v[100:103], v90 offset:15504
    ds_read_b128 v[104:107], v90 offset:31008
    ds_read_b128 v[108:111], v90 offset:46512
    ds_read_b128 v[112:115], v91 offset:0
    ds_read_b128 v[116:119], v91 offset:15504
    ds_read_b128 v[120:123], v91 offset:31008
    ds_read_b128 v[124:127], v91 offset:46512
    v_mov_b32 v128, 0
    v_mov_b32 v129, 0
    v_mov_b32 v130, 0
    v_mov_b32 v131, 0
    v_and_b32_e64 v132, 7, v1
    v_mul_u32_u24 v132, 4160, v132
    v_bfe_u32 v133, v1, 3, 1
    v_lshl_add_u32 v132, v133, 4, v132
    v_add_u32 v132, 82688, v132
    ds_write_b128 v132, v[128:131] offset:4096
    v_lshrrev_b32 v92, 4, v1
    v_lshlrev_b32 v92, 7, v92
    v_and_b32_e64 v93, 15, v1
    v_lshl_add_u32 v92, v93, 1, v92
    s_mul_i32 s71, s67, 1600
    s_add_u32 s71, s71, 640
    v_add_u32 v93, s71, v92
    s_lshl_b32 s72, s70, 9
    v_add_u32 v92, s72, v93
    s_waitcnt lgkmcnt(9)
    v_pk_add_f32 v[44:45], v[44:45], v[46:47]
    v_pk_add_f32 v[48:49], v[48:49], v[50:51]
    v_add_f32 v44, v44, v45
    v_add_f32 v45, v48, v49
    s_cmp_eq_u32 s67, 0
    s_cselect_b64 vcc, -1, 0
    v_pk_mul_f32 v[54:55], v[54:55], v[44:45]
    v_cndmask_b32 v46, v45, v44, vcc
    v_pk_add_f32 v[54:55], v[54:55], v[54:55]
    v_rcp_f32_e64 v46, v46
    s_waitcnt lgkmcnt(5)
    v_pk_add_f32 v[96:97], v[96:97], v[100:101]
    v_pk_add_f32 v[104:105], v[104:105], v[108:109]
    v_pk_add_f32 v[98:99], v[98:99], v[102:103]
    v_pk_add_f32 v[106:107], v[106:107], v[110:111]
    v_pk_add_f32 v[96:97], v[96:97], v[104:105]
    v_pk_add_f32 v[98:99], v[98:99], v[106:107]
    v_pk_mul_f32 v[96:97], v[96:97], v[46:47] op_sel:[0,0] op_sel_hi:[1,0]
    v_pk_mul_f32 v[98:99], v[98:99], v[46:47] op_sel:[0,0] op_sel_hi:[1,0]
    v_cvt_pk_f16_f32 v100, v96, v97
    v_cvt_pk_f16_f32 v101, v98, v99
    ds_write_b16 v92, v100 offset:0
    ds_write_b16_d16_hi v92, v100 offset:32
    ds_write_b16 v92, v101 offset:64
    ds_write_b16_d16_hi v92, v101 offset:96
    s_waitcnt lgkmcnt(5)
    s_nop 0
    v_pk_add_f32 v[112:113], v[112:113], v[116:117]
    v_pk_add_f32 v[120:121], v[120:121], v[124:125]
    v_pk_add_f32 v[114:115], v[114:115], v[118:119]
    v_pk_add_f32 v[122:123], v[122:123], v[126:127]
    v_pk_add_f32 v[112:113], v[112:113], v[120:121]
    v_pk_add_f32 v[114:115], v[114:115], v[122:123]
    v_pk_mul_f32 v[112:113], v[112:113], v[46:47] op_sel:[0,0] op_sel_hi:[1,0]
    v_pk_mul_f32 v[114:115], v[114:115], v[46:47] op_sel:[0,0] op_sel_hi:[1,0]
    v_cvt_pk_f16_f32 v116, v112, v113
    v_cvt_pk_f16_f32 v117, v114, v115
    ds_write_b16 v93, v116 offset:1024
    ds_write_b16_d16_hi v93, v116 offset:1056
    ds_write_b16 v93, v117 offset:1088
    ds_write_b16_d16_hi v93, v117 offset:1120
    v_and_b32 v136, 0xffff, v160
    v_lshrrev_b32_e64 v137, 16, v160
    v_and_b32 v138, 0xffff, v161
    v_lshrrev_b32_e64 v139, 16, v161
    v_and_b32 v140, 0xffff, v162
    v_lshrrev_b32_e64 v141, 16, v162
    v_and_b32 v142, 0xffff, v163
    v_lshrrev_b32_e64 v143, 16, v163
    v_and_b32 v144, 0xffff, v164
    v_lshrrev_b32_e64 v145, 16, v164
    v_and_b32 v146, 0xffff, v165
    s_waitcnt lgkmcnt(0)
    s_barrier
    s_lshr_b32 s66, s28, 1
    s_and_b32 s67, s28, 1
    v_and_b32 v2, 7, v1
    v_sub_u32 v2, 7, v2
    v_lshrrev_b32 v5, 2, v2
    v_and_b32 v2, 3, v2
    v_mul_u32_u24 v2, 4160, v2
    v_lshl_add_u32 v2, v5, 3, v2
    v_lshrrev_b32_e64 v3, 4, v1
    v_bfe_u32 v4, v1, 3, 1
    v_sub_u32_e64 v4, v3, v4
    v_lshl_add_u32 v2, v4, 4, v2
    s_mul_i32 s70, s66, 16640
    s_lshl_b32 s71, s67, 8
    s_sub_u32 s70, s70, s71
    s_add_u32 s70, s70, 82960
    v_add_u32 v48, s70, v2
    v_and_b32 v2, 15, v1
    v_lshlrev_b32_e64 v2, 5, v2
    v_lshl_add_u32 v2, v3, 4, v2
    s_mul_i32 s70, s66, 4608
    s_sub_u32 s70, s70, s71
    s_add_u32 s70, s70, 4128
    v_add_u32 v49, s70, v2
    v_lshlrev_b32_e64 v111, 4, v0
    v_add_u32 v111, 82688, v111
    ds_read_u16 v96, v136 offset:640
    ds_read_u16 v97, v137 offset:640
    ds_read_u16 v98, v138 offset:640
    ds_read_u16 v99, v139 offset:640
    ds_read_u16 v100, v140 offset:640
    ds_read_u16 v101, v141 offset:640
    ds_read_u16 v102, v142 offset:640
    ds_read_u16 v103, v143 offset:640
    ds_read_u16 v104, v144 offset:640
    ds_read_u16 v105, v145 offset:640
    ds_read_u16 v106, v146 offset:640
    ds_read_u16 v112, v136 offset:2240
    ds_read_u16 v113, v137 offset:2240
    ds_read_u16 v114, v138 offset:2240
    ds_read_u16 v115, v139 offset:2240
    ds_read_u16 v116, v140 offset:2240
    ds_read_u16 v117, v141 offset:2240
    ds_read_u16 v118, v142 offset:2240
    ds_read_u16 v119, v143 offset:2240
    ds_read_u16 v120, v144 offset:2240
    ds_read_u16 v121, v145 offset:2240
    ds_read_u16 v122, v146 offset:2240
    s_waitcnt lgkmcnt(11)
    s_nop 0
    v_lshl_or_b32 v56, v97, 16, v96
    v_lshl_or_b32 v64, v98, 16, v97
    v_lshl_or_b32 v60, v99, 16, v98
    v_lshl_or_b32 v68, v100, 16, v99
    v_lshl_or_b32 v57, v99, 16, v98
    v_lshl_or_b32 v65, v100, 16, v99
    v_lshl_or_b32 v61, v101, 16, v100
    v_lshl_or_b32 v69, v102, 16, v101
    v_lshl_or_b32 v58, v101, 16, v100
    v_lshl_or_b32 v66, v102, 16, v101
    v_lshl_or_b32 v62, v103, 16, v102
    v_lshl_or_b32 v70, v104, 16, v103
    v_lshl_or_b32 v59, v103, 16, v102
    v_lshl_or_b32 v67, v104, 16, v103
    v_lshl_or_b32 v63, v105, 16, v104
    v_lshl_or_b32 v71, v106, 16, v105
    ds_write_b128 v111, v[56:59] offset:0
    ds_write_b128 v111, v[64:67] offset:4160
    ds_write_b128 v111, v[60:63] offset:8320
    ds_write_b128 v111, v[68:71] offset:12480
    s_waitcnt lgkmcnt(4)
    s_nop 0
    v_lshl_or_b32 v16, v113, 16, v112
    v_lshl_or_b32 v24, v114, 16, v113
    v_lshl_or_b32 v20, v115, 16, v114
    v_lshl_or_b32 v28, v116, 16, v115
    v_lshl_or_b32 v17, v115, 16, v114
    v_lshl_or_b32 v25, v116, 16, v115
    v_lshl_or_b32 v21, v117, 16, v116
    v_lshl_or_b32 v29, v118, 16, v117
    v_lshl_or_b32 v18, v117, 16, v116
    v_lshl_or_b32 v26, v118, 16, v117
    v_lshl_or_b32 v22, v119, 16, v118
    v_lshl_or_b32 v30, v120, 16, v119
    v_lshl_or_b32 v19, v119, 16, v118
    v_lshl_or_b32 v27, v120, 16, v119
    v_lshl_or_b32 v23, v121, 16, v120
    v_lshl_or_b32 v31, v122, 16, v121
    ds_write_b128 v111, v[16:19] offset:16640
    ds_write_b128 v111, v[24:27] offset:20800
    ds_write_b128 v111, v[20:23] offset:24960
    ds_write_b128 v111, v[28:31] offset:29120
    s_cmp_lg_u32 s43, 0
    s_cbranch_scc1 haveu_10
    s_mov_b32 s97, 0
fpoll_11:
    buffer_load_dword v234, v233, s[4:7], 0 offen sc1
    s_waitcnt vmcnt(0)
    v_cmp_ne_u32 vcc, s96, v234
    s_nop 3
    s_cbranch_vccz fdone_12
    s_add_u32 s97, s97, 1
    s_cmp_lt_u32 s97, 4000
    s_cbranch_scc1 fpoll_11
fdone_12:
    s_lshl_b32 s66, s32, 4
    s_add_u32 s66, s66, 10485760
    v_mul_u32_u24 v2, 7168, v0
    v_add_u32_e64 v2, s66, v2
    v_add_u32 v3, 3584, v2
    buffer_load_dwordx4 v[176:179], v2, s[4:7], 0 offen sc1
    buffer_load_dwordx4 v[180:183], v3, s[4:7], 0 offen sc1
haveu_10:
    v_lshlrev_b32 v2, 4, v0
    s_waitcnt vmcnt(0)
    ds_write_b128 v2, v[176:179] offset:4352
    ds_write_b128 v2, v[180:183] offset:8960
    s_waitcnt lgkmcnt(0)
    s_barrier
    s_cmp_lg_u32 s2, 0
    s_cbranch_scc1 noep_13
    v_mov_b32 v2, 36864
    v_mov_b32 v3, s96
    s_mov_b64 exec, 1
    buffer_store_dword v3, v2, s[4:7], 0 offen sc1
    s_mov_b64 exec, -1
noep_13:
    s_lshl_b32 s66, s34, 3
    s_lshl_b32 s70, s28, 1
    s_add_u32 s66, s66, s70
    s_mul_i32 s66, s66, 7168
    s_mul_i32 s70, s33, 896
    s_add_u32 s66, s66, s70
    s_add_u32 s66, s66, 6291456
    v_lshl_add_u32 v4, v1, 4, s66
    v_mov_b32_e64 v6, 1073741824
    v_cmp_gt_u32 vcc, 56, v1
    s_nop 1
    v_cndmask_b32 v4, v6, v4, vcc
    v_add_u32 v5, 7168, v4
    buffer_store_dwordx4 v[216:219], v4, s[4:7], 0 offen sc1
    buffer_store_dwordx4 v[216:219], v5, s[4:7], 0 offen sc1
    ds_read_b128 v[96:99], v49 offset:192
    ds_read_b64 v[64:65], v48 offset:3776
    ds_read_b64 v[66:67], v48 offset:3784
    ds_read_b128 v[100:103], v49 offset:704
    ds_read_b64 v[68:69], v48 offset:3264
    ds_read_b64 v[70:71], v48 offset:3272
    ds_read_b128 v[104:107], v49 offset:1216
    ds_read_b64 v[72:73], v48 offset:2752
    ds_read_b64 v[74:75], v48 offset:2760
    ds_read_b128 v[108:111], v49 offset:1728
    ds_read_b64 v[76:77], v48 offset:2240
    ds_read_b64 v[78:79], v48 offset:2248
    ds_read_b128 v[112:115], v49 offset:2240
    ds_read_b64 v[80:81], v48 offset:1728
    ds_read_b64 v[82:83], v48 offset:1736
    ds_read_b128 v[116:119], v49 offset:2752
    ds_read_b64 v[84:85], v48 offset:1216
    ds_read_b64 v[86:87], v48 offset:1224
    ds_read_b128 v[120:123], v49 offset:3264
    ds_read_b64 v[88:89], v48 offset:704
    ds_read_b64 v[90:91], v48 offset:712
    ds_read_b128 v[124:127], v49 offset:3776
    ds_read_b64 v[92:93], v48 offset:192
    ds_read_b64 v[94:95], v48 offset:200
    s_waitcnt lgkmcnt(0)
    s_nop 0
    v_mfma_f32_16x16x32_f16 v[16:19], v[64:67], v[96:99], 0
    ds_read_b128 v[160:163], v49 offset:128
    v_mfma_f32_16x16x32_f16 v[20:23], v[64:67], v[100:103], 0
    ds_read_b64 v[128:129], v48 offset:3712
    v_mfma_f32_16x16x32_f16 v[24:27], v[64:67], v[104:107], 0
    s_add_u32 s70, s38, 229376
    s_cmp_ge_u32 s70, 1835008
    s_cselect_b32 s71, 1835008, 0
    s_sub_u32 s70, s70, s71
    s_add_u32 m0, s50, 0
    s_nop 0
    s_nop 0
    buffer_load_dwordx4 v224, s[12:15], s70 offen offset:0 lds
    v_mfma_f32_16x16x32_f16 v[28:31], v[64:67], v[108:111], 0
    ds_read_b64 v[130:131], v48 offset:3720
    v_mfma_f32_16x16x32_f16 v[32:35], v[64:67], v[112:115], 0
    ds_read_b128 v[164:167], v49 offset:640
    v_mfma_f32_16x16x32_f16 v[36:39], v[64:67], v[116:119], 0
    ds_read_b64 v[132:133], v48 offset:3200
    v_mfma_f32_16x16x32_f16 v[40:43], v[64:67], v[120:123], 0
    v_mfma_f32_16x16x32_f16 v[44:47], v[64:67], v[124:127], 0
    ds_read_b64 v[134:135], v48 offset:3208
    v_mfma_f32_16x16x32_f16 v[20:23], v[68:71], v[96:99], v[20:23]
    ds_read_b128 v[168:171], v49 offset:1152
    v_mfma_f32_16x16x32_f16 v[24:27], v[68:71], v[100:103], v[24:27]
    ds_read_b64 v[136:137], v48 offset:2688
    v_mfma_f32_16x16x32_f16 v[28:31], v[68:71], v[104:107], v[28:31]
    buffer_load_dwordx4 v225, s[12:15], s70 offen offset:1024 lds
    v_mfma_f32_16x16x32_f16 v[32:35], v[68:71], v[108:111], v[32:35]
    ds_read_b64 v[138:139], v48 offset:2696
    v_mfma_f32_16x16x32_f16 v[36:39], v[68:71], v[112:115], v[36:39]
    ds_read_b128 v[172:175], v49 offset:1664
    v_mfma_f32_16x16x32_f16 v[40:43], v[68:71], v[116:119], v[40:43]
    ds_read_b64 v[140:141], v48 offset:2176
    v_mfma_f32_16x16x32_f16 v[44:47], v[68:71], v[120:123], v[44:47]
    v_mfma_f32_16x16x32_f16 v[24:27], v[72:75], v[96:99], v[24:27]
    ds_read_b64 v[142:143], v48 offset:2184
    v_mfma_f32_16x16x32_f16 v[28:31], v[72:75], v[100:103], v[28:31]
    ds_read_b128 v[176:179], v49 offset:2176
    v_mfma_f32_16x16x32_f16 v[32:35], v[72:75], v[104:107], v[32:35]
    ds_read_b64 v[144:145], v48 offset:1664
    v_mfma_f32_16x16x32_f16 v[36:39], v[72:75], v[108:111], v[36:39]
    buffer_load_dwordx4 v226, s[12:15], s70 offen offset:2048 lds
    v_mfma_f32_16x16x32_f16 v[40:43], v[72:75], v[112:115], v[40:43]
    ds_read_b64 v[146:147], v48 offset:1672
    v_mfma_f32_16x16x32_f16 v[44:47], v[72:75], v[116:119], v[44:47]
    ds_read_b128 v[180:183], v49 offset:2688
    v_mfma_f32_16x16x32_f16 v[28:31], v[76:79], v[96:99], v[28:31]
    ds_read_b64 v[148:149], v48 offset:1152
    v_mfma_f32_16x16x32_f16 v[32:35], v[76:79], v[100:103], v[32:35]
    v_mfma_f32_16x16x32_f16 v[36:39], v[76:79], v[104:107], v[36:39]
    ds_read_b64 v[150:151], v48 offset:1160
    v_mfma_f32_16x16x32_f16 v[40:43], v[76:79], v[108:111], v[40:43]
    ds_read_b128 v[184:187], v49 offset:3200
    v_mfma_f32_16x16x32_f16 v[44:47], v[76:79], v[112:115], v[44:47]
    ds_read_b64 v[152:153], v48 offset:640
    v_mfma_f32_16x16x32_f16 v[32:35], v[80:83], v[96:99], v[32:35]
    buffer_load_dwordx4 v227, s[12:15], s70 offen offset:3072 lds
    v_mfma_f32_16x16x32_f16 v[36:39], v[80:83], v[100:103], v[36:39]
    ds_read_b64 v[154:155], v48 offset:648
    v_mfma_f32_16x16x32_f16 v[40:43], v[80:83], v[104:107], v[40:43]
    ds_read_b128 v[188:191], v49 offset:3712
    v_mfma_f32_16x16x32_f16 v[44:47], v[80:83], v[108:111], v[44:47]
    ds_read_b64 v[156:157], v48 offset:128
    v_mfma_f32_16x16x32_f16 v[36:39], v[84:87], v[96:99], v[36:39]
    v_mfma_f32_16x16x32_f16 v[40:43], v[84:87], v[100:103], v[40:43]
    ds_read_b64 v[158:159], v48 offset:136
    v_mfma_f32_16x16x32_f16 v[44:47], v[84:87], v[104:107], v[44:47]
    v_mfma_f32_16x16x32_f16 v[40:43], v[88:91], v[96:99], v[40:43]
    v_mfma_f32_16x16x32_f16 v[44:47], v[88:91], v[100:103], v[44:47]
    s_add_u32 s70, s38, 344064
    s_cmp_ge_u32 s70, 1835008
    s_cselect_b32 s71, 1835008, 0
    s_sub_u32 s70, s70, s71
    s_add_u32 m0, s50, 4096
    s_nop 0
    buffer_load_dwordx4 v224, s[12:15], s70 offen offset:0 lds
    v_mfma_f32_16x16x32_f16 v[44:47], v[92:95], v[96:99], v[44:47]
    s_waitcnt lgkmcnt(0)
    s_nop 0
    v_mfma_f32_16x16x32_f16 v[16:19], v[128:131], v[160:163], v[16:19]
    ds_read_b128 v[96:99], v49 offset:64
    v_mfma_f32_16x16x32_f16 v[20:23], v[128:131], v[164:167], v[20:23]
    ds_read_b64 v[64:65], v48 offset:3648
    v_mfma_f32_16x16x32_f16 v[24:27], v[128:131], v[168:171], v[24:27]
    v_mfma_f32_16x16x32_f16 v[28:31], v[128:131], v[172:175], v[28:31]
    ds_read_b64 v[66:67], v48 offset:3656
    v_mfma_f32_16x16x32_f16 v[32:35], v[128:131], v[176:179], v[32:35]
    ds_read_b128 v[100:103], v49 offset:576
    v_mfma_f32_16x16x32_f16 v[36:39], v[128:131], v[180:183], v[36:39]
    ds_read_b64 v[68:69], v48 offset:3136
    v_mfma_f32_16x16x32_f16 v[40:43], v[128:131], v[184:187], v[40:43]
    buffer_load_dwordx4 v225, s[12:15], s70 offen offset:1024 lds
    v_mfma_f32_16x16x32_f16 v[44:47], v[128:131], v[188:191], v[44:47]
    ds_read_b64 v[70:71], v48 offset:3144
    v_mfma_f32_16x16x32_f16 v[20:23], v[132:135], v[160:163], v[20:23]
    ds_read_b128 v[104:107], v49 offset:1088
    v_mfma_f32_16x16x32_f16 v[24:27], v[132:135], v[164:167], v[24:27]
    ds_read_b64 v[72:73], v48 offset:2624
    v_mfma_f32_16x16x32_f16 v[28:31], v[132:135], v[168:171], v[28:31]
    v_mfma_f32_16x16x32_f16 v[32:35], v[132:135], v[172:175], v[32:35]
    ds_read_b64 v[74:75], v48 offset:2632
    v_mfma_f32_16x16x32_f16 v[36:39], v[132:135], v[176:179], v[36:39]
    ds_read_b128 v[108:111], v49 offset:1600
    v_mfma_f32_16x16x32_f16 v[40:43], v[132:135], v[180:183], v[40:43]
    ds_read_b64 v[76:77], v48 offset:2112
    v_mfma_f32_16x16x32_f16 v[44:47], v[132:135], v[184:187], v[44:47]
    buffer_load_dwordx4 v226, s[12:15], s70 offen offset:2048 lds
    v_mfma_f32_16x16x32_f16 v[24:27], v[136:139], v[160:163], v[24:27]
    ds_read_b64 v[78:79], v48 offset:2120
    v_mfma_f32_16x16x32_f16 v[28:31], v[136:139], v[164:167], v[28:31]
    ds_read_b128 v[112:115], v49 offset:2112
    v_mfma_f32_16x16x32_f16 v[32:35], v[136:139], v[168:171], v[32:35]
    ds_read_b64 v[80:81], v48 offset:1600
    v_mfma_f32_16x16x32_f16 v[36:39], v[136:139], v[172:175], v[36:39]
    v_mfma_f32_16x16x32_f16 v[40:43], v[136:139], v[176:179], v[40:43]
    ds_read_b64 v[82:83], v48 offset:1608
    v_mfma_f32_16x16x32_f16 v[44:47], v[136:139], v[180:183], v[44:47]
    ds_read_b128 v[116:119], v49 offset:2624
    v_mfma_f32_16x16x32_f16 v[28:31], v[140:143], v[160:163], v[28:31]
    ds_read_b64 v[84:85], v48 offset:1088
    v_mfma_f32_16x16x32_f16 v[32:35], v[140:143], v[164:167], v[32:35]
    buffer_load_dwordx4 v227, s[12:15], s70 offen offset:3072 lds
    v_mfma_f32_16x16x32_f16 v[36:39], v[140:143], v[168:171], v[36:39]
    ds_read_b64 v[86:87], v48 offset:1096
    v_mfma_f32_16x16x32_f16 v[40:43], v[140:143], v[172:175], v[40:43]
    ds_read_b128 v[120:123], v49 offset:3136
    v_mfma_f32_16x16x32_f16 v[44:47], v[140:143], v[176:179], v[44:47]
    ds_read_b64 v[88:89], v48 offset:576
    v_mfma_f32_16x16x32_f16 v[32:35], v[144:147], v[160:163], v[32:35]
    v_mfma_f32_16x16x32_f16 v[36:39], v[144:147], v[164:167], v[36:39]
    ds_read_b64 v[90:91], v48 offset:584
    v_mfma_f32_16x16x32_f16 v[40:43], v[144:147], v[168:171], v[40:43]
    ds_read_b128 v[124:127], v49 offset:3648
    v_mfma_f32_16x16x32_f16 v[44:47], v[144:147], v[172:175], v[44:47]
    ds_read_b64 v[92:93], v48 offset:64
    v_mfma_f32_16x16x32_f16 v[36:39], v[148:151], v[160:163], v[36:39]
    s_add_u32 s70, s38, 458752
    s_cmp_ge_u32 s70, 1835008
    s_cselect_b32 s71, 1835008, 0
    s_sub_u32 s70, s70, s71
    s_add_u32 m0, s50, 8192
    s_nop 0
    buffer_load_dwordx4 v224, s[12:15], s70 offen offset:0 lds
    v_mfma_f32_16x16x32_f16 v[40:43], v[148:151], v[164:167], v[40:43]
    ds_read_b64 v[94:95], v48 offset:72
    v_mfma_f32_16x16x32_f16 v[44:47], v[148:151], v[168:171], v[44:47]
    v_mfma_f32_16x16x32_f16 v[40:43], v[152:155], v[160:163], v[40:43]
    v_mfma_f32_16x16x32_f16 v[44:47], v[152:155], v[164:167], v[44:47]
    v_mfma_f32_16x16x32_f16 v[44:47], v[156:159], v[160:163], v[44:47]
    s_waitcnt lgkmcnt(0)
    s_nop 0
    v_mfma_f32_16x16x32_f16 v[16:19], v[64:67], v[96:99], v[16:19]
    ds_read_b128 v[160:163], v49 offset:0
    v_mfma_f32_16x16x32_f16 v[20:23], v[64:67], v[100:103], v[20:23]
    ds_read_b64 v[128:129], v48 offset:3584
    v_mfma_f32_16x16x32_f16 v[24:27], v[64:67], v[104:107], v[24:27]
    buffer_load_dwordx4 v225, s[12:15], s70 offen offset:1024 lds
    v_mfma_f32_16x16x32_f16 v[28:31], v[64:67], v[108:111], v[28:31]
    ds_read_b64 v[130:131], v48 offset:3592
    v_mfma_f32_16x16x32_f16 v[32:35], v[64:67], v[112:115], v[32:35]
    ds_read_b128 v[164:167], v49 offset:512
    v_mfma_f32_16x16x32_f16 v[36:39], v[64:67], v[116:119], v[36:39]
    ds_read_b64 v[132:133], v48 offset:3072
    v_mfma_f32_16x16x32_f16 v[40:43], v[64:67], v[120:123], v[40:43]
    v_mfma_f32_16x16x32_f16 v[44:47], v[64:67], v[124:127], v[44:47]
    ds_read_b64 v[134:135], v48 offset:3080
    v_mfma_f32_16x16x32_f16 v[20:23], v[68:71], v[96:99], v[20:23]
    ds_read_b128 v[168:171], v49 offset:1024
    v_mfma_f32_16x16x32_f16 v[24:27], v[68:71], v[100:103], v[24:27]
    ds_read_b64 v[136:137], v48 offset:2560
    v_mfma_f32_16x16x32_f16 v[28:31], v[68:71], v[104:107], v[28:31]
    buffer_load_dwordx4 v226, s[12:15], s70 offen offset:2048 lds
    v_mfma_f32_16x16x32_f16 v[32:35], v[68:71], v[108:111], v[32:35]
    ds_read_b64 v[138:139], v48 offset:2568
    v_mfma_f32_16x16x32_f16 v[36:39], v[68:71], v[112:115], v[36:39]
    ds_read_b128 v[172:175], v49 offset:1536
    v_mfma_f32_16x16x32_f16 v[40:43], v[68:71], v[116:119], v[40:43]
    ds_read_b64 v[140:141], v48 offset:2048
    v_mfma_f32_16x16x32_f16 v[44:47], v[68:71], v[120:123], v[44:47]
    v_mfma_f32_16x16x32_f16 v[24:27], v[72:75], v[96:99], v[24:27]
    ds_read_b64 v[142:143], v48 offset:2056
    v_mfma_f32_16x16x32_f16 v[28:31], v[72:75], v[100:103], v[28:31]
    ds_read_b128 v[176:179], v49 offset:2048
    v_mfma_f32_16x16x32_f16 v[32:35], v[72:75], v[104:107], v[32:35]
    ds_read_b64 v[144:145], v48 offset:1536
    v_mfma_f32_16x16x32_f16 v[36:39], v[72:75], v[108:111], v[36:39]
    buffer_load_dwordx4 v227, s[12:15], s70 offen offset:3072 lds
    v_mfma_f32_16x16x32_f16 v[40:43], v[72:75], v[112:115], v[40:43]
    ds_read_b64 v[146:147], v48 offset:1544
    v_mfma_f32_16x16x32_f16 v[44:47], v[72:75], v[116:119], v[44:47]
    ds_read_b128 v[180:183], v49 offset:2560
    v_mfma_f32_16x16x32_f16 v[28:31], v[76:79], v[96:99], v[28:31]
    ds_read_b64 v[148:149], v48 offset:1024
    v_mfma_f32_16x16x32_f16 v[32:35], v[76:79], v[100:103], v[32:35]
    v_mfma_f32_16x16x32_f16 v[36:39], v[76:79], v[104:107], v[36:39]
    ds_read_b64 v[150:151], v48 offset:1032
    v_mfma_f32_16x16x32_f16 v[40:43], v[76:79], v[108:111], v[40:43]
    ds_read_b128 v[184:187], v49 offset:3072
    v_mfma_f32_16x16x32_f16 v[44:47], v[76:79], v[112:115], v[44:47]
    ds_read_b64 v[152:153], v48 offset:512
    v_mfma_f32_16x16x32_f16 v[32:35], v[80:83], v[96:99], v[32:35]
    s_add_u32 s70, s38, 573440
    s_cmp_ge_u32 s70, 1835008
    s_cselect_b32 s71, 1835008, 0
    s_sub_u32 s70, s70, s71
    s_add_u32 m0, s50, 12288
    s_nop 0
    buffer_load_dwordx4 v224, s[12:15], s70 offen offset:0 lds
    v_mfma_f32_16x16x32_f16 v[36:39], v[80:83], v[100:103], v[36:39]
    ds_read_b64 v[154:155], v48 offset:520
    v_mfma_f32_16x16x32_f16 v[40:43], v[80:83], v[104:107], v[40:43]
    ds_read_b128 v[188:191], v49 offset:3584
    v_mfma_f32_16x16x32_f16 v[44:47], v[80:83], v[108:111], v[44:47]
    ds_read_b64 v[156:157], v48 offset:0
    v_mfma_f32_16x16x32_f16 v[36:39], v[84:87], v[96:99], v[36:39]
    v_mfma_f32_16x16x32_f16 v[40:43], v[84:87], v[100:103], v[40:43]
    ds_read_b64 v[158:159], v48 offset:8
    v_mfma_f32_16x16x32_f16 v[44:47], v[84:87], v[104:107], v[44:47]
    v_mfma_f32_16x16x32_f16 v[40:43], v[88:91], v[96:99], v[40:43]
    v_mfma_f32_16x16x32_f16 v[44:47], v[88:91], v[100:103], v[44:47]
    buffer_load_dwordx4 v225, s[12:15], s70 offen offset:1024 lds
    v_mfma_f32_16x16x32_f16 v[44:47], v[92:95], v[96:99], v[44:47]
    s_waitcnt lgkmcnt(0)
    s_barrier
    v_mfma_f32_16x16x32_f16 v[16:19], v[128:131], v[160:163], v[16:19]
    v_mfma_f32_16x16x32_f16 v[20:23], v[128:131], v[164:167], v[20:23]
    v_mfma_f32_16x16x32_f16 v[24:27], v[128:131], v[168:171], v[24:27]
    v_mfma_f32_16x16x32_f16 v[28:31], v[128:131], v[172:175], v[28:31]
    v_mfma_f32_16x16x32_f16 v[32:35], v[128:131], v[176:179], v[32:35]
    v_mfma_f32_16x16x32_f16 v[36:39], v[128:131], v[180:183], v[36:39]
    v_mfma_f32_16x16x32_f16 v[40:43], v[128:131], v[184:187], v[40:43]
    buffer_load_dwordx4 v226, s[12:15], s70 offen offset:2048 lds
    v_mfma_f32_16x16x32_f16 v[44:47], v[128:131], v[188:191], v[44:47]
    v_mfma_f32_16x16x32_f16 v[20:23], v[132:135], v[160:163], v[20:23]
    v_mfma_f32_16x16x32_f16 v[24:27], v[132:135], v[164:167], v[24:27]
    v_mfma_f32_16x16x32_f16 v[28:31], v[132:135], v[168:171], v[28:31]
    v_mfma_f32_16x16x32_f16 v[32:35], v[132:135], v[172:175], v[32:35]
    v_mfma_f32_16x16x32_f16 v[36:39], v[132:135], v[176:179], v[36:39]
    v_mfma_f32_16x16x32_f16 v[40:43], v[132:135], v[180:183], v[40:43]
    v_mfma_f32_16x16x32_f16 v[44:47], v[132:135], v[184:187], v[44:47]
    buffer_load_dwordx4 v227, s[12:15], s70 offen offset:3072 lds
    v_mfma_f32_16x16x32_f16 v[24:27], v[136:139], v[160:163], v[24:27]
    v_mfma_f32_16x16x32_f16 v[28:31], v[136:139], v[164:167], v[28:31]
    v_mfma_f32_16x16x32_f16 v[32:35], v[136:139], v[168:171], v[32:35]
    v_mfma_f32_16x16x32_f16 v[36:39], v[136:139], v[172:175], v[36:39]
    v_mfma_f32_16x16x32_f16 v[40:43], v[136:139], v[176:179], v[40:43]
    v_mfma_f32_16x16x32_f16 v[44:47], v[136:139], v[180:183], v[44:47]
    v_mfma_f32_16x16x32_f16 v[28:31], v[140:143], v[160:163], v[28:31]
    v_mfma_f32_16x16x32_f16 v[32:35], v[140:143], v[164:167], v[32:35]
    v_mfma_f32_16x16x32_f16 v[36:39], v[140:143], v[168:171], v[36:39]
    v_mfma_f32_16x16x32_f16 v[40:43], v[140:143], v[172:175], v[40:43]
    v_mfma_f32_16x16x32_f16 v[44:47], v[140:143], v[176:179], v[44:47]
    v_mfma_f32_16x16x32_f16 v[32:35], v[144:147], v[160:163], v[32:35]
    v_mfma_f32_16x16x32_f16 v[36:39], v[144:147], v[164:167], v[36:39]
    v_mfma_f32_16x16x32_f16 v[40:43], v[144:147], v[168:171], v[40:43]
    v_mfma_f32_16x16x32_f16 v[44:47], v[144:147], v[172:175], v[44:47]
    v_mfma_f32_16x16x32_f16 v[36:39], v[148:151], v[160:163], v[36:39]
    v_mfma_f32_16x16x32_f16 v[40:43], v[148:151], v[164:167], v[40:43]
    v_mfma_f32_16x16x32_f16 v[44:47], v[148:151], v[168:171], v[44:47]
    v_mfma_f32_16x16x32_f16 v[40:43], v[152:155], v[160:163], v[40:43]
    v_mfma_f32_16x16x32_f16 v[44:47], v[152:155], v[164:167], v[44:47]
    v_mfma_f32_16x16x32_f16 v[44:47], v[156:159], v[160:163], v[44:47]
    v_and_b32 v2, 15, v1
    v_lshlrev_b32 v2, 4, v2
    v_lshrrev_b32_e64 v3, 4, v1
    v_mul_u32_u24 v3, 320, v3
    v_add_u32_e64 v2, v2, v3
    s_mul_i32 s70, s28, 10240
    s_add_u32 s70, s70, 82688
    v_add_u32_e64 v2, s70, v2
    ds_write_b128 v2, v[16:19] offset:0
    ds_write_b128 v2, v[20:23] offset:1280
    ds_write_b128 v2, v[24:27] offset:2560
    ds_write_b128 v2, v[28:31] offset:3840
    ds_write_b128 v2, v[32:35] offset:5120
    ds_write_b128 v2, v[36:39] offset:6400
    ds_write_b128 v2, v[40:43] offset:7680
    ds_write_b128 v2, v[44:47] offset:8960
    v_lshrrev_b32 v2, 2, v1
    v_lshlrev_b32 v2, 4, v2
    v_and_b32_e64 v3, 3, v1
    v_mul_u32_u24 v3, 320, v3
    v_add_u32 v2, v2, v3
    s_lshl_b32 s70, s28, 1
    s_mul_i32 s71, s70, 1280
    s_add_u32 s71, s71, 82688
    v_add_u32 v2, s71, v2
    s_lshl_b32 s71, s70, 9
    s_add_u32 s71, s71, 4352
    v_lshl_add_u32 v3, v1, 3, s71
    s_mul_i32 s71, s32, 8448
    s_lshl_b32 s72, s70, 10
    s_add_u32 s71, s71, s72
    s_add_u32 s71, s71, 65536
    v_lshl_add_u32 v4, v1, 4, s71
    s_lshl_b32 s72, s69, 16
    s_and_b32 s73, s69, 0xffff0000
    v_mov_b32 v56, s72
    v_mov_b32_e64 v57, s73
    s_waitcnt lgkmcnt(0) vmcnt(16)
    s_barrier
    ds_read_b128 v[64:67], v2 offset:0
    ds_read_b128 v[68:71], v2 offset:10240
    ds_read_b128 v[72:75], v2 offset:20480
    ds_read_b128 v[76:79], v2 offset:30720
    ds_read_b64 v[80:81], v3 offset:0
    ds_read_b64 v[82:83], v3 offset:4608
    ds_read_b128 v[96:99], v2 offset:1280
    ds_read_b128 v[100:103], v2 offset:11520
    ds_read_b128 v[104:107], v2 offset:21760
    ds_read_b128 v[108:111], v2 offset:32000
    ds_read_b64 v[112:113], v3 offset:512
    ds_read_b64 v[114:115], v3 offset:5120
    s_waitcnt lgkmcnt(6)
    s_nop 0
    v_pk_add_f32 v[64:65], v[64:65], v[68:69]
    v_pk_add_f32 v[66:67], v[66:67], v[70:71]
    v_fma_mix_f32 v128, v80, v56, 0 op_sel:[0,0,0] op_sel_hi:[1,0,0]
    v_fma_mix_f32 v129, v80, v56, 0 op_sel:[1,0,0] op_sel_hi:[1,0,0]
    v_fma_mix_f32 v130, v81, v56, 0 op_sel:[0,0,0] op_sel_hi:[1,0,0]
    v_fma_mix_f32 v131, v81, v56, 0 op_sel:[1,0,0] op_sel_hi:[1,0,0]
    v_pk_mul_f32 v[64:65], v[64:65], v[54:55] op_sel:[0,0] op_sel_hi:[1,0]
    v_pk_mul_f32 v[66:67], v[66:67], v[54:55] op_sel:[0,0] op_sel_hi:[1,0]
    v_cvt_pk_bf16_f32 v134, v128, v129
    v_cvt_pk_bf16_f32 v132, v64, v65
    v_cvt_pk_bf16_f32 v135, v130, v131
    v_cvt_pk_bf16_f32 v133, v66, v67
    v_lshlrev_b32_e64 v128, 16, v134
    v_and_b32 v129, 0xffff0000, v134
    v_lshlrev_b32_e64 v64, 16, v132
    v_and_b32 v65, 0xffff0000, v132
    v_lshlrev_b32_e64 v130, 16, v135
    v_and_b32 v131, 0xffff0000, v135
    v_lshlrev_b32_e64 v66, 16, v133
    v_and_b32 v67, 0xffff0000, v133
    v_pk_add_f32 v[64:65], v[64:65], v[128:129]
    v_pk_add_f32 v[66:67], v[66:67], v[130:131]
    v_pk_add_f32 v[72:73], v[72:73], v[76:77]
    v_pk_add_f32 v[74:75], v[74:75], v[78:79]
    v_fma_mix_f32 v144, v82, v57, 0 op_sel:[0,0,0] op_sel_hi:[1,0,0]
    v_fma_mix_f32 v145, v82, v57, 0 op_sel:[1,0,0] op_sel_hi:[1,0,0]
    v_fma_mix_f32 v146, v83, v57, 0 op_sel:[0,0,0] op_sel_hi:[1,0,0]
    v_fma_mix_f32 v147, v83, v57, 0 op_sel:[1,0,0] op_sel_hi:[1,0,0]
    v_pk_mul_f32 v[72:73], v[72:73], v[54:55] op_sel:[0,1] op_sel_hi:[1,1]
    v_pk_mul_f32 v[74:75], v[74:75], v[54:55] op_sel:[0,1] op_sel_hi:[1,1]
    v_cvt_pk_bf16_f32 v150, v144, v145
    v_cvt_pk_bf16_f32 v148, v72, v73
    v_cvt_pk_bf16_f32 v151, v146, v147
    v_cvt_pk_bf16_f32 v149, v74, v75
    v_lshlrev_b32_e64 v144, 16, v150
    v_and_b32 v145, 0xffff0000, v150
    v_lshlrev_b32_e64 v72, 16, v148
    v_and_b32 v73, 0xffff0000, v148
    v_lshlrev_b32_e64 v146, 16, v151
    v_and_b32 v147, 0xffff0000, v151
    v_lshlrev_b32_e64 v74, 16, v149
    v_and_b32 v75, 0xffff0000, v149
    v_pk_add_f32 v[72:73], v[72:73], v[144:145]
    v_pk_add_f32 v[74:75], v[74:75], v[146:147]
    v_cvt_pk_bf16_f32 v160, v64, v72
    v_cvt_pk_bf16_f32 v161, v65, v73
    v_cvt_pk_bf16_f32 v162, v66, v74
    v_cvt_pk_bf16_f32 v163, v67, v75
    buffer_store_dwordx4 v[160:163], v4, s[4:7], 0 offen offset:0 sc1
    s_waitcnt lgkmcnt(0)
    s_nop 0
    v_pk_add_f32 v[96:97], v[96:97], v[100:101]
    v_pk_add_f32 v[98:99], v[98:99], v[102:103]
    v_fma_mix_f32 v128, v112, v56, 0 op_sel:[0,0,0] op_sel_hi:[1,0,0]
    v_fma_mix_f32 v129, v112, v56, 0 op_sel:[1,0,0] op_sel_hi:[1,0,0]
    v_fma_mix_f32 v130, v113, v56, 0 op_sel:[0,0,0] op_sel_hi:[1,0,0]
    v_fma_mix_f32 v131, v113, v56, 0 op_sel:[1,0,0] op_sel_hi:[1,0,0]
    v_pk_mul_f32 v[96:97], v[96:97], v[54:55] op_sel:[0,0] op_sel_hi:[1,0]
    v_pk_mul_f32 v[98:99], v[98:99], v[54:55] op_sel:[0,0] op_sel_hi:[1,0]
    v_cvt_pk_bf16_f32 v134, v128, v129
    v_cvt_pk_bf16_f32 v132, v96, v97
    v_cvt_pk_bf16_f32 v135, v130, v131
    v_cvt_pk_bf16_f32 v133, v98, v99
    v_lshlrev_b32_e64 v128, 16, v134
    v_and_b32 v129, 0xffff0000, v134
    v_lshlrev_b32_e64 v96, 16, v132
    v_and_b32 v97, 0xffff0000, v132
    v_lshlrev_b32_e64 v130, 16, v135
    v_and_b32 v131, 0xffff0000, v135
    v_lshlrev_b32_e64 v98, 16, v133
    v_and_b32 v99, 0xffff0000, v133
    v_pk_add_f32 v[96:97], v[96:97], v[128:129]
    v_pk_add_f32 v[98:99], v[98:99], v[130:131]
    v_pk_add_f32 v[104:105], v[104:105], v[108:109]
    v_pk_add_f32 v[106:107], v[106:107], v[110:111]
    v_fma_mix_f32 v144, v114, v57, 0 op_sel:[0,0,0] op_sel_hi:[1,0,0]
    v_fma_mix_f32 v145, v114, v57, 0 op_sel:[1,0,0] op_sel_hi:[1,0,0]
    v_fma_mix_f32 v146, v115, v57, 0 op_sel:[0,0,0] op_sel_hi:[1,0,0]
    v_fma_mix_f32 v147, v115, v57, 0 op_sel:[1,0,0] op_sel_hi:[1,0,0]
    v_pk_mul_f32 v[104:105], v[104:105], v[54:55] op_sel:[0,1] op_sel_hi:[1,1]
    v_pk_mul_f32 v[106:107], v[106:107], v[54:55] op_sel:[0,1] op_sel_hi:[1,1]
    v_cvt_pk_bf16_f32 v150, v144, v145
    v_cvt_pk_bf16_f32 v148, v104, v105
    v_cvt_pk_bf16_f32 v151, v146, v147
    v_cvt_pk_bf16_f32 v149, v106, v107
    v_lshlrev_b32_e64 v144, 16, v150
    v_and_b32 v145, 0xffff0000, v150
    v_lshlrev_b32_e64 v104, 16, v148
    v_and_b32 v105, 0xffff0000, v148
    v_lshlrev_b32_e64 v146, 16, v151
    v_and_b32 v147, 0xffff0000, v151
    v_lshlrev_b32_e64 v106, 16, v149
    v_and_b32 v107, 0xffff0000, v149
    v_pk_add_f32 v[104:105], v[104:105], v[144:145]
    v_pk_add_f32 v[106:107], v[106:107], v[146:147]
    v_cvt_pk_bf16_f32 v164, v96, v104
    v_cvt_pk_bf16_f32 v165, v97, v105
    v_cvt_pk_bf16_f32 v166, v98, v106
    v_cvt_pk_bf16_f32 v167, v99, v107
    buffer_store_dwordx4 v[164:167], v4, s[4:7], 0 offen offset:1024 sc1
    s_waitcnt vmcnt(2)
    s_nop 0
    ds_read_b64_tr_b16 a[0:1], v236 offset:0
    ds_read_b64_tr_b16 a[2:3], v236 offset:512
    ds_read_b64_tr_b16 a[4:5], v237 offset:0
    ds_read_b64_tr_b16 a[6:7], v237 offset:512
    ds_read_b64_tr_b16 a[8:9], v238 offset:0
    ds_read_b64_tr_b16 a[10:11], v238 offset:512
    ds_read_b64_tr_b16 a[12:13], v239 offset:0
    ds_read_b64_tr_b16 a[14:15], v239 offset:512
    ds_read_b64_tr_b16 a[16:17], v236 offset:4096
    ds_read_b64_tr_b16 a[18:19], v236 offset:4608
    ds_read_b64_tr_b16 a[20:21], v237 offset:4096
    ds_read_b64_tr_b16 a[22:23], v237 offset:4608
    ds_read_b64_tr_b16 a[24:25], v238 offset:4096
    ds_read_b64_tr_b16 a[26:27], v238 offset:4608
    ds_read_b64_tr_b16 a[28:29], v239 offset:4096
    ds_read_b64_tr_b16 a[30:31], v239 offset:4608
    ds_read_b64_tr_b16 a[32:33], v244 offset:0
    ds_read_b64_tr_b16 a[34:35], v244 offset:512
    ds_read_b64_tr_b16 a[36:37], v245 offset:0
    ds_read_b64_tr_b16 a[38:39], v245 offset:512
    ds_read_b64_tr_b16 a[40:41], v246 offset:0
    ds_read_b64_tr_b16 a[42:43], v246 offset:512
    ds_read_b64_tr_b16 a[44:45], v247 offset:0
    ds_read_b64_tr_b16 a[46:47], v247 offset:512
    ds_read_b64_tr_b16 a[48:49], v244 offset:4096
    ds_read_b64_tr_b16 a[50:51], v244 offset:4608
    ds_read_b64_tr_b16 a[52:53], v245 offset:4096
    ds_read_b64_tr_b16 a[54:55], v245 offset:4608
    ds_read_b64_tr_b16 a[56:57], v246 offset:4096
    ds_read_b64_tr_b16 a[58:59], v246 offset:4608
    ds_read_b64_tr_b16 a[60:61], v247 offset:4096
    ds_read_b64_tr_b16 a[62:63], v247 offset:4608
    ds_read_b64_tr_b16 a[64:65], v244 offset:8192
    ds_read_b64_tr_b16 a[66:67], v244 offset:8704
    ds_read_b64_tr_b16 a[68:69], v245 offset:8192
    ds_read_b64_tr_b16 a[70:71], v245 offset:8704
    ds_read_b64_tr_b16 a[72:73], v246 offset:8192
    ds_read_b64_tr_b16 a[74:75], v246 offset:8704
    ds_read_b64_tr_b16 a[76:77], v247 offset:8192
    ds_read_b64_tr_b16 a[78:79], v247 offset:8704
    ds_read_b64_tr_b16 a[80:81], v244 offset:12288
    ds_read_b64_tr_b16 a[82:83], v244 offset:12800
    ds_read_b64_tr_b16 a[84:85], v245 offset:12288
    ds_read_b64_tr_b16 a[86:87], v245 offset:12800
    ds_read_b64_tr_b16 a[88:89], v246 offset:12288
    ds_read_b64_tr_b16 a[90:91], v246 offset:12800
    ds_read_b64_tr_b16 a[92:93], v247 offset:12288
    ds_read_b64_tr_b16 a[94:95], v247 offset:12800
    s_waitcnt lgkmcnt(0)
    s_barrier
    s_add_u32 s70, s38, 688128
    s_cmp_ge_u32 s70, 1835008
    s_cselect_b32 s71, 1835008, 0
    s_sub_u32 s70, s70, s71
    s_add_u32 m0, s51, 0
    s_nop 0
    s_nop 0
    buffer_load_dwordx4 v224, s[12:15], s70 offen offset:0 lds
    buffer_load_dwordx4 v225, s[12:15], s70 offen offset:1024 lds
    buffer_load_dwordx4 v226, s[12:15], s70 offen offset:2048 lds
    buffer_load_dwordx4 v227, s[12:15], s70 offen offset:3072 lds
    s_add_u32 s70, s38, 802816
    s_cmp_ge_u32 s70, 1835008
    s_cselect_b32 s71, 1835008, 0
    s_sub_u32 s70, s70, s71
    s_add_u32 m0, s51, 4096
    s_nop 0
    buffer_load_dwordx4 v224, s[12:15], s70 offen offset:0 lds
    buffer_load_dwordx4 v225, s[12:15], s70 offen offset:1024 lds
    buffer_load_dwordx4 v226, s[12:15], s70 offen offset:2048 lds
    buffer_load_dwordx4 v227, s[12:15], s70 offen offset:3072 lds
    s_add_u32 s70, s38, 917504
    s_cmp_ge_u32 s70, 1835008
    s_cselect_b32 s71, 1835008, 0
    s_sub_u32 s70, s70, s71
    s_add_u32 m0, s51, 8192
    s_nop 0
    buffer_load_dwordx4 v224, s[12:15], s70 offen offset:0 lds
    buffer_load_dwordx4 v225, s[12:15], s70 offen offset:1024 lds
    buffer_load_dwordx4 v226, s[12:15], s70 offen offset:2048 lds
    buffer_load_dwordx4 v227, s[12:15], s70 offen offset:3072 lds
    s_add_u32 s70, s38, 1032192
    s_cmp_ge_u32 s70, 1835008
    s_cselect_b32 s71, 1835008, 0
    s_sub_u32 s70, s70, s71
    s_add_u32 m0, s51, 12288
    s_nop 0
    buffer_load_dwordx4 v224, s[12:15], s70 offen offset:0 lds
    buffer_load_dwordx4 v225, s[12:15], s70 offen offset:1024 lds
    buffer_load_dwordx4 v226, s[12:15], s70 offen offset:2048 lds
    buffer_load_dwordx4 v227, s[12:15], s70 offen offset:3072 lds
    s_add_u32 s70, s38, 1146880
    s_cmp_ge_u32 s70, 1835008
    s_cselect_b32 s71, 1835008, 0
    s_sub_u32 s70, s70, s71
    s_add_u32 m0, s51, 16384
    s_nop 0
    buffer_load_dwordx4 v224, s[12:15], s70 offen offset:0 lds
    buffer_load_dwordx4 v225, s[12:15], s70 offen offset:1024 lds
    buffer_load_dwordx4 v226, s[12:15], s70 offen offset:2048 lds
    buffer_load_dwordx4 v227, s[12:15], s70 offen offset:3072 lds
    s_add_u32 s70, s38, 1261568
    s_cmp_ge_u32 s70, 1835008
    s_cselect_b32 s71, 1835008, 0
    s_sub_u32 s70, s70, s71
    s_add_u32 m0, s50, 0
    s_nop 0
    s_nop 0
    buffer_load_dwordx4 v224, s[12:15], s70 offen offset:0 lds
    buffer_load_dwordx4 v225, s[12:15], s70 offen offset:1024 lds
    buffer_load_dwordx4 v226, s[12:15], s70 offen offset:2048 lds
    buffer_load_dwordx4 v227, s[12:15], s70 offen offset:3072 lds
    s_add_u32 s70, s38, 1376256
    s_cmp_ge_u32 s70, 1835008
    s_cselect_b32 s71, 1835008, 0
    s_sub_u32 s70, s70, s71
    s_add_u32 m0, s50, 4096
    s_nop 0
    buffer_load_dwordx4 v224, s[12:15], s70 offen offset:0 lds
    buffer_load_dwordx4 v225, s[12:15], s70 offen offset:1024 lds
    buffer_load_dwordx4 v226, s[12:15], s70 offen offset:2048 lds
    buffer_load_dwordx4 v227, s[12:15], s70 offen offset:3072 lds
    s_add_u32 s70, s38, 1490944
    s_cmp_ge_u32 s70, 1835008
    s_cselect_b32 s71, 1835008, 0
    s_sub_u32 s70, s70, s71
    s_add_u32 m0, s50, 8192
    s_nop 0
    buffer_load_dwordx4 v224, s[12:15], s70 offen offset:0 lds
    buffer_load_dwordx4 v225, s[12:15], s70 offen offset:1024 lds
    buffer_load_dwordx4 v226, s[12:15], s70 offen offset:2048 lds
    buffer_load_dwordx4 v227, s[12:15], s70 offen offset:3072 lds
    s_add_u32 s70, s38, 1605632
    s_cmp_ge_u32 s70, 1835008
    s_cselect_b32 s71, 1835008, 0
    s_sub_u32 s70, s70, s71
    s_add_u32 m0, s50, 12288
    s_nop 0
    buffer_load_dwordx4 v224, s[12:15], s70 offen offset:0 lds
    buffer_load_dwordx4 v225, s[12:15], s70 offen offset:1024 lds
    buffer_load_dwordx4 v226, s[12:15], s70 offen offset:2048 lds
    buffer_load_dwordx4 v227, s[12:15], s70 offen offset:3072 lds
    s_branch noconv_3
noconv_2:
    s_getpc_b64 s[74:75]
pcp_14:
    s_sub_u32 s74, s74, pcp_14-sequential_preLN__ssm_conv_s4d__mixer_token_mlp__prompt_kernel
    s_subb_u32 s75, s75, 0
    v_lshlrev_b32 v4, 6, v0
    s_mov_b32 s76, kcode_end-sequential_preLN__ssm_conv_s4d__mixer_token_mlp__prompt_kernel-4
    v_add_u32 v5, 16384, v4
    v_add_u32 v6, 32768, v4
    v_min_u32 v4, s76, v4
    v_min_u32 v5, s76, v5
    v_min_u32_e64 v6, s76, v6
    global_load_dword v220, v4, s[74:75]
    global_load_dword v220, v5, s[74:75]
    global_load_dword v220, v6, s[74:75]
    s_mov_b32 s12, s52
    s_and_b32 s13, s53, 0xffff
    s_mov_b32 s14, 7340032
    s_mov_b32 s15, 0x00020000
    s_mov_b32 s16, s56
    s_and_b32 s17, s57, 0xffff
    s_mov_b32 s18, 7340032
    s_mov_b32 s19, 0x00020000
    v_lshrrev_b32_e64 v4, 3, v1
    v_bfe_u32 v5, v1, 4, 1
    v_lshlrev_b32 v5, 1, v5
    v_and_b32 v6, 7, v1
    v_xor_b32 v6, v6, v5
    v_xor_b32 v7, 4, v6
    s_mov_b32 s66, 3584
    v_mul_lo_u32 v5, v4, s66
    s_mul_i32 s67, s28, 1835008
    s_lshl_b32 s66, s34, 7
    s_add_u32 s67, s67, s66
    v_add_u32_e64 v5, s67, v5
    v_lshl_add_u32 v224, v6, 4, v5
    v_lshl_add_u32 v225, v7, 4, v5
    v_add_u32 v225, 27648, v225
    v_lshl_add_u32 v226, v6, 4, v5
    v_add_u32 v226, 55296, v226
    v_lshl_add_u32 v227, v7, 4, v5
    v_add_u32 v227, 82944, v227
    s_mov_b32 s66, 4096
    v_mul_lo_u32 v5, v4, s66
    s_mul_i32 s67, s28, 1835008
    s_lshl_b32 s66, s35, 7
    s_add_u32 s67, s67, s66
    v_add_u32_e64 v5, s67, v5
    v_lshl_add_u32 v228, v6, 4, v5
    v_lshl_add_u32 v229, v7, 4, v5
    v_add_u32 v229, 31744, v229
    v_lshl_add_u32 v230, v6, 4, v5
    v_add_u32 v230, 63488, v230
    v_lshl_add_u32 v231, v7, 4, v5
    v_add_u32 v231, 95232, v231
    v_lshlrev_b32 v5, 12, v4
    v_and_b32 v6, 7, v1
    v_lshl_add_u32 v232, v6, 4, v5
    s_and_b32 s66, s30, 3
    s_mul_i32 s66, s66, 448
    s_mul_i32 s67, s28, 32
    s_add_u32 s67, s67, 320
    s_add_u32 s66, s66, s67
    s_lshl_b32 s66, s66, 12
    s_lshl_b32 s67, s35, 7
    s_add_u32 s42, s66, s67
    v_lshrrev_b32_e64 v4, 4, v1
    v_bfe_u32 v5, v1, 2, 2
    v_lshl_add_u32 v5, v4, 3, v5
    v_lshlrev_b32 v5, 7, v5
    v_and_b32 v6, 1, v1
    v_lshl_add_u32 v5, v6, 3, v5
    v_bfe_u32 v6, v1, 1, 1
    v_lshl_add_u32 v5, v6, 4, v5
    v_bfe_u32 v6, v1, 3, 1
    v_and_b32_e64 v4, 1, v4
    v_lshl_add_u32 v6, v4, 1, v6
    s_and_b32 s66, s30, 3
    s_lshr_b32 s67, s30, 2
    s_lshl_b32 s67, s67, 1
    s_lshl_b32 s70, s66, 2
    s_add_u32 s70, s70, s67
    s_and_b32 s70, s70, 15
    s_mul_i32 s38, s70, 114688
    s_mul_i32 s39, s70, 28672
    s_mul_i32 s66, s66, 7
    s_lshr_b32 s66, s66, 1
    s_add_u32 s66, s66, s67
    s_cmp_ge_u32 s66, 14
    s_cselect_b32 s67, 14, 0
    s_sub_u32 s66, s66, s67
    s_cmp_ge_u32 s66, 14
    s_cselect_b32 s67, 14, 0
    s_sub_u32 s66, s66, s67
    s_mul_i32 s40, s66, 131072
    s_mul_i32 s41, s66, 28672
    s_lshl_b32 s50, s28, 14
    s_add_u32 s50, s50, 13056
    s_mul_i32 s51, s28, 20480
    s_add_u32 s51, s51, 78592
    s_lshl_b32 s44, s28, 13
    s_add_u32 s44, s44, 123904
    v_xor_b32 v4, 0, v6
    v_lshl_add_u32 v4, v4, 5, v5
    v_add_u32 v244, s50, v4
    v_add_u32 v248, s51, v4
    v_add_u32 v236, s44, v4
    v_xor_b32 v4, 1, v6
    v_lshl_add_u32 v4, v4, 5, v5
    v_add_u32 v245, s50, v4
    v_add_u32 v249, s51, v4
    v_add_u32 v237, s44, v4
    v_xor_b32 v4, 2, v6
    v_lshl_add_u32 v4, v4, 5, v5
    v_add_u32 v246, s50, v4
    v_add_u32 v250, s51, v4
    v_add_u32 v238, s44, v4
    v_xor_b32 v4, 3, v6
    v_lshl_add_u32 v4, v4, 5, v5
    v_add_u32 v247, s50, v4
    v_add_u32 v251, s51, v4
    v_add_u32 v239, s44, v4
    s_mov_b32 s20, s60
    s_and_b32 s21, s61, 0xffff
    s_mov_b32 s22, 1835008
    s_mov_b32 s23, 0x00020000
    s_mov_b32 s24, s58
    s_and_b32 s25, s59, 0xffff
    s_mov_b32 s26, 4096
    s_mov_b32 s27, 0x00020000
    v_lshlrev_b32 v4, 21, v1
    s_mov_b32 s70, 0x1f8000
    buffer_load_dword v220, v4, s[12:15], 0 offen
    buffer_load_dword v220, v4, s[16:19], 0 offen
    buffer_load_dword v220, v4, s[4:7], s70 offen
    buffer_load_dword v220, v4, s[24:27], 0 offen
    v_lshlrev_b32_e64 v233, 6, v0
    v_add_u32 v233, 16384, v233
    s_waitcnt lgkmcnt(0)
    s_add_u32 s96, s99, 0x9e3779b9
    s_waitcnt vmcnt(7)
    s_mul_i32 s66, s31, 7168
    s_add_u32 s66, s66, 4194304
    v_lshl_add_u32 v4, v0, 4, s66
    v_add_u32 v5, 4096, v4
    v_mov_b32_e64 v6, 1073741824
    v_cmp_gt_u32 vcc, 192, v0
    s_nop 1
    v_cndmask_b32 v5, v6, v5, vcc
    buffer_store_dwordx4 v[216:219], v4, s[4:7], 0 offen sc1
    buffer_store_dwordx4 v[216:219], v5, s[4:7], 0 offen sc1
    s_mov_b32 s66, 0x3f803f80
    v_dot2_f32_bf16 v16, v8, s66, 0
    v_dot2_f32_bf16 v24, v8, v8, 0
    v_dot2_f32_bf16 v17, v9, s66, 0
    v_dot2_f32_bf16 v25, v9, v9, 0
    v_dot2_f32_bf16 v18, v10, s66, 0
    v_dot2_f32_bf16 v26, v10, v10, 0
    v_dot2_f32_bf16 v19, v11, s66, 0
    v_dot2_f32_bf16 v27, v11, v11, 0
    v_dot2_f32_bf16 v20, v12, s66, 0
    v_dot2_f32_bf16 v28, v12, v12, 0
    v_dot2_f32_bf16 v21, v13, s66, 0
    v_dot2_f32_bf16 v29, v13, v13, 0
    v_dot2_f32_bf16 v22, v14, s66, 0
    v_dot2_f32_bf16 v30, v14, v14, 0
    v_dot2_f32_bf16 v23, v15, s66, 0
    v_dot2_f32_bf16 v31, v15, v15, 0
    v_lshlrev_b32_e64 v5, 2, v1
    v_and_b32 v5, 0xf0, v5
    s_lshl_b32 s66, s28, 2
    v_add_u32 v5, s66, v5
    v_permlane32_swap_b32 v16, v24
    v_permlane32_swap_b32 v17, v25
    v_permlane32_swap_b32 v18, v26
    v_permlane32_swap_b32 v19, v27
    v_permlane32_swap_b32 v20, v28
    v_permlane32_swap_b32 v21, v29
    v_permlane32_swap_b32 v22, v30
    v_permlane32_swap_b32 v23, v31
    v_add_f32 v16, v16, v24
    v_add_f32 v17, v17, v25
    v_add_f32 v18, v18, v26
    v_add_f32 v19, v19, v27
    v_add_f32 v20, v20, v28
    v_add_f32 v21, v21, v29
    v_add_f32 v22, v22, v30
    v_add_f32 v23, v23, v31
    v_permlane16_swap_b32 v16, v20
    v_permlane16_swap_b32 v17, v21
    v_permlane16_swap_b32 v18, v22
    v_permlane16_swap_b32 v19, v23
    v_add_f32 v16, v16, v20
    v_add_f32 v17, v17, v21
    v_add_f32 v18, v18, v22
    v_add_f32 v19, v19, v23
    v_add_f32_dpp v16, v16, v16 row_ror:8 row_mask:0xf bank_mask:0x3
    v_add_f32_dpp v17, v17, v17 row_ror:8 row_mask:0xf bank_mask:0x3
    s_nop 0
    v_add_f32_dpp v16, v18, v18 row_ror:8 row_mask:0xf bank_mask:0xc
    v_add_f32_dpp v17, v19, v19 row_ror:8 row_mask:0xf bank_mask:0xc
    s_nop 0
    v_add_f32_dpp v16, v16, v16 row_half_mirror row_mask:0xf bank_mask:0x5
    s_nop 1
    v_add_f32_dpp v16, v17, v17 row_half_mirror row_mask:0xf bank_mask:0xa
    s_nop 1
    v_add_f32_dpp v16, v16, v16 quad_perm:[1,0,3,2] row_mask:0xf bank_mask:0xf
    s_nop 1
    v_add_f32_dpp v16, v16, v16 quad_perm:[2,3,0,1] row_mask:0xf bank_mask:0xf
    s_mov_b32 exec_lo, 0x11111111
    s_mov_b32 exec_hi, 0x11111111
    ds_write_b32 v5, v16 offset:0
    s_mov_b64 exec, -1
    v_and_b32 v5, 7, v1
    v_lshlrev_b32 v5, 4, v5
    s_waitcnt lgkmcnt(0)
    s_barrier
    ds_read_b128 v[16:19], v5 offset:0
    ds_read_b128 v[20:23], v5 offset:128
    s_waitcnt lgkmcnt(1)
    v_pk_add_f32 v[16:17], v[16:17], v[18:19]
    s_waitcnt lgkmcnt(0)
    v_pk_add_f32 v[20:21], v[20:21], v[22:23]
    v_add_f32 v16, v16, v17
    v_add_f32 v20, v20, v21
    v_mul_f32 v16, 0x3b124925, v16
    v_mul_f32 v20, 0x3b124925, v20
    v_fma_f32 v20, -v16, v16, v20
    v_max_f32_e64 v20, 0, v20
    v_cvt_pk_bf16_f32 v20, v20, v20
    v_lshlrev_b32_e64 v20, 16, v20
    v_add_f32 v20, 0x3727c5ac, v20
    v_cvt_pk_bf16_f32 v20, v20, v20
    v_lshlrev_b32 v20, 16, v20
    v_sqrt_f32_e64 v20, v20
    s_nop 0
    v_cvt_pk_bf16_f32 v16, v16, v20
    v_lshlrev_b32_e64 v17, 16, v16
    v_and_b32 v18, 0xffff0000, v16
    v_rcp_f32_e64 v18, v18
    v_readlane_b32 s72, v17, 0
    v_readlane_b32 s74, v17, 1
    v_readlane_b32 s76, v17, 2
    v_readlane_b32 s78, v17, 3
    v_readlane_b32 s80, v17, 4
    v_readlane_b32 s82, v17, 5
    v_readlane_b32 s84, v17, 6
    v_readlane_b32 s86, v17, 7
    v_readlane_b32 s73, v18, 0
    v_readlane_b32 s75, v18, 1
    v_readlane_b32 s77, v18, 2
    v_readlane_b32 s79, v18, 3
    v_readlane_b32 s81, v18, 4
    v_readlane_b32 s83, v18, 5
    v_readlane_b32 s85, v18, 6
    v_readlane_b32 s87, v18, 7
    v_lshlrev_b32_e64 v64, 16, v8
    v_and_b32 v65, 0xffff0000, v8
    v_pk_add_f32 v[64:65], v[64:65], s[72:73] op_sel:[0,0] op_sel_hi:[1,0] neg_lo:[0,1] neg_hi:[0,1]
    v_cvt_pk_bf16_f32 v48, v64, v65
    v_lshlrev_b32_e64 v64, 16, v48
    v_and_b32 v65, 0xffff0000, v48
    v_pk_mul_f32 v[64:65], v[64:65], s[72:73] op_sel:[0,1] op_sel_hi:[1,1]
    v_cvt_pk_bf16_f32 v48, v64, v65
    v_lshlrev_b32_e64 v64, 16, v48
    v_and_b32 v65, 0xffff0000, v48
    v_lshlrev_b32_e64 v66, 16, v9
    v_and_b32 v67, 0xffff0000, v9
    v_pk_add_f32 v[66:67], v[66:67], s[74:75] op_sel:[0,0] op_sel_hi:[1,0] neg_lo:[0,1] neg_hi:[0,1]
    v_cvt_pk_bf16_f32 v49, v66, v67
    v_lshlrev_b32_e64 v66, 16, v49
    v_and_b32 v67, 0xffff0000, v49
    v_pk_mul_f32 v[66:67], v[66:67], s[74:75] op_sel:[0,1] op_sel_hi:[1,1]
    v_cvt_pk_bf16_f32 v49, v66, v67
    v_lshlrev_b32_e64 v66, 16, v49
    v_and_b32 v67, 0xffff0000, v49
    v_lshlrev_b32_e64 v68, 16, v10
    v_and_b32 v69, 0xffff0000, v10
    v_pk_add_f32 v[68:69], v[68:69], s[76:77] op_sel:[0,0] op_sel_hi:[1,0] neg_lo:[0,1] neg_hi:[0,1]
    v_cvt_pk_bf16_f32 v50, v68, v69
    v_lshlrev_b32_e64 v68, 16, v50
    v_and_b32 v69, 0xffff0000, v50
    v_pk_mul_f32 v[68:69], v[68:69], s[76:77] op_sel:[0,1] op_sel_hi:[1,1]
    v_cvt_pk_bf16_f32 v50, v68, v69
    v_lshlrev_b32_e64 v68, 16, v50
    v_and_b32 v69, 0xffff0000, v50
    v_lshlrev_b32_e64 v70, 16, v11
    v_and_b32 v71, 0xffff0000, v11
    v_pk_add_f32 v[70:71], v[70:71], s[78:79] op_sel:[0,0] op_sel_hi:[1,0] neg_lo:[0,1] neg_hi:[0,1]
    v_cvt_pk_bf16_f32 v51, v70, v71
    v_lshlrev_b32_e64 v70, 16, v51
    v_and_b32 v71, 0xffff0000, v51
    v_pk_mul_f32 v[70:71], v[70:71], s[78:79] op_sel:[0,1] op_sel_hi:[1,1]
    v_cvt_pk_bf16_f32 v51, v70, v71
    v_lshlrev_b32_e64 v70, 16, v51
    v_and_b32 v71, 0xffff0000, v51
    v_lshlrev_b32_e64 v72, 16, v12
    v_and_b32 v73, 0xffff0000, v12
    v_pk_add_f32 v[72:73], v[72:73], s[80:81] op_sel:[0,0] op_sel_hi:[1,0] neg_lo:[0,1] neg_hi:[0,1]
    v_cvt_pk_bf16_f32 v52, v72, v73
    v_lshlrev_b32_e64 v72, 16, v52
    v_and_b32 v73, 0xffff0000, v52
    v_pk_mul_f32 v[72:73], v[72:73], s[80:81] op_sel:[0,1] op_sel_hi:[1,1]
    v_cvt_pk_bf16_f32 v52, v72, v73
    v_lshlrev_b32_e64 v72, 16, v52
    v_and_b32 v73, 0xffff0000, v52
    v_lshlrev_b32_e64 v74, 16, v13
    v_and_b32 v75, 0xffff0000, v13
    v_pk_add_f32 v[74:75], v[74:75], s[82:83] op_sel:[0,0] op_sel_hi:[1,0] neg_lo:[0,1] neg_hi:[0,1]
    v_cvt_pk_bf16_f32 v53, v74, v75
    v_lshlrev_b32_e64 v74, 16, v53
    v_and_b32 v75, 0xffff0000, v53
    v_pk_mul_f32 v[74:75], v[74:75], s[82:83] op_sel:[0,1] op_sel_hi:[1,1]
    v_cvt_pk_bf16_f32 v53, v74, v75
    v_lshlrev_b32_e64 v74, 16, v53
    v_and_b32 v75, 0xffff0000, v53
    v_lshlrev_b32_e64 v76, 16, v14
    v_and_b32 v77, 0xffff0000, v14
    v_pk_add_f32 v[76:77], v[76:77], s[84:85] op_sel:[0,0] op_sel_hi:[1,0] neg_lo:[0,1] neg_hi:[0,1]
    v_cvt_pk_bf16_f32 v54, v76, v77
    v_lshlrev_b32_e64 v76, 16, v54
    v_and_b32 v77, 0xffff0000, v54
    v_pk_mul_f32 v[76:77], v[76:77], s[84:85] op_sel:[0,1] op_sel_hi:[1,1]
    v_cvt_pk_bf16_f32 v54, v76, v77
    v_lshlrev_b32_e64 v76, 16, v54
    v_and_b32 v77, 0xffff0000, v54
    v_lshlrev_b32_e64 v78, 16, v15
    v_and_b32 v79, 0xffff0000, v15
    v_pk_add_f32 v[78:79], v[78:79], s[86:87] op_sel:[0,0] op_sel_hi:[1,0] neg_lo:[0,1] neg_hi:[0,1]
    v_cvt_pk_bf16_f32 v55, v78, v79
    v_lshlrev_b32_e64 v78, 16, v55
    v_and_b32 v79, 0xffff0000, v55
    v_pk_mul_f32 v[78:79], v[78:79], s[86:87] op_sel:[0,1] op_sel_hi:[1,1]
    v_cvt_pk_bf16_f32 v55, v78, v79
    v_lshlrev_b32_e64 v78, 16, v55
    v_and_b32 v79, 0xffff0000, v55
    v_cvt_pk_f16_f32 v80, v64, v66
    v_cvt_pk_f16_f32 v84, v65, v67
    v_cvt_pk_f16_f32 v81, v68, v70
    v_cvt_pk_f16_f32 v85, v69, v71
    v_cvt_pk_f16_f32 v82, v72, v74
    v_cvt_pk_f16_f32 v86, v73, v75
    v_cvt_pk_f16_f32 v83, v76, v78
    v_cvt_pk_f16_f32 v87, v77, v79
    s_mul_i32 s66, s28, 896
    s_mul_i32 s67, s31, 7168
    s_add_u32 s66, s66, s67
    s_add_u32 s66, s66, 10485760
    v_lshl_add_u32 v4, v1, 4, s66
    v_mov_b32_e64 v5, 1073741824
    v_cmp_gt_u32 vcc, 56, v1
    s_nop 1
    v_cndmask_b32 v4, v5, v4, vcc
    v_add_u32 v5, 3584, v4
    buffer_store_dwordx4 v[80:83], v4, s[4:7], 0 offen sc1
    buffer_store_dwordx4 v[84:87], v5, s[4:7], 0 offen sc1
    s_waitcnt vmcnt(0)
    s_barrier
    s_cmp_lg_u32 s28, 0
    s_cbranch_scc1 noflag_15
    s_lshl_b32 s66, s31, 6
    s_add_u32 s66, s66, 16384
    v_mov_b32 v2, s66
    v_mov_b32 v3, s96
    s_mov_b64 exec, 1
    buffer_store_dword v3, v2, s[4:7], 0 offen sc1
    s_mov_b64 exec, -1
noflag_15:
    s_nop 0
    buffer_load_dwordx4 v[220:223], v232, s[16:19], s42 offen
    s_add_u32 s42, s42, 32768
    buffer_load_dwordx4 v[220:223], v232, s[16:19], s42 offen
    s_add_u32 s42, s42, 32768
    buffer_load_dwordx4 v[220:223], v232, s[16:19], s42 offen
    s_add_u32 s42, s42, 32768
    buffer_load_dwordx4 v[220:223], v232, s[16:19], s42 offen
    s_add_u32 s42, s42, 32768
    s_lshr_b32 s66, s29, 1
    s_lshl_b32 s66, s66, 10
    s_sub_u32 s67, s30, 28
    s_mul_i32 s67, s67, 448
    s_add_u32 s67, s67, s28
    s_lshl_b32 s67, s67, 12
    s_add_u32 s90, s66, s67
    v_lshlrev_b32 v4, 4, v1
    s_mov_b32 s91, 20
l2s_16:
    buffer_load_dwordx4 v[220:223], v4, s[16:19], s90 offen
    s_add_u32 s90, s90, 16384
    buffer_load_dwordx4 v[220:223], v4, s[16:19], s90 offen
    s_add_u32 s90, s90, 16384
    buffer_load_dwordx4 v[220:223], v4, s[16:19], s90 offen
    s_add_u32 s90, s90, 16384
    buffer_load_dwordx4 v[220:223], v4, s[16:19], s90 offen
    s_add_u32 s90, s90, 16384
    s_waitcnt vmcnt(8)
    s_sub_u32 s91, s91, 1
    s_cmp_lg_u32 s91, 0
    s_cbranch_scc1 l2s_16
    s_mov_b32 s97, 0
fpoll_17:
    buffer_load_dword v234, v233, s[4:7], 0 offen sc1
    s_waitcnt vmcnt(0)
    v_cmp_ne_u32 vcc, s96, v234
    s_nop 3
    s_cbranch_vccz fdone_18
    s_add_u32 s97, s97, 1
    s_cmp_lt_u32 s97, 4000
    s_cbranch_scc1 fpoll_17
fdone_18:
    s_barrier
noconv_3:
    s_mul_i32 s66, s28, 224
    s_mul_i32 s67, s31, 7168
    s_add_u32 s66, s66, s67
    v_lshl_add_u32 v2, v1, 2, s66
    v_mov_b32_e64 v3, 1073741824
    v_cmp_gt_u32 vcc, 56, v1
    s_nop 1
    v_cndmask_b32 v2, v3, v2, vcc
    v_add_u32 v3, 4480, v2
    s_mul_i32 s66, s28, 473088
    s_lshl_b32 s67, s31, 5
    s_add_u32 s66, s66, s67
    s_add_u32 s66, s66, 65536
    v_mul_u32_u24 v4, 8448, v1
    v_add_u32 v4, s66, v4
    v_mov_b32_e64 v5, 1073741824
    v_cndmask_b32 v4, v5, v4, vcc
    s_mul_i32 s66, s28, 1792
    s_add_u32 s66, s66, 1024
    v_lshl_add_u32 v6, v1, 2, s66
    v_lshl_add_u32 v7, v1, 4, s66
    s_mul_i32 s66, s31, 7168
    s_mul_i32 s67, s28, 224
    s_add_u32 s66, s66, s67
    s_add_u32 s66, s66, 2097152
    v_add_u32 v58, 0, v1
    v_mul_u32_u24 v59, 4682, v58
    v_lshrrev_b32_e64 v59, 16, v59
    v_mul_u32_u24 v56, 672, v59
    v_lshl_add_u32 v56, v58, 4, v56
    v_add_u32 v56, s66, v56
    v_add_u32 v58, 64, v1
    v_mul_u32_u24 v59, 4682, v58
    v_lshrrev_b32_e64 v59, 16, v59
    v_mul_u32_u24 v57, 672, v59
    v_lshl_add_u32 v57, v58, 4, v57
    v_add_u32 v57, s66, v57
    v_mov_b32 v58, 1073741824
    v_cmp_gt_u32 vcc, 48, v1
    s_nop 1
    v_cndmask_b32 v57, v58, v57, vcc
    v_lshlrev_b32 v64, 16, v8
    v_and_b32 v65, 0xffff0000, v8
    v_lshlrev_b32_e64 v66, 16, v9
    v_and_b32 v67, 0xffff0000, v9
    v_lshlrev_b32_e64 v68, 16, v10
    v_and_b32 v69, 0xffff0000, v10
    v_lshlrev_b32_e64 v70, 16, v11
    v_and_b32 v71, 0xffff0000, v11
    v_lshlrev_b32_e64 v72, 16, v12
    v_and_b32 v73, 0xffff0000, v12
    v_lshlrev_b32_e64 v74, 16, v13
    v_and_b32 v75, 0xffff0000, v13
    v_lshlrev_b32_e64 v76, 16, v14
    v_and_b32 v77, 0xffff0000, v14
    v_lshlrev_b32_e64 v78, 16, v15
    v_and_b32 v79, 0xffff0000, v15
h2poll0_19:
    s_mov_b32 s97, 0
h2poll_21:
    buffer_load_dwordx4 v[32:35], v4, s[4:7], 0 offen sc1
    buffer_load_dwordx4 v[36:39], v4, s[4:7], 0 offen offset:16 sc1
    s_waitcnt vmcnt(0)
    v_max3_u32 v40, v32, v33, v34
    v_max3_u32 v41, v35, v36, v37
    v_max3_u32 v40, v40, v38, v39
    v_max_u32_e64 v40, v40, v41
    v_cmp_eq_u32 vcc, -1, v40
    s_nop 3
    s_cbranch_vccz h2done_20
    s_add_u32 s97, s97, 1
    s_cmp_lt_u32 s97, 4000
    s_cbranch_scc1 h2poll_21
h2done_20:
    v_lshlrev_b32 v40, 16, v32
    v_and_b32 v41, 0xffff0000, v32
    v_pk_add_f32 v[40:41], v[40:41], v[64:65]
    v_cvt_pk_bf16_f32 v48, v40, v41
    v_lshlrev_b32_e64 v42, 16, v33
    v_and_b32 v43, 0xffff0000, v33
    v_pk_add_f32 v[42:43], v[42:43], v[66:67]
    v_cvt_pk_bf16_f32 v49, v42, v43
    v_lshlrev_b32_e64 v44, 16, v34
    v_and_b32 v45, 0xffff0000, v34
    v_pk_add_f32 v[44:45], v[44:45], v[68:69]
    v_cvt_pk_bf16_f32 v50, v44, v45
    v_lshlrev_b32_e64 v46, 16, v35
    v_and_b32 v47, 0xffff0000, v35
    v_pk_add_f32 v[46:47], v[46:47], v[70:71]
    v_cvt_pk_bf16_f32 v51, v46, v47
    v_lshlrev_b32_e64 v40, 16, v36
    v_and_b32 v41, 0xffff0000, v36
    v_pk_add_f32 v[40:41], v[40:41], v[72:73]
    v_cvt_pk_bf16_f32 v52, v40, v41
    v_lshlrev_b32_e64 v42, 16, v37
    v_and_b32 v43, 0xffff0000, v37
    v_pk_add_f32 v[42:43], v[42:43], v[74:75]
    v_cvt_pk_bf16_f32 v53, v42, v43
    v_lshlrev_b32_e64 v44, 16, v38
    v_and_b32 v45, 0xffff0000, v38
    v_pk_add_f32 v[44:45], v[44:45], v[76:77]
    v_cvt_pk_bf16_f32 v54, v44, v45
    v_lshlrev_b32_e64 v46, 16, v39
    v_and_b32 v47, 0xffff0000, v39
    v_pk_add_f32 v[46:47], v[46:47], v[78:79]
    v_cvt_pk_bf16_f32 v55, v46, v47
    s_mov_b32 exec_hi, 0x00ffffff
    ds_write_b32 v6, v48 offset:0
    ds_write_b32 v6, v49 offset:224
    ds_write_b32 v6, v50 offset:448
    ds_write_b32 v6, v51 offset:672
    ds_write_b32 v6, v52 offset:896
    ds_write_b32 v6, v53 offset:1120
    ds_write_b32 v6, v54 offset:1344
    ds_write_b32 v6, v55 offset:1568
    s_mov_b32 exec_hi, -1
    ds_read_b128 v[32:35], v7
    ds_read_b128 v[36:39], v7 offset:1024
    s_waitcnt lgkmcnt(1)
    buffer_store_dwordx4 v[32:35], v56, s[4:7], 0 offen sc1
    s_waitcnt lgkmcnt(0)
    s_nop 0
    buffer_store_dwordx4 v[36:39], v57, s[4:7], 0 offen sc1
    s_mov_b32 s66, 0x3f803f80
    v_dot2_f32_bf16 v16, v48, s66, 0
    v_dot2_f32_bf16 v24, v48, v48, 0
    v_dot2_f32_bf16 v17, v49, s66, 0
    v_dot2_f32_bf16 v25, v49, v49, 0
    v_dot2_f32_bf16 v18, v50, s66, 0
    v_dot2_f32_bf16 v26, v50, v50, 0
    v_dot2_f32_bf16 v19, v51, s66, 0
    v_dot2_f32_bf16 v27, v51, v51, 0
    v_dot2_f32_bf16 v20, v52, s66, 0
    v_dot2_f32_bf16 v28, v52, v52, 0
    v_dot2_f32_bf16 v21, v53, s66, 0
    v_dot2_f32_bf16 v29, v53, v53, 0
    v_dot2_f32_bf16 v22, v54, s66, 0
    v_dot2_f32_bf16 v30, v54, v54, 0
    v_dot2_f32_bf16 v23, v55, s66, 0
    v_dot2_f32_bf16 v31, v55, v55, 0
    v_lshlrev_b32_e64 v5, 2, v1
    v_and_b32 v5, 0xf0, v5
    s_lshl_b32 s66, s28, 2
    v_add_u32 v5, s66, v5
    v_permlane32_swap_b32 v16, v24
    v_permlane32_swap_b32 v17, v25
    v_permlane32_swap_b32 v18, v26
    v_permlane32_swap_b32 v19, v27
    v_permlane32_swap_b32 v20, v28
    v_permlane32_swap_b32 v21, v29
    v_permlane32_swap_b32 v22, v30
    v_permlane32_swap_b32 v23, v31
    v_add_f32 v16, v16, v24
    v_add_f32 v17, v17, v25
    v_add_f32 v18, v18, v26
    v_add_f32 v19, v19, v27
    v_add_f32 v20, v20, v28
    v_add_f32 v21, v21, v29
    v_add_f32 v22, v22, v30
    v_add_f32 v23, v23, v31
    v_permlane16_swap_b32 v16, v20
    v_permlane16_swap_b32 v17, v21
    v_permlane16_swap_b32 v18, v22
    v_permlane16_swap_b32 v19, v23
    v_add_f32 v16, v16, v20
    v_add_f32 v17, v17, v21
    v_add_f32 v18, v18, v22
    v_add_f32 v19, v19, v23
    v_add_f32_dpp v16, v16, v16 row_ror:8 row_mask:0xf bank_mask:0x3
    v_add_f32_dpp v17, v17, v17 row_ror:8 row_mask:0xf bank_mask:0x3
    s_nop 0
    v_add_f32_dpp v16, v18, v18 row_ror:8 row_mask:0xf bank_mask:0xc
    v_add_f32_dpp v17, v19, v19 row_ror:8 row_mask:0xf bank_mask:0xc
    s_nop 0
    v_add_f32_dpp v16, v16, v16 row_half_mirror row_mask:0xf bank_mask:0x5
    s_nop 1
    v_add_f32_dpp v16, v17, v17 row_half_mirror row_mask:0xf bank_mask:0xa
    s_nop 1
    v_add_f32_dpp v16, v16, v16 quad_perm:[1,0,3,2] row_mask:0xf bank_mask:0xf
    s_nop 1
    v_add_f32_dpp v16, v16, v16 quad_perm:[2,3,0,1] row_mask:0xf bank_mask:0xf
    s_mov_b32 exec_lo, 0x11111111
    s_mov_b32 exec_hi, 0x11111111
    ds_write_b32 v5, v16 offset:0
    s_mov_b64 exec, -1
    v_and_b32 v5, 7, v1
    v_lshlrev_b32 v5, 4, v5
    s_waitcnt lgkmcnt(0)
    s_barrier
    ds_read_b128 v[16:19], v5 offset:0
    ds_read_b128 v[20:23], v5 offset:128
    s_waitcnt lgkmcnt(1)
    v_pk_add_f32 v[16:17], v[16:17], v[18:19]
    s_waitcnt lgkmcnt(0)
    v_pk_add_f32 v[20:21], v[20:21], v[22:23]
    v_add_f32 v16, v16, v17
    v_add_f32 v20, v20, v21
    v_mul_f32 v16, 0x3b124925, v16
    v_mul_f32 v20, 0x3b124925, v20
    v_fma_f32 v20, -v16, v16, v20
    v_max_f32_e64 v20, 0, v20
    v_cvt_pk_bf16_f32 v20, v20, v20
    v_lshlrev_b32_e64 v20, 16, v20
    v_add_f32 v20, 0x3727c5ac, v20
    v_cvt_pk_bf16_f32 v20, v20, v20
    v_lshlrev_b32 v20, 16, v20
    v_sqrt_f32_e64 v20, v20
    s_nop 0
    v_cvt_pk_bf16_f32 v16, v16, v20
    v_lshlrev_b32_e64 v17, 16, v16
    v_and_b32 v18, 0xffff0000, v16
    v_rcp_f32_e64 v18, v18
    v_readlane_b32 s72, v17, 0
    v_readlane_b32 s74, v17, 1
    v_readlane_b32 s76, v17, 2
    v_readlane_b32 s78, v17, 3
    v_readlane_b32 s80, v17, 4
    v_readlane_b32 s82, v17, 5
    v_readlane_b32 s84, v17, 6
    v_readlane_b32 s86, v17, 7
    v_readlane_b32 s73, v18, 0
    v_readlane_b32 s75, v18, 1
    v_readlane_b32 s77, v18, 2
    v_readlane_b32 s79, v18, 3
    v_readlane_b32 s81, v18, 4
    v_readlane_b32 s83, v18, 5
    v_readlane_b32 s85, v18, 6
    v_readlane_b32 s87, v18, 7
    s_mov_b32 exec_hi, 0x00ffffff
    v_lshlrev_b32_e64 v40, 16, v48
    v_and_b32 v41, 0xffff0000, v48
    v_pk_add_f32 v[40:41], v[40:41], s[72:73] op_sel:[0,0] op_sel_hi:[1,0] neg_lo:[0,1] neg_hi:[0,1]
    v_cvt_pk_bf16_f32 v48, v40, v41
    v_lshlrev_b32_e64 v40, 16, v48
    v_and_b32 v41, 0xffff0000, v48
    v_pk_mul_f32 v[40:41], v[40:41], s[72:73] op_sel:[0,1] op_sel_hi:[1,1]
    v_cvt_pk_bf16_f32 v48, v40, v41
    v_lshlrev_b32_e64 v42, 16, v49
    v_and_b32 v43, 0xffff0000, v49
    v_pk_add_f32 v[42:43], v[42:43], s[74:75] op_sel:[0,0] op_sel_hi:[1,0] neg_lo:[0,1] neg_hi:[0,1]
    v_cvt_pk_bf16_f32 v49, v42, v43
    v_lshlrev_b32_e64 v42, 16, v49
    v_and_b32 v43, 0xffff0000, v49
    v_pk_mul_f32 v[42:43], v[42:43], s[74:75] op_sel:[0,1] op_sel_hi:[1,1]
    v_cvt_pk_bf16_f32 v49, v42, v43
    v_lshlrev_b32_e64 v44, 16, v50
    v_and_b32 v45, 0xffff0000, v50
    v_pk_add_f32 v[44:45], v[44:45], s[76:77] op_sel:[0,0] op_sel_hi:[1,0] neg_lo:[0,1] neg_hi:[0,1]
    v_cvt_pk_bf16_f32 v50, v44, v45
    v_lshlrev_b32_e64 v44, 16, v50
    v_and_b32 v45, 0xffff0000, v50
    v_pk_mul_f32 v[44:45], v[44:45], s[76:77] op_sel:[0,1] op_sel_hi:[1,1]
    v_cvt_pk_bf16_f32 v50, v44, v45
    v_lshlrev_b32_e64 v46, 16, v51
    v_and_b32 v47, 0xffff0000, v51
    v_pk_add_f32 v[46:47], v[46:47], s[78:79] op_sel:[0,0] op_sel_hi:[1,0] neg_lo:[0,1] neg_hi:[0,1]
    v_cvt_pk_bf16_f32 v51, v46, v47
    v_lshlrev_b32_e64 v46, 16, v51
    v_and_b32 v47, 0xffff0000, v51
    v_pk_mul_f32 v[46:47], v[46:47], s[78:79] op_sel:[0,1] op_sel_hi:[1,1]
    v_cvt_pk_bf16_f32 v51, v46, v47
    v_lshlrev_b32_e64 v40, 16, v52
    v_and_b32 v41, 0xffff0000, v52
    v_pk_add_f32 v[40:41], v[40:41], s[80:81] op_sel:[0,0] op_sel_hi:[1,0] neg_lo:[0,1] neg_hi:[0,1]
    v_cvt_pk_bf16_f32 v52, v40, v41
    v_lshlrev_b32_e64 v40, 16, v52
    v_and_b32 v41, 0xffff0000, v52
    v_pk_mul_f32 v[40:41], v[40:41], s[80:81] op_sel:[0,1] op_sel_hi:[1,1]
    v_cvt_pk_bf16_f32 v52, v40, v41
    v_lshlrev_b32_e64 v42, 16, v53
    v_and_b32 v43, 0xffff0000, v53
    v_pk_add_f32 v[42:43], v[42:43], s[82:83] op_sel:[0,0] op_sel_hi:[1,0] neg_lo:[0,1] neg_hi:[0,1]
    v_cvt_pk_bf16_f32 v53, v42, v43
    v_lshlrev_b32_e64 v42, 16, v53
    v_and_b32 v43, 0xffff0000, v53
    v_pk_mul_f32 v[42:43], v[42:43], s[82:83] op_sel:[0,1] op_sel_hi:[1,1]
    v_cvt_pk_bf16_f32 v53, v42, v43
    v_lshlrev_b32_e64 v44, 16, v54
    v_and_b32 v45, 0xffff0000, v54
    v_pk_add_f32 v[44:45], v[44:45], s[84:85] op_sel:[0,0] op_sel_hi:[1,0] neg_lo:[0,1] neg_hi:[0,1]
    v_cvt_pk_bf16_f32 v54, v44, v45
    v_lshlrev_b32_e64 v44, 16, v54
    v_and_b32 v45, 0xffff0000, v54
    v_pk_mul_f32 v[44:45], v[44:45], s[84:85] op_sel:[0,1] op_sel_hi:[1,1]
    v_cvt_pk_bf16_f32 v54, v44, v45
    v_lshlrev_b32_e64 v46, 16, v55
    v_and_b32 v47, 0xffff0000, v55
    v_pk_add_f32 v[46:47], v[46:47], s[86:87] op_sel:[0,0] op_sel_hi:[1,0] neg_lo:[0,1] neg_hi:[0,1]
    v_cvt_pk_bf16_f32 v55, v46, v47
    v_lshlrev_b32_e64 v46, 16, v55
    v_and_b32 v47, 0xffff0000, v55
    v_pk_mul_f32 v[46:47], v[46:47], s[86:87] op_sel:[0,1] op_sel_hi:[1,1]
    v_cvt_pk_bf16_f32 v55, v46, v47
    s_mov_b32 exec_hi, -1
    s_nop 0
    s_mov_b32 s66, 0x3f803f80
    v_dot2_f32_bf16 v16, v48, s66, 0
    v_dot2_f32_bf16 v24, v48, v48, 0
    v_dot2_f32_bf16 v17, v49, s66, 0
    v_dot2_f32_bf16 v25, v49, v49, 0
    v_dot2_f32_bf16 v18, v50, s66, 0
    v_dot2_f32_bf16 v26, v50, v50, 0
    v_dot2_f32_bf16 v19, v51, s66, 0
    v_dot2_f32_bf16 v27, v51, v51, 0
    v_dot2_f32_bf16 v20, v52, s66, 0
    v_dot2_f32_bf16 v28, v52, v52, 0
    v_dot2_f32_bf16 v21, v53, s66, 0
    v_dot2_f32_bf16 v29, v53, v53, 0
    v_dot2_f32_bf16 v22, v54, s66, 0
    v_dot2_f32_bf16 v30, v54, v54, 0
    v_dot2_f32_bf16 v23, v55, s66, 0
    v_dot2_f32_bf16 v31, v55, v55, 0
    v_lshlrev_b32_e64 v5, 2, v1
    v_and_b32 v5, 0xf0, v5
    s_lshl_b32 s66, s28, 2
    v_add_u32 v5, s66, v5
    v_permlane32_swap_b32 v16, v24
    v_permlane32_swap_b32 v17, v25
    v_permlane32_swap_b32 v18, v26
    v_permlane32_swap_b32 v19, v27
    v_permlane32_swap_b32 v20, v28
    v_permlane32_swap_b32 v21, v29
    v_permlane32_swap_b32 v22, v30
    v_permlane32_swap_b32 v23, v31
    v_add_f32 v16, v16, v24
    v_add_f32 v17, v17, v25
    v_add_f32 v18, v18, v26
    v_add_f32 v19, v19, v27
    v_add_f32 v20, v20, v28
    v_add_f32 v21, v21, v29
    v_add_f32 v22, v22, v30
    v_add_f32 v23, v23, v31
    v_permlane16_swap_b32 v16, v20
    v_permlane16_swap_b32 v17, v21
    v_permlane16_swap_b32 v18, v22
    v_permlane16_swap_b32 v19, v23
    v_add_f32 v16, v16, v20
    v_add_f32 v17, v17, v21
    v_add_f32 v18, v18, v22
    v_add_f32 v19, v19, v23
    v_add_f32_dpp v16, v16, v16 row_ror:8 row_mask:0xf bank_mask:0x3
    v_add_f32_dpp v17, v17, v17 row_ror:8 row_mask:0xf bank_mask:0x3
    s_nop 0
    v_add_f32_dpp v16, v18, v18 row_ror:8 row_mask:0xf bank_mask:0xc
    v_add_f32_dpp v17, v19, v19 row_ror:8 row_mask:0xf bank_mask:0xc
    s_nop 0
    v_add_f32_dpp v16, v16, v16 row_half_mirror row_mask:0xf bank_mask:0x5
    s_nop 1
    v_add_f32_dpp v16, v17, v17 row_half_mirror row_mask:0xf bank_mask:0xa
    s_nop 1
    v_add_f32_dpp v16, v16, v16 quad_perm:[1,0,3,2] row_mask:0xf bank_mask:0xf
    s_nop 1
    v_add_f32_dpp v16, v16, v16 quad_perm:[2,3,0,1] row_mask:0xf bank_mask:0xf
    s_mov_b32 exec_lo, 0x11111111
    s_mov_b32 exec_hi, 0x11111111
    ds_write_b32 v5, v16 offset:256
    s_mov_b64 exec, -1
    v_and_b32 v5, 7, v1
    v_lshlrev_b32 v5, 4, v5
    s_waitcnt lgkmcnt(0)
    s_barrier
    ds_read_b128 v[16:19], v5 offset:256
    ds_read_b128 v[20:23], v5 offset:384
    s_waitcnt lgkmcnt(1)
    v_pk_add_f32 v[16:17], v[16:17], v[18:19]
    s_waitcnt lgkmcnt(0)
    v_pk_add_f32 v[20:21], v[20:21], v[22:23]
    v_add_f32 v16, v16, v17
    v_add_f32 v20, v20, v21
    v_mul_f32 v16, 0x3b124925, v16
    v_mul_f32 v20, 0x3b124925, v20
    v_fma_f32 v20, -v16, v16, v20
    v_max_f32_e64 v20, 0, v20
    v_cvt_pk_bf16_f32 v20, v20, v20
    v_lshlrev_b32_e64 v20, 16, v20
    v_add_f32 v20, 0x3727c5ac, v20
    v_cvt_pk_bf16_f32 v20, v20, v20
    v_lshlrev_b32 v20, 16, v20
    v_sqrt_f32_e64 v20, v20
    s_nop 0
    v_cvt_pk_bf16_f32 v16, v16, v20
    v_lshlrev_b32_e64 v17, 16, v16
    v_and_b32 v18, 0xffff0000, v16
    v_rcp_f32_e64 v18, v18
    v_readlane_b32 s72, v17, 0
    v_readlane_b32 s74, v17, 1
    v_readlane_b32 s76, v17, 2
    v_readlane_b32 s78, v17, 3
    v_readlane_b32 s80, v17, 4
    v_readlane_b32 s82, v17, 5
    v_readlane_b32 s84, v17, 6
    v_readlane_b32 s86, v17, 7
    v_readlane_b32 s73, v18, 0
    v_readlane_b32 s75, v18, 1
    v_readlane_b32 s77, v18, 2
    v_readlane_b32 s79, v18, 3
    v_readlane_b32 s81, v18, 4
    v_readlane_b32 s83, v18, 5
    v_readlane_b32 s85, v18, 6
    v_readlane_b32 s87, v18, 7
    s_mul_i32 s66, s31, 7168
    s_mul_i32 s67, s28, 1792
    s_add_u32 s66, s66, s67
    s_add_u32 s66, s66, 4194304
    v_lshl_add_u32 v4, v1, 4, s66
    v_add_u32 v5, 448, v4
    v_cmp_gt_u32 vcc, 28, v1
    s_nop 1
    v_cndmask_b32 v4, v5, v4, vcc
    v_mov_b32 v5, 1073741824
    v_cmp_gt_u32 vcc, 56, v1
    s_nop 1
    v_cndmask_b32 v4, v5, v4, vcc
    v_lshlrev_b32_e64 v64, 16, v48
    v_and_b32 v65, 0xffff0000, v48
    v_pk_add_f32 v[64:65], v[64:65], s[72:73] op_sel:[0,0] op_sel_hi:[1,0] neg_lo:[0,1] neg_hi:[0,1]
    v_cvt_pk_bf16_f32 v48, v64, v65
    v_lshlrev_b32_e64 v64, 16, v48
    v_and_b32 v65, 0xffff0000, v48
    v_pk_mul_f32 v[64:65], v[64:65], s[72:73] op_sel:[0,1] op_sel_hi:[1,1]
    v_lshlrev_b32_e64 v66, 16, v49
    v_and_b32 v67, 0xffff0000, v49
    v_pk_add_f32 v[66:67], v[66:67], s[74:75] op_sel:[0,0] op_sel_hi:[1,0] neg_lo:[0,1] neg_hi:[0,1]
    v_cvt_pk_bf16_f32 v49, v66, v67
    v_lshlrev_b32_e64 v66, 16, v49
    v_and_b32 v67, 0xffff0000, v49
    v_pk_mul_f32 v[66:67], v[66:67], s[74:75] op_sel:[0,1] op_sel_hi:[1,1]
    v_lshlrev_b32_e64 v68, 16, v50
    v_and_b32 v69, 0xffff0000, v50
    v_pk_add_f32 v[68:69], v[68:69], s[76:77] op_sel:[0,0] op_sel_hi:[1,0] neg_lo:[0,1] neg_hi:[0,1]
    v_cvt_pk_bf16_f32 v50, v68, v69
    v_lshlrev_b32_e64 v68, 16, v50
    v_and_b32 v69, 0xffff0000, v50
    v_pk_mul_f32 v[68:69], v[68:69], s[76:77] op_sel:[0,1] op_sel_hi:[1,1]
    v_lshlrev_b32_e64 v70, 16, v51
    v_and_b32 v71, 0xffff0000, v51
    v_pk_add_f32 v[70:71], v[70:71], s[78:79] op_sel:[0,0] op_sel_hi:[1,0] neg_lo:[0,1] neg_hi:[0,1]
    v_cvt_pk_bf16_f32 v51, v70, v71
    v_lshlrev_b32_e64 v70, 16, v51
    v_and_b32 v71, 0xffff0000, v51
    v_pk_mul_f32 v[70:71], v[70:71], s[78:79] op_sel:[0,1] op_sel_hi:[1,1]
    v_lshlrev_b32_e64 v72, 16, v52
    v_and_b32 v73, 0xffff0000, v52
    v_pk_add_f32 v[72:73], v[72:73], s[80:81] op_sel:[0,0] op_sel_hi:[1,0] neg_lo:[0,1] neg_hi:[0,1]
    v_cvt_pk_bf16_f32 v52, v72, v73
    v_lshlrev_b32_e64 v72, 16, v52
    v_and_b32 v73, 0xffff0000, v52
    v_pk_mul_f32 v[72:73], v[72:73], s[80:81] op_sel:[0,1] op_sel_hi:[1,1]
    v_lshlrev_b32_e64 v74, 16, v53
    v_and_b32 v75, 0xffff0000, v53
    v_pk_add_f32 v[74:75], v[74:75], s[82:83] op_sel:[0,0] op_sel_hi:[1,0] neg_lo:[0,1] neg_hi:[0,1]
    v_cvt_pk_bf16_f32 v53, v74, v75
    v_lshlrev_b32_e64 v74, 16, v53
    v_and_b32 v75, 0xffff0000, v53
    v_pk_mul_f32 v[74:75], v[74:75], s[82:83] op_sel:[0,1] op_sel_hi:[1,1]
    v_lshlrev_b32_e64 v76, 16, v54
    v_and_b32 v77, 0xffff0000, v54
    v_pk_add_f32 v[76:77], v[76:77], s[84:85] op_sel:[0,0] op_sel_hi:[1,0] neg_lo:[0,1] neg_hi:[0,1]
    v_cvt_pk_bf16_f32 v54, v76, v77
    v_lshlrev_b32_e64 v76, 16, v54
    v_and_b32 v77, 0xffff0000, v54
    v_pk_mul_f32 v[76:77], v[76:77], s[84:85] op_sel:[0,1] op_sel_hi:[1,1]
    v_lshlrev_b32_e64 v78, 16, v55
    v_and_b32 v79, 0xffff0000, v55
    v_pk_add_f32 v[78:79], v[78:79], s[86:87] op_sel:[0,0] op_sel_hi:[1,0] neg_lo:[0,1] neg_hi:[0,1]
    v_cvt_pk_bf16_f32 v55, v78, v79
    v_lshlrev_b32_e64 v78, 16, v55
    v_and_b32 v79, 0xffff0000, v55
    v_pk_mul_f32 v[78:79], v[78:79], s[86:87] op_sel:[0,1] op_sel_hi:[1,1]
    v_cvt_pk_bf16_f32 v80, v64, v66
    v_cvt_pk_bf16_f32 v84, v65, v67
    v_cvt_pk_bf16_f32 v81, v68, v70
    v_cvt_pk_bf16_f32 v85, v69, v71
    v_cvt_pk_bf16_f32 v82, v72, v74
    v_cvt_pk_bf16_f32 v86, v73, v75
    v_cvt_pk_bf16_f32 v83, v76, v78
    v_cvt_pk_bf16_f32 v87, v77, v79
    s_waitcnt vmcnt(0)
    buffer_store_dwordx4 v[80:83], v4, s[4:7], 0 offen sc1
    buffer_store_dwordx4 v[84:87], v4, s[4:7], 0 offen offset:448 sc1
    s_mov_b32 s20, s60
    s_and_b32 s21, s61, 0xffff
    s_mov_b32 s22, 1835008
    s_mov_b32 s23, 0x00020000
    s_mov_b32 s24, s58
    s_and_b32 s25, s59, 0xffff
    s_mov_b32 s26, 4096
    s_mov_b32 s27, 0x00020000
    v_lshrrev_b32 v4, 3, v1
    v_and_b32 v5, 7, v1
    s_lshl_b32 s66, s28, 4
    v_add_u32 v4, s66, v4
    s_lshl_b32 s67, s35, 6
    v_add_u32_e64 v7, s67, v4
    v_mul_u32_u24 v210, 896, v7
    v_lshl_add_u32 v210, v5, 4, v210
    s_mul_i32 s70, s33, 112
    v_add_u32 v210, s70, v210
    v_mov_b32_e64 v6, 1073741824
    v_cmp_gt_u32 vcc, 7, v5
    s_nop 1
    v_cndmask_b32 v210, v6, v210, vcc
    v_add_u32 v211, 2097152, v210
    v_lshlrev_b32 v212, 1, v7
    s_cmp_ge_u32 s30, 28
    s_cbranch_scc1 noconv_4
    s_lshl_b32 s67, s34, 7
    s_lshl_b32 s70, s28, 5
    s_add_u32 s67, s67, s70
    s_load_dwordx8 s[72:79], s[54:55], s67
    ds_read_b64_tr_b16 a[96:97], v248 offset:0
    ds_read_b64_tr_b16 a[98:99], v248 offset:512
    ds_read_b64_tr_b16 a[100:101], v249 offset:0
    ds_read_b64_tr_b16 a[102:103], v249 offset:512
    ds_read_b64_tr_b16 a[104:105], v250 offset:0
    ds_read_b64_tr_b16 a[106:107], v250 offset:512
    ds_read_b64_tr_b16 a[108:109], v251 offset:0
    ds_read_b64_tr_b16 a[110:111], v251 offset:512
    ds_read_b64_tr_b16 a[112:113], v248 offset:4096
    ds_read_b64_tr_b16 a[114:115], v248 offset:4608
    ds_read_b64_tr_b16 a[116:117], v249 offset:4096
    ds_read_b64_tr_b16 a[118:119], v249 offset:4608
    ds_read_b64_tr_b16 a[120:121], v250 offset:4096
    ds_read_b64_tr_b16 a[122:123], v250 offset:4608
    ds_read_b64_tr_b16 a[124:125], v251 offset:4096
    ds_read_b64_tr_b16 a[126:127], v251 offset:4608
    ds_read_b64_tr_b16 a[128:129], v248 offset:8192
    ds_read_b64_tr_b16 a[130:131], v248 offset:8704
    ds_read_b64_tr_b16 a[132:133], v249 offset:8192
    ds_read_b64_tr_b16 a[134:135], v249 offset:8704
    ds_read_b64_tr_b16 a[136:137], v250 offset:8192
    ds_read_b64_tr_b16 a[138:139], v250 offset:8704
    ds_read_b64_tr_b16 a[140:141], v251 offset:8192
    ds_read_b64_tr_b16 a[142:143], v251 offset:8704
    ds_read_b64_tr_b16 a[144:145], v248 offset:12288
    ds_read_b64_tr_b16 a[146:147], v248 offset:12800
    ds_read_b64_tr_b16 a[148:149], v249 offset:12288
    ds_read_b64_tr_b16 a[150:151], v249 offset:12800
    ds_read_b64_tr_b16 a[152:153], v250 offset:12288
    ds_read_b64_tr_b16 a[154:155], v250 offset:12800
    ds_read_b64_tr_b16 a[156:157], v251 offset:12288
    ds_read_b64_tr_b16 a[158:159], v251 offset:12800
    ds_read_b64_tr_b16 a[160:161], v248 offset:16384
    ds_read_b64_tr_b16 a[162:163], v248 offset:16896
    ds_read_b64_tr_b16 a[164:165], v249 offset:16384
    ds_read_b64_tr_b16 a[166:167], v249 offset:16896
    ds_read_b64_tr_b16 a[168:169], v250 offset:16384
    ds_read_b64_tr_b16 a[170:171], v250 offset:16896
    ds_read_b64_tr_b16 a[172:173], v251 offset:16384
    ds_read_b64_tr_b16 a[174:175], v251 offset:16896
    ds_read_b64_tr_b16 a[176:177], v244 offset:0
    ds_read_b64_tr_b16 a[178:179], v244 offset:512
    ds_read_b64_tr_b16 a[180:181], v245 offset:0
    ds_read_b64_tr_b16 a[182:183], v245 offset:512
    ds_read_b64_tr_b16 a[184:185], v246 offset:0
    ds_read_b64_tr_b16 a[186:187], v246 offset:512
    ds_read_b64_tr_b16 a[188:189], v247 offset:0
    ds_read_b64_tr_b16 a[190:191], v247 offset:512
    ds_read_b64_tr_b16 a[192:193], v244 offset:4096
    ds_read_b64_tr_b16 a[194:195], v244 offset:4608
    ds_read_b64_tr_b16 a[196:197], v245 offset:4096
    ds_read_b64_tr_b16 a[198:199], v245 offset:4608
    ds_read_b64_tr_b16 a[200:201], v246 offset:4096
    ds_read_b64_tr_b16 a[202:203], v246 offset:4608
    ds_read_b64_tr_b16 a[204:205], v247 offset:4096
    ds_read_b64_tr_b16 a[206:207], v247 offset:4608
    ds_read_b64_tr_b16 a[208:209], v244 offset:8192
    ds_read_b64_tr_b16 a[210:211], v244 offset:8704
    ds_read_b64_tr_b16 a[212:213], v245 offset:8192
    ds_read_b64_tr_b16 a[214:215], v245 offset:8704
    ds_read_b64_tr_b16 a[216:217], v246 offset:8192
    ds_read_b64_tr_b16 a[218:219], v246 offset:8704
    ds_read_b64_tr_b16 a[220:221], v247 offset:8192
    ds_read_b64_tr_b16 a[222:223], v247 offset:8704
    ds_read_b64_tr_b16 a[224:225], v244 offset:12288
    ds_read_b64_tr_b16 a[226:227], v244 offset:12800
    ds_read_b64_tr_b16 a[228:229], v245 offset:12288
    ds_read_b64_tr_b16 a[230:231], v245 offset:12800
    ds_read_b64_tr_b16 a[232:233], v246 offset:12288
    ds_read_b64_tr_b16 a[234:235], v246 offset:12800
    ds_read_b64_tr_b16 a[236:237], v247 offset:12288
    ds_read_b64_tr_b16 a[238:239], v247 offset:12800
    s_waitcnt lgkmcnt(0)
    s_add_u32 s70, s38, 1720320
    s_cmp_ge_u32 s70, 1835008
    s_cselect_b32 s71, 1835008, 0
    s_sub_u32 s70, s70, s71
    s_add_u32 m0, s50, 0
    s_nop 0
    buffer_load_dwordx4 v224, s[12:15], s70 offen offset:0 lds
    buffer_load_dwordx4 v225, s[12:15], s70 offen offset:1024 lds
    buffer_load_dwordx4 v226, s[12:15], s70 offen offset:2048 lds
    buffer_load_dwordx4 v227, s[12:15], s70 offen offset:3072 lds
    s_add_u32 s70, s40, 0
    s_cmp_ge_u32 s70, 1835008
    s_cselect_b32 s71, 1835008, 0
    s_sub_u32 s70, s70, s71
    s_add_u32 m0, s51, 0
    s_nop 0
    buffer_load_dwordx4 v228, s[16:19], s70 offen offset:0 lds
    buffer_load_dwordx4 v229, s[16:19], s70 offen offset:1024 lds
    buffer_load_dwordx4 v230, s[16:19], s70 offen offset:2048 lds
    buffer_load_dwordx4 v231, s[16:19], s70 offen offset:3072 lds
    s_add_u32 s70, s40, 131072
    s_cmp_ge_u32 s70, 1835008
    s_cselect_b32 s71, 1835008, 0
    s_sub_u32 s70, s70, s71
    s_add_u32 m0, s51, 4096
    s_nop 0
    buffer_load_dwordx4 v228, s[16:19], s70 offen offset:0 lds
    buffer_load_dwordx4 v229, s[16:19], s70 offen offset:1024 lds
    buffer_load_dwordx4 v230, s[16:19], s70 offen offset:2048 lds
    buffer_load_dwordx4 v231, s[16:19], s70 offen offset:3072 lds
    s_add_u32 s70, s40, 262144
    s_cmp_ge_u32 s70, 1835008
    s_cselect_b32 s71, 1835008, 0
    s_sub_u32 s70, s70, s71
    s_add_u32 m0, s51, 8192
    s_nop 0
    buffer_load_dwordx4 v228, s[16:19], s70 offen offset:0 lds
    buffer_load_dwordx4 v229, s[16:19], s70 offen offset:1024 lds
    buffer_load_dwordx4 v230, s[16:19], s70 offen offset:2048 lds
    buffer_load_dwordx4 v231, s[16:19], s70 offen offset:3072 lds
    s_add_u32 s70, s40, 393216
    s_cmp_ge_u32 s70, 1835008
    s_cselect_b32 s71, 1835008, 0
    s_sub_u32 s70, s70, s71
    s_add_u32 m0, s51, 12288
    s_nop 0
    buffer_load_dwordx4 v228, s[16:19], s70 offen offset:0 lds
    buffer_load_dwordx4 v229, s[16:19], s70 offen offset:1024 lds
    buffer_load_dwordx4 v230, s[16:19], s70 offen offset:2048 lds
    buffer_load_dwordx4 v231, s[16:19], s70 offen offset:3072 lds
    s_add_u32 s70, s40, 524288
    s_cmp_ge_u32 s70, 1835008
    s_cselect_b32 s71, 1835008, 0
    s_sub_u32 s70, s70, s71
    s_add_u32 m0, s51, 16384
    s_nop 0
    buffer_load_dwordx4 v228, s[16:19], s70 offen offset:0 lds
    buffer_load_dwordx4 v229, s[16:19], s70 offen offset:1024 lds
    buffer_load_dwordx4 v230, s[16:19], s70 offen offset:2048 lds
    buffer_load_dwordx4 v231, s[16:19], s70 offen offset:3072 lds
    s_mul_i32 s66, s28, 458752
    s_mul_i32 s67, s33, 896
    s_add_u32 s66, s66, s67
    s_add_u32 s66, s66, 4194304
    v_lshrrev_b32 v4, 4, v1
    v_mul_u32_u24 v4, 7168, v4
    v_add_u32 v4, s66, v4
    v_and_b32 v5, 15, v1
    v_lshl_add_u32 v208, v5, 4, v4
    v_add_u32 v209, 768, v208
    v_mov_b32_e64 v4, 1073741824
    v_cmp_gt_u32 vcc, 8, v5
    s_nop 1
    v_cndmask_b32 v209, v4, v209, vcc
    s_add_u32 s70, s39, 0
    s_cmp_ge_u32 s70, 458752
    s_cselect_b32 s71, 458752, 0
    s_sub_u32 s70, s70, s71
    s_nop 0
    buffer_load_dwordx4 v[80:83], v208, s[4:7], s70 offen offset:0 sc1
    buffer_load_dwordx4 v[84:87], v208, s[4:7], s70 offen offset:256 sc1
    buffer_load_dwordx4 v[88:91], v208, s[4:7], s70 offen offset:512 sc1
    buffer_load_dwordx4 v[92:95], v209, s[4:7], s70 offen sc1
    s_add_u32 s70, s39, 28672
    s_cmp_ge_u32 s70, 458752
    s_cselect_b32 s71, 458752, 0
    s_sub_u32 s70, s70, s71
    s_nop 0
    buffer_load_dwordx4 v[96:99], v208, s[4:7], s70 offen offset:0 sc1
    buffer_load_dwordx4 v[100:103], v208, s[4:7], s70 offen offset:256 sc1
    buffer_load_dwordx4 v[104:107], v208, s[4:7], s70 offen offset:512 sc1
    buffer_load_dwordx4 v[108:111], v209, s[4:7], s70 offen sc1
    s_add_u32 s70, s39, 57344
    s_cmp_ge_u32 s70, 458752
    s_cselect_b32 s71, 458752, 0
    s_sub_u32 s70, s70, s71
    buffer_load_dwordx4 v[112:115], v208, s[4:7], s70 offen offset:0 sc1
    buffer_load_dwordx4 v[116:119], v208, s[4:7], s70 offen offset:256 sc1
    buffer_load_dwordx4 v[120:123], v208, s[4:7], s70 offen offset:512 sc1
    buffer_load_dwordx4 v[124:127], v209, s[4:7], s70 offen sc1
    s_waitcnt vmcnt(32)
    ds_read_b64_tr_b16 a[240:241], v244 offset:0
    ds_read_b64_tr_b16 a[242:243], v244 offset:512
    ds_read_b64_tr_b16 a[244:245], v245 offset:0
    ds_read_b64_tr_b16 a[246:247], v245 offset:512
    ds_read_b64_tr_b16 a[248:249], v246 offset:0
    ds_read_b64_tr_b16 a[250:251], v246 offset:512
    ds_read_b64_tr_b16 a[252:253], v247 offset:0
    ds_read_b64_tr_b16 a[254:255], v247 offset:512
    s_waitcnt lgkmcnt(0)
    s_barrier
    s_waitcnt vmcnt(8)
    s_add_u32 s70, s39, 86016
    s_cmp_ge_u32 s70, 458752
    s_cselect_b32 s71, 458752, 0
    s_sub_u32 s70, s70, s71
    buffer_load_dwordx4 v[128:131], v208, s[4:7], s70 offen offset:0 sc1
    buffer_load_dwordx4 v[132:135], v208, s[4:7], s70 offen offset:256 sc1
    buffer_load_dwordx4 v[136:139], v208, s[4:7], s70 offen offset:512 sc1
    buffer_load_dwordx4 v[140:143], v209, s[4:7], s70 offen sc1
    v_max3_u32 v214, v80, v81, v82
    v_max3_u32 v214, v214, v83, v84
    v_max3_u32 v214, v214, v85, v86
    v_max3_u32 v214, v214, v87, v88
    v_max3_u32 v214, v214, v89, v90
    v_max3_u32 v214, v214, v91, v92
    v_max3_u32 v214, v214, v93, v94
    v_max_u32 v214, v214, v95
    v_cmp_eq_u32 vcc, -1, v214
    s_nop 3
    s_cbranch_vccnz slow_24
back_25:
    v_mfma_f32_16x16x32_bf16 v[16:19], a[0:3], v[80:83], 0
    v_mfma_f32_16x16x32_bf16 v[20:23], a[0:3], v[84:87], 0
    v_mfma_f32_16x16x32_bf16 v[24:27], a[0:3], v[88:91], 0
    v_mfma_f32_16x16x32_bf16 v[28:31], a[0:3], v[92:95], 0
    v_mfma_f32_16x16x32_bf16 v[32:35], a[4:7], v[80:83], 0
    v_mfma_f32_16x16x32_bf16 v[36:39], a[4:7], v[84:87], 0
    v_mfma_f32_16x16x32_bf16 v[40:43], a[4:7], v[88:91], 0
    v_mfma_f32_16x16x32_bf16 v[44:47], a[4:7], v[92:95], 0
    s_waitcnt vmcnt(8)
    s_nop 0
    v_mfma_f32_16x16x32_bf16 v[48:51], a[8:11], v[80:83], 0
    s_add_u32 s70, s39, 114688
    s_cmp_ge_u32 s70, 458752
    s_cselect_b32 s71, 458752, 0
    v_mfma_f32_16x16x32_bf16 v[52:55], a[8:11], v[84:87], 0
    s_sub_u32 s70, s70, s71
    s_nop 0
    buffer_load_dwordx4 v[144:147], v208, s[4:7], s70 offen offset:0 sc1
    buffer_load_dwordx4 v[148:151], v208, s[4:7], s70 offen offset:256 sc1
    v_mfma_f32_16x16x32_bf16 v[56:59], a[8:11], v[88:91], 0
    buffer_load_dwordx4 v[152:155], v208, s[4:7], s70 offen offset:512 sc1
    buffer_load_dwordx4 v[156:159], v209, s[4:7], s70 offen sc1
    v_max3_u32 v214, v96, v97, v98
    v_mfma_f32_16x16x32_bf16 v[60:63], a[8:11], v[92:95], 0
    v_max3_u32 v214, v214, v99, v100
    v_max3_u32 v214, v214, v101, v102
    v_max3_u32 v214, v214, v103, v104
    v_mfma_f32_16x16x32_bf16 v[64:67], a[12:15], v[80:83], 0
    v_max3_u32 v214, v214, v105, v106
    v_max3_u32 v214, v214, v107, v108
    v_max3_u32 v214, v214, v109, v110
    v_mfma_f32_16x16x32_bf16 v[68:71], a[12:15], v[84:87], 0
    v_max_u32 v214, v214, v111
    v_cmp_eq_u32 vcc, -1, v214
    v_mfma_f32_16x16x32_bf16 v[72:75], a[12:15], v[88:91], 0
    v_mfma_f32_16x16x32_bf16 v[76:79], a[12:15], v[92:95], 0
    s_nop 1
    s_cbranch_vccnz slow_27
back_28:
    v_mfma_f32_16x16x32_bf16 v[16:19], a[16:19], v[96:99], v[16:19]
    v_mfma_f32_16x16x32_bf16 v[20:23], a[16:19], v[100:103], v[20:23]
    v_mfma_f32_16x16x32_bf16 v[24:27], a[16:19], v[104:107], v[24:27]
    v_mfma_f32_16x16x32_bf16 v[28:31], a[16:19], v[108:111], v[28:31]
    v_mfma_f32_16x16x32_bf16 v[32:35], a[20:23], v[96:99], v[32:35]
    v_mfma_f32_16x16x32_bf16 v[36:39], a[20:23], v[100:103], v[36:39]
    v_mfma_f32_16x16x32_bf16 v[40:43], a[20:23], v[104:107], v[40:43]
    v_mfma_f32_16x16x32_bf16 v[44:47], a[20:23], v[108:111], v[44:47]
    s_waitcnt vmcnt(8)
    s_nop 0
    v_mfma_f32_16x16x32_bf16 v[48:51], a[24:27], v[96:99], v[48:51]
    s_add_u32 s70, s39, 143360
    s_cmp_ge_u32 s70, 458752
    s_cselect_b32 s71, 458752, 0
    v_mfma_f32_16x16x32_bf16 v[52:55], a[24:27], v[100:103], v[52:55]
    s_sub_u32 s70, s70, s71
    s_nop 0
    buffer_load_dwordx4 v[160:163], v208, s[4:7], s70 offen offset:0 sc1
    buffer_load_dwordx4 v[164:167], v208, s[4:7], s70 offen offset:256 sc1
    v_mfma_f32_16x16x32_bf16 v[56:59], a[24:27], v[104:107], v[56:59]
    buffer_load_dwordx4 v[168:171], v208, s[4:7], s70 offen offset:512 sc1
    buffer_load_dwordx4 v[172:175], v209, s[4:7], s70 offen sc1
    v_max3_u32 v214, v112, v113, v114
    v_mfma_f32_16x16x32_bf16 v[60:63], a[24:27], v[108:111], v[60:63]
    v_max3_u32 v214, v214, v115, v116
    v_max3_u32 v214, v214, v117, v118
    v_max3_u32 v214, v214, v119, v120
    v_mfma_f32_16x16x32_bf16 v[64:67], a[28:31], v[96:99], v[64:67]
    v_max3_u32 v214, v214, v121, v122
    v_max3_u32 v214, v214, v123, v124
    v_max3_u32 v214, v214, v125, v126
    v_mfma_f32_16x16x32_bf16 v[68:71], a[28:31], v[100:103], v[68:71]
    v_max_u32 v214, v214, v127
    v_cmp_eq_u32 vcc, -1, v214
    v_mfma_f32_16x16x32_bf16 v[72:75], a[28:31], v[104:107], v[72:75]
    v_mfma_f32_16x16x32_bf16 v[76:79], a[28:31], v[108:111], v[76:79]
    s_nop 1
    s_cbranch_vccnz slow_30
back_31:
    v_mfma_f32_16x16x32_bf16 v[16:19], a[32:35], v[112:115], v[16:19]
    v_mfma_f32_16x16x32_bf16 v[20:23], a[32:35], v[116:119], v[20:23]
    v_mfma_f32_16x16x32_bf16 v[24:27], a[32:35], v[120:123], v[24:27]
    v_mfma_f32_16x16x32_bf16 v[28:31], a[32:35], v[124:127], v[28:31]
    v_mfma_f32_16x16x32_bf16 v[32:35], a[36:39], v[112:115], v[32:35]
    v_mfma_f32_16x16x32_bf16 v[36:39], a[36:39], v[116:119], v[36:39]
    v_mfma_f32_16x16x32_bf16 v[40:43], a[36:39], v[120:123], v[40:43]
    v_mfma_f32_16x16x32_bf16 v[44:47], a[36:39], v[124:127], v[44:47]
    s_waitcnt vmcnt(8)
    s_nop 0
    v_mfma_f32_16x16x32_bf16 v[48:51], a[40:43], v[112:115], v[48:51]
    s_add_u32 s70, s39, 172032
    s_cmp_ge_u32 s70, 458752
    s_cselect_b32 s71, 458752, 0
    v_mfma_f32_16x16x32_bf16 v[52:55], a[40:43], v[116:119], v[52:55]
    s_sub_u32 s70, s70, s71
    s_nop 0
    buffer_load_dwordx4 v[80:83], v208, s[4:7], s70 offen offset:0 sc1
    buffer_load_dwordx4 v[84:87], v208, s[4:7], s70 offen offset:256 sc1
    v_mfma_f32_16x16x32_bf16 v[56:59], a[40:43], v[120:123], v[56:59]
    buffer_load_dwordx4 v[88:91], v208, s[4:7], s70 offen offset:512 sc1
    buffer_load_dwordx4 v[92:95], v209, s[4:7], s70 offen sc1
    v_max3_u32 v214, v128, v129, v130
    v_mfma_f32_16x16x32_bf16 v[60:63], a[40:43], v[124:127], v[60:63]
    v_max3_u32 v214, v214, v131, v132
    v_max3_u32 v214, v214, v133, v134
    v_max3_u32 v214, v214, v135, v136
    v_mfma_f32_16x16x32_bf16 v[64:67], a[44:47], v[112:115], v[64:67]
    v_max3_u32 v214, v214, v137, v138
    v_max3_u32 v214, v214, v139, v140
    v_max3_u32 v214, v214, v141, v142
    v_mfma_f32_16x16x32_bf16 v[68:71], a[44:47], v[116:119], v[68:71]
    v_max_u32 v214, v214, v143
    v_cmp_eq_u32 vcc, -1, v214
    v_mfma_f32_16x16x32_bf16 v[72:75], a[44:47], v[120:123], v[72:75]
    v_mfma_f32_16x16x32_bf16 v[76:79], a[44:47], v[124:127], v[76:79]
    s_nop 1
    s_cbranch_vccnz slow_33
back_34:
    v_mfma_f32_16x16x32_bf16 v[16:19], a[48:51], v[128:131], v[16:19]
    v_mfma_f32_16x16x32_bf16 v[20:23], a[48:51], v[132:135], v[20:23]
    v_mfma_f32_16x16x32_bf16 v[24:27], a[48:51], v[136:139], v[24:27]
    v_mfma_f32_16x16x32_bf16 v[28:31], a[48:51], v[140:143], v[28:31]
    v_mfma_f32_16x16x32_bf16 v[32:35], a[52:55], v[128:131], v[32:35]
    v_mfma_f32_16x16x32_bf16 v[36:39], a[52:55], v[132:135], v[36:39]
    v_mfma_f32_16x16x32_bf16 v[40:43], a[52:55], v[136:139], v[40:43]
    v_mfma_f32_16x16x32_bf16 v[44:47], a[52:55], v[140:143], v[44:47]
    s_waitcnt vmcnt(8)
    s_nop 0
    v_mfma_f32_16x16x32_bf16 v[48:51], a[56:59], v[128:131], v[48:51]
    s_add_u32 s70, s39, 200704
    s_cmp_ge_u32 s70, 458752
    s_cselect_b32 s71, 458752, 0
    v_mfma_f32_16x16x32_bf16 v[52:55], a[56:59], v[132:135], v[52:55]
    s_sub_u32 s70, s70, s71
    s_nop 0
    buffer_load_dwordx4 v[96:99], v208, s[4:7], s70 offen offset:0 sc1
    buffer_load_dwordx4 v[100:103], v208, s[4:7], s70 offen offset:256 sc1
    v_mfma_f32_16x16x32_bf16 v[56:59], a[56:59], v[136:139], v[56:59]
    buffer_load_dwordx4 v[104:107], v208, s[4:7], s70 offen offset:512 sc1
    buffer_load_dwordx4 v[108:111], v209, s[4:7], s70 offen sc1
    v_max3_u32 v214, v144, v145, v146
    v_mfma_f32_16x16x32_bf16 v[60:63], a[56:59], v[140:143], v[60:63]
    v_max3_u32 v214, v214, v147, v148
    v_max3_u32 v214, v214, v149, v150
    v_max3_u32 v214, v214, v151, v152
    v_mfma_f32_16x16x32_bf16 v[64:67], a[60:63], v[128:131], v[64:67]
    v_max3_u32 v214, v214, v153, v154
    v_max3_u32 v214, v214, v155, v156
    v_max3_u32 v214, v214, v157, v158
    v_mfma_f32_16x16x32_bf16 v[68:71], a[60:63], v[132:135], v[68:71]
    v_max_u32 v214, v214, v159
    v_cmp_eq_u32 vcc, -1, v214
    v_mfma_f32_16x16x32_bf16 v[72:75], a[60:63], v[136:139], v[72:75]
    v_mfma_f32_16x16x32_bf16 v[76:79], a[60:63], v[140:143], v[76:79]
    s_nop 1
    s_cbranch_vccnz slow_36
back_37:
    v_mfma_f32_16x16x32_bf16 v[16:19], a[64:67], v[144:147], v[16:19]
    v_mfma_f32_16x16x32_bf16 v[20:23], a[64:67], v[148:151], v[20:23]
    v_mfma_f32_16x16x32_bf16 v[24:27], a[64:67], v[152:155], v[24:27]
    v_mfma_f32_16x16x32_bf16 v[28:31], a[64:67], v[156:159], v[28:31]
    v_mfma_f32_16x16x32_bf16 v[32:35], a[68:71], v[144:147], v[32:35]
    v_mfma_f32_16x16x32_bf16 v[36:39], a[68:71], v[148:151], v[36:39]
    v_mfma_f32_16x16x32_bf16 v[40:43], a[68:71], v[152:155], v[40:43]
    v_mfma_f32_16x16x32_bf16 v[44:47], a[68:71], v[156:159], v[44:47]
    s_waitcnt vmcnt(8)
    s_nop 0
    v_mfma_f32_16x16x32_bf16 v[48:51], a[72:75], v[144:147], v[48:51]
    s_add_u32 s70, s39, 229376
    s_cmp_ge_u32 s70, 458752
    s_cselect_b32 s71, 458752, 0
    v_mfma_f32_16x16x32_bf16 v[52:55], a[72:75], v[148:151], v[52:55]
    s_sub_u32 s70, s70, s71
    s_nop 0
    buffer_load_dwordx4 v[112:115], v208, s[4:7], s70 offen offset:0 sc1
    buffer_load_dwordx4 v[116:119], v208, s[4:7], s70 offen offset:256 sc1
    v_mfma_f32_16x16x32_bf16 v[56:59], a[72:75], v[152:155], v[56:59]
    buffer_load_dwordx4 v[120:123], v208, s[4:7], s70 offen offset:512 sc1
    buffer_load_dwordx4 v[124:127], v209, s[4:7], s70 offen sc1
    v_max3_u32 v214, v160, v161, v162
    v_mfma_f32_16x16x32_bf16 v[60:63], a[72:75], v[156:159], v[60:63]
    v_max3_u32 v214, v214, v163, v164
    v_max3_u32 v214, v214, v165, v166
    v_max3_u32 v214, v214, v167, v168
    v_mfma_f32_16x16x32_bf16 v[64:67], a[76:79], v[144:147], v[64:67]
    v_max3_u32 v214, v214, v169, v170
    v_max3_u32 v214, v214, v171, v172
    v_max3_u32 v214, v214, v173, v174
    v_mfma_f32_16x16x32_bf16 v[68:71], a[76:79], v[148:151], v[68:71]
    v_max_u32 v214, v214, v175
    v_cmp_eq_u32 vcc, -1, v214
    v_mfma_f32_16x16x32_bf16 v[72:75], a[76:79], v[152:155], v[72:75]
    v_mfma_f32_16x16x32_bf16 v[76:79], a[76:79], v[156:159], v[76:79]
    s_nop 1
    s_cbranch_vccnz slow_39
back_40:
    v_mfma_f32_16x16x32_bf16 v[16:19], a[80:83], v[160:163], v[16:19]
    v_mfma_f32_16x16x32_bf16 v[20:23], a[80:83], v[164:167], v[20:23]
    v_mfma_f32_16x16x32_bf16 v[24:27], a[80:83], v[168:171], v[24:27]
    v_mfma_f32_16x16x32_bf16 v[28:31], a[80:83], v[172:175], v[28:31]
    v_mfma_f32_16x16x32_bf16 v[32:35], a[84:87], v[160:163], v[32:35]
    v_mfma_f32_16x16x32_bf16 v[36:39], a[84:87], v[164:167], v[36:39]
    v_mfma_f32_16x16x32_bf16 v[40:43], a[84:87], v[168:171], v[40:43]
    v_mfma_f32_16x16x32_bf16 v[44:47], a[84:87], v[172:175], v[44:47]
    s_waitcnt vmcnt(8)
    v_mfma_f32_16x16x32_bf16 v[48:51], a[88:91], v[160:163], v[48:51]
    s_add_u32 s70, s39, 258048
    s_cmp_ge_u32 s70, 458752
    s_cselect_b32 s71, 458752, 0
    s_sub_u32 s70, s70, s71
    v_mfma_f32_16x16x32_bf16 v[52:55], a[88:91], v[164:167], v[52:55]
    buffer_load_dwordx4 v[128:131], v208, s[4:7], s70 offen offset:0 sc1
    buffer_load_dwordx4 v[132:135], v208, s[4:7], s70 offen offset:256 sc1
    buffer_load_dwordx4 v[136:139], v208, s[4:7], s70 offen offset:512 sc1
    buffer_load_dwordx4 v[140:143], v209, s[4:7], s70 offen sc1
    v_mfma_f32_16x16x32_bf16 v[56:59], a[88:91], v[168:171], v[56:59]
    ds_read_b64_tr_b16 a[0:1], v248 offset:0
    ds_read_b64_tr_b16 a[2:3], v248 offset:512
    ds_read_b64_tr_b16 a[4:5], v249 offset:0
    ds_read_b64_tr_b16 a[6:7], v249 offset:512
    v_mfma_f32_16x16x32_bf16 v[60:63], a[88:91], v[172:175], v[60:63]
    ds_read_b64_tr_b16 a[8:9], v250 offset:0
    ds_read_b64_tr_b16 a[10:11], v250 offset:512
    ds_read_b64_tr_b16 a[12:13], v251 offset:0
    ds_read_b64_tr_b16 a[14:15], v251 offset:512
    v_mfma_f32_16x16x32_bf16 v[64:67], a[92:95], v[160:163], v[64:67]
    v_max3_u32 v214, v80, v81, v82
    v_max3_u32 v214, v214, v83, v84
    v_max3_u32 v214, v214, v85, v86
    v_max3_u32 v214, v214, v87, v88
    v_mfma_f32_16x16x32_bf16 v[68:71], a[92:95], v[164:167], v[68:71]
    v_max3_u32 v214, v214, v89, v90
    v_max3_u32 v214, v214, v91, v92
    v_max3_u32 v214, v214, v93, v94
    v_max_u32_e64 v214, v214, v95
    v_mfma_f32_16x16x32_bf16 v[72:75], a[92:95], v[168:171], v[72:75]
    v_cmp_eq_u32 vcc, -1, v214
    v_mfma_f32_16x16x32_bf16 v[76:79], a[92:95], v[172:175], v[76:79]
    s_nop 2
    s_cbranch_vccnz slow_42
back_43:
    s_nop 0
    v_mfma_f32_16x16x32_bf16 v[16:19], a[96:99], v[80:83], v[16:19]
    v_mfma_f32_16x16x32_bf16 v[20:23], a[96:99], v[84:87], v[20:23]
    v_mfma_f32_16x16x32_bf16 v[24:27], a[96:99], v[88:91], v[24:27]
    v_mfma_f32_16x16x32_bf16 v[28:31], a[96:99], v[92:95], v[28:31]
    v_mfma_f32_16x16x32_bf16 v[32:35], a[100:103], v[80:83], v[32:35]
    v_mfma_f32_16x16x32_bf16 v[36:39], a[100:103], v[84:87], v[36:39]
    v_mfma_f32_16x16x32_bf16 v[40:43], a[100:103], v[88:91], v[40:43]
    v_mfma_f32_16x16x32_bf16 v[44:47], a[100:103], v[92:95], v[44:47]
    s_waitcnt vmcnt(8)
    v_mfma_f32_16x16x32_bf16 v[48:51], a[104:107], v[80:83], v[48:51]
    s_add_u32 s70, s39, 286720
    s_cmp_ge_u32 s70, 458752
    s_cselect_b32 s71, 458752, 0
    s_sub_u32 s70, s70, s71
    v_mfma_f32_16x16x32_bf16 v[52:55], a[104:107], v[84:87], v[52:55]
    buffer_load_dwordx4 v[144:147], v208, s[4:7], s70 offen offset:0 sc1
    buffer_load_dwordx4 v[148:151], v208, s[4:7], s70 offen offset:256 sc1
    buffer_load_dwordx4 v[152:155], v208, s[4:7], s70 offen offset:512 sc1
    buffer_load_dwordx4 v[156:159], v209, s[4:7], s70 offen sc1
    v_mfma_f32_16x16x32_bf16 v[56:59], a[104:107], v[88:91], v[56:59]
    ds_read_b64_tr_b16 a[16:17], v248 offset:4096
    ds_read_b64_tr_b16 a[18:19], v248 offset:4608
    ds_read_b64_tr_b16 a[20:21], v249 offset:4096
    ds_read_b64_tr_b16 a[22:23], v249 offset:4608
    v_mfma_f32_16x16x32_bf16 v[60:63], a[104:107], v[92:95], v[60:63]
    ds_read_b64_tr_b16 a[24:25], v250 offset:4096
    ds_read_b64_tr_b16 a[26:27], v250 offset:4608
    ds_read_b64_tr_b16 a[28:29], v251 offset:4096
    ds_read_b64_tr_b16 a[30:31], v251 offset:4608
    v_mfma_f32_16x16x32_bf16 v[64:67], a[108:111], v[80:83], v[64:67]
    v_max3_u32 v214, v96, v97, v98
    v_max3_u32 v214, v214, v99, v100
    v_max3_u32 v214, v214, v101, v102
    v_max3_u32 v214, v214, v103, v104
    v_mfma_f32_16x16x32_bf16 v[68:71], a[108:111], v[84:87], v[68:71]
    v_max3_u32 v214, v214, v105, v106
    v_max3_u32 v214, v214, v107, v108
    v_max3_u32 v214, v214, v109, v110
    v_max_u32_e64 v214, v214, v111
    v_mfma_f32_16x16x32_bf16 v[72:75], a[108:111], v[88:91], v[72:75]
    v_cmp_eq_u32 vcc, -1, v214
    v_mfma_f32_16x16x32_bf16 v[76:79], a[108:111], v[92:95], v[76:79]
    s_nop 2
    s_cbranch_vccnz slow_45
back_46:
    s_nop 0
    v_mfma_f32_16x16x32_bf16 v[16:19], a[112:115], v[96:99], v[16:19]
    v_mfma_f32_16x16x32_bf16 v[20:23], a[112:115], v[100:103], v[20:23]
    v_mfma_f32_16x16x32_bf16 v[24:27], a[112:115], v[104:107], v[24:27]
    v_mfma_f32_16x16x32_bf16 v[28:31], a[112:115], v[108:111], v[28:31]
    v_mfma_f32_16x16x32_bf16 v[32:35], a[116:119], v[96:99], v[32:35]
    v_mfma_f32_16x16x32_bf16 v[36:39], a[116:119], v[100:103], v[36:39]
    v_mfma_f32_16x16x32_bf16 v[40:43], a[116:119], v[104:107], v[40:43]
    v_mfma_f32_16x16x32_bf16 v[44:47], a[116:119], v[108:111], v[44:47]
    s_waitcnt vmcnt(8)
    v_mfma_f32_16x16x32_bf16 v[48:51], a[120:123], v[96:99], v[48:51]
    s_add_u32 s70, s39, 315392
    s_cmp_ge_u32 s70, 458752
    s_cselect_b32 s71, 458752, 0
    s_sub_u32 s70, s70, s71
    v_mfma_f32_16x16x32_bf16 v[52:55], a[120:123], v[100:103], v[52:55]
    buffer_load_dwordx4 v[160:163], v208, s[4:7], s70 offen offset:0 sc1
    buffer_load_dwordx4 v[164:167], v208, s[4:7], s70 offen offset:256 sc1
    buffer_load_dwordx4 v[168:171], v208, s[4:7], s70 offen offset:512 sc1
    buffer_load_dwordx4 v[172:175], v209, s[4:7], s70 offen sc1
    v_mfma_f32_16x16x32_bf16 v[56:59], a[120:123], v[104:107], v[56:59]
    ds_read_b64_tr_b16 a[32:33], v248 offset:8192
    ds_read_b64_tr_b16 a[34:35], v248 offset:8704
    ds_read_b64_tr_b16 a[36:37], v249 offset:8192
    ds_read_b64_tr_b16 a[38:39], v249 offset:8704
    v_mfma_f32_16x16x32_bf16 v[60:63], a[120:123], v[108:111], v[60:63]
    ds_read_b64_tr_b16 a[40:41], v250 offset:8192
    ds_read_b64_tr_b16 a[42:43], v250 offset:8704
    ds_read_b64_tr_b16 a[44:45], v251 offset:8192
    ds_read_b64_tr_b16 a[46:47], v251 offset:8704
    v_mfma_f32_16x16x32_bf16 v[64:67], a[124:127], v[96:99], v[64:67]
    v_max3_u32 v214, v112, v113, v114
    v_max3_u32 v214, v214, v115, v116
    v_max3_u32 v214, v214, v117, v118
    v_max3_u32 v214, v214, v119, v120
    v_mfma_f32_16x16x32_bf16 v[68:71], a[124:127], v[100:103], v[68:71]
    v_max3_u32 v214, v214, v121, v122
    v_max3_u32 v214, v214, v123, v124
    v_max3_u32 v214, v214, v125, v126
    v_max_u32_e64 v214, v214, v127
    v_mfma_f32_16x16x32_bf16 v[72:75], a[124:127], v[104:107], v[72:75]
    v_cmp_eq_u32 vcc, -1, v214
    v_mfma_f32_16x16x32_bf16 v[76:79], a[124:127], v[108:111], v[76:79]
    s_nop 2
    s_cbranch_vccnz slow_48
back_49:
    s_nop 0
    v_mfma_f32_16x16x32_bf16 v[16:19], a[128:131], v[112:115], v[16:19]
    v_mfma_f32_16x16x32_bf16 v[20:23], a[128:131], v[116:119], v[20:23]
    v_mfma_f32_16x16x32_bf16 v[24:27], a[128:131], v[120:123], v[24:27]
    v_mfma_f32_16x16x32_bf16 v[28:31], a[128:131], v[124:127], v[28:31]
    v_mfma_f32_16x16x32_bf16 v[32:35], a[132:135], v[112:115], v[32:35]
    v_mfma_f32_16x16x32_bf16 v[36:39], a[132:135], v[116:119], v[36:39]
    v_mfma_f32_16x16x32_bf16 v[40:43], a[132:135], v[120:123], v[40:43]
    v_mfma_f32_16x16x32_bf16 v[44:47], a[132:135], v[124:127], v[44:47]
    s_waitcnt vmcnt(8)
    v_mfma_f32_16x16x32_bf16 v[48:51], a[136:139], v[112:115], v[48:51]
    s_add_u32 s70, s39, 344064
    s_cmp_ge_u32 s70, 458752
    s_cselect_b32 s71, 458752, 0
    s_sub_u32 s70, s70, s71
    v_mfma_f32_16x16x32_bf16 v[52:55], a[136:139], v[116:119], v[52:55]
    buffer_load_dwordx4 v[80:83], v208, s[4:7], s70 offen offset:0 sc1
    buffer_load_dwordx4 v[84:87], v208, s[4:7], s70 offen offset:256 sc1
    buffer_load_dwordx4 v[88:91], v208, s[4:7], s70 offen offset:512 sc1
    buffer_load_dwordx4 v[92:95], v209, s[4:7], s70 offen sc1
    v_mfma_f32_16x16x32_bf16 v[56:59], a[136:139], v[120:123], v[56:59]
    ds_read_b64_tr_b16 a[48:49], v248 offset:12288
    ds_read_b64_tr_b16 a[50:51], v248 offset:12800
    ds_read_b64_tr_b16 a[52:53], v249 offset:12288
    ds_read_b64_tr_b16 a[54:55], v249 offset:12800
    v_mfma_f32_16x16x32_bf16 v[60:63], a[136:139], v[124:127], v[60:63]
    ds_read_b64_tr_b16 a[56:57], v250 offset:12288
    ds_read_b64_tr_b16 a[58:59], v250 offset:12800
    ds_read_b64_tr_b16 a[60:61], v251 offset:12288
    ds_read_b64_tr_b16 a[62:63], v251 offset:12800
    v_mfma_f32_16x16x32_bf16 v[64:67], a[140:143], v[112:115], v[64:67]
    v_max3_u32 v214, v128, v129, v130
    v_max3_u32 v214, v214, v131, v132
    v_max3_u32 v214, v214, v133, v134
    v_max3_u32 v214, v214, v135, v136
    v_mfma_f32_16x16x32_bf16 v[68:71], a[140:143], v[116:119], v[68:71]
    v_max3_u32 v214, v214, v137, v138
    v_max3_u32 v214, v214, v139, v140
    v_max3_u32 v214, v214, v141, v142
    v_max_u32_e64 v214, v214, v143
    v_mfma_f32_16x16x32_bf16 v[72:75], a[140:143], v[120:123], v[72:75]
    v_cmp_eq_u32 vcc, -1, v214
    v_mfma_f32_16x16x32_bf16 v[76:79], a[140:143], v[124:127], v[76:79]
    s_nop 2
    s_cbranch_vccnz slow_51
back_52:
    s_nop 0
    v_mfma_f32_16x16x32_bf16 v[16:19], a[144:147], v[128:131], v[16:19]
    v_mfma_f32_16x16x32_bf16 v[20:23], a[144:147], v[132:135], v[20:23]
    v_mfma_f32_16x16x32_bf16 v[24:27], a[144:147], v[136:139], v[24:27]
    v_mfma_f32_16x16x32_bf16 v[28:31], a[144:147], v[140:143], v[28:31]
    v_mfma_f32_16x16x32_bf16 v[32:35], a[148:151], v[128:131], v[32:35]
    v_mfma_f32_16x16x32_bf16 v[36:39], a[148:151], v[132:135], v[36:39]
    v_mfma_f32_16x16x32_bf16 v[40:43], a[148:151], v[136:139], v[40:43]
    v_mfma_f32_16x16x32_bf16 v[44:47], a[148:151], v[140:143], v[44:47]
    s_waitcnt vmcnt(8)
    v_mfma_f32_16x16x32_bf16 v[48:51], a[152:155], v[128:131], v[48:51]
    s_add_u32 s70, s39, 372736
    s_cmp_ge_u32 s70, 458752
    s_cselect_b32 s71, 458752, 0
    s_sub_u32 s70, s70, s71
    v_mfma_f32_16x16x32_bf16 v[52:55], a[152:155], v[132:135], v[52:55]
    buffer_load_dwordx4 v[96:99], v208, s[4:7], s70 offen offset:0 sc1
    buffer_load_dwordx4 v[100:103], v208, s[4:7], s70 offen offset:256 sc1
    buffer_load_dwordx4 v[104:107], v208, s[4:7], s70 offen offset:512 sc1
    buffer_load_dwordx4 v[108:111], v209, s[4:7], s70 offen sc1
    v_mfma_f32_16x16x32_bf16 v[56:59], a[152:155], v[136:139], v[56:59]
    ds_read_b64_tr_b16 a[64:65], v248 offset:16384
    ds_read_b64_tr_b16 a[66:67], v248 offset:16896
    ds_read_b64_tr_b16 a[68:69], v249 offset:16384
    ds_read_b64_tr_b16 a[70:71], v249 offset:16896
    v_mfma_f32_16x16x32_bf16 v[60:63], a[152:155], v[140:143], v[60:63]
    ds_read_b64_tr_b16 a[72:73], v250 offset:16384
    ds_read_b64_tr_b16 a[74:75], v250 offset:16896
    ds_read_b64_tr_b16 a[76:77], v251 offset:16384
    ds_read_b64_tr_b16 a[78:79], v251 offset:16896
    v_mfma_f32_16x16x32_bf16 v[64:67], a[156:159], v[128:131], v[64:67]
    v_max3_u32 v214, v144, v145, v146
    v_max3_u32 v214, v214, v147, v148
    v_max3_u32 v214, v214, v149, v150
    v_max3_u32 v214, v214, v151, v152
    v_mfma_f32_16x16x32_bf16 v[68:71], a[156:159], v[132:135], v[68:71]
    v_max3_u32 v214, v214, v153, v154
    v_max3_u32 v214, v214, v155, v156
    v_max3_u32 v214, v214, v157, v158
    v_max_u32_e64 v214, v214, v159
    v_mfma_f32_16x16x32_bf16 v[72:75], a[156:159], v[136:139], v[72:75]
    v_cmp_eq_u32 vcc, -1, v214
    v_mfma_f32_16x16x32_bf16 v[76:79], a[156:159], v[140:143], v[76:79]
    s_nop 2
    s_cbranch_vccnz slow_54
back_55:
    s_nop 0
    v_mfma_f32_16x16x32_bf16 v[16:19], a[160:163], v[144:147], v[16:19]
    v_mfma_f32_16x16x32_bf16 v[20:23], a[160:163], v[148:151], v[20:23]
    v_mfma_f32_16x16x32_bf16 v[24:27], a[160:163], v[152:155], v[24:27]
    v_mfma_f32_16x16x32_bf16 v[28:31], a[160:163], v[156:159], v[28:31]
    v_mfma_f32_16x16x32_bf16 v[32:35], a[164:167], v[144:147], v[32:35]
    v_mfma_f32_16x16x32_bf16 v[36:39], a[164:167], v[148:151], v[36:39]
    v_mfma_f32_16x16x32_bf16 v[40:43], a[164:167], v[152:155], v[40:43]
    v_mfma_f32_16x16x32_bf16 v[44:47], a[164:167], v[156:159], v[44:47]
    s_waitcnt vmcnt(8)
    s_nop 0
    v_mfma_f32_16x16x32_bf16 v[48:51], a[168:171], v[144:147], v[48:51]
    s_add_u32 s70, s39, 401408
    s_cmp_ge_u32 s70, 458752
    s_cselect_b32 s71, 458752, 0
    v_mfma_f32_16x16x32_bf16 v[52:55], a[168:171], v[148:151], v[52:55]
    s_sub_u32 s70, s70, s71
    s_nop 0
    buffer_load_dwordx4 v[112:115], v208, s[4:7], s70 offen offset:0 sc1
    buffer_load_dwordx4 v[116:119], v208, s[4:7], s70 offen offset:256 sc1
    v_mfma_f32_16x16x32_bf16 v[56:59], a[168:171], v[152:155], v[56:59]
    buffer_load_dwordx4 v[120:123], v208, s[4:7], s70 offen offset:512 sc1
    buffer_load_dwordx4 v[124:127], v209, s[4:7], s70 offen sc1
    v_max3_u32 v214, v160, v161, v162
    v_mfma_f32_16x16x32_bf16 v[60:63], a[168:171], v[156:159], v[60:63]
    v_max3_u32 v214, v214, v163, v164
    v_max3_u32 v214, v214, v165, v166
    v_max3_u32 v214, v214, v167, v168
    v_mfma_f32_16x16x32_bf16 v[64:67], a[172:175], v[144:147], v[64:67]
    v_max3_u32 v214, v214, v169, v170
    v_max3_u32 v214, v214, v171, v172
    v_max3_u32 v214, v214, v173, v174
    v_mfma_f32_16x16x32_bf16 v[68:71], a[172:175], v[148:151], v[68:71]
    v_max_u32 v214, v214, v175
    v_cmp_eq_u32 vcc, -1, v214
    v_mfma_f32_16x16x32_bf16 v[72:75], a[172:175], v[152:155], v[72:75]
    v_mfma_f32_16x16x32_bf16 v[76:79], a[172:175], v[156:159], v[76:79]
    s_nop 1
    s_cbranch_vccnz slow_57
back_58:
    v_mfma_f32_16x16x32_bf16 v[16:19], a[176:179], v[160:163], v[16:19]
    v_mfma_f32_16x16x32_bf16 v[20:23], a[176:179], v[164:167], v[20:23]
    v_mfma_f32_16x16x32_bf16 v[24:27], a[176:179], v[168:171], v[24:27]
    v_mfma_f32_16x16x32_bf16 v[28:31], a[176:179], v[172:175], v[28:31]
    v_mfma_f32_16x16x32_bf16 v[32:35], a[180:183], v[160:163], v[32:35]
    v_mfma_f32_16x16x32_bf16 v[36:39], a[180:183], v[164:167], v[36:39]
    v_mfma_f32_16x16x32_bf16 v[40:43], a[180:183], v[168:171], v[40:43]
    v_mfma_f32_16x16x32_bf16 v[44:47], a[180:183], v[172:175], v[44:47]
    s_waitcnt vmcnt(8)
    s_nop 0
    v_mfma_f32_16x16x32_bf16 v[48:51], a[184:187], v[160:163], v[48:51]
    s_add_u32 s70, s39, 430080
    s_cmp_ge_u32 s70, 458752
    s_cselect_b32 s71, 458752, 0
    v_mfma_f32_16x16x32_bf16 v[52:55], a[184:187], v[164:167], v[52:55]
    s_sub_u32 s70, s70, s71
    s_nop 0
    buffer_load_dwordx4 v[128:131], v208, s[4:7], s70 offen offset:0 sc1
    buffer_load_dwordx4 v[132:135], v208, s[4:7], s70 offen offset:256 sc1
    v_mfma_f32_16x16x32_bf16 v[56:59], a[184:187], v[168:171], v[56:59]
    buffer_load_dwordx4 v[136:139], v208, s[4:7], s70 offen offset:512 sc1
    buffer_load_dwordx4 v[140:143], v209, s[4:7], s70 offen sc1
    v_max3_u32 v214, v80, v81, v82
    v_mfma_f32_16x16x32_bf16 v[60:63], a[184:187], v[172:175], v[60:63]
    v_max3_u32 v214, v214, v83, v84
    v_max3_u32 v214, v214, v85, v86
    v_max3_u32 v214, v214, v87, v88
    v_mfma_f32_16x16x32_bf16 v[64:67], a[188:191], v[160:163], v[64:67]
    v_max3_u32 v214, v214, v89, v90
    v_max3_u32 v214, v214, v91, v92
    v_max3_u32 v214, v214, v93, v94
    v_mfma_f32_16x16x32_bf16 v[68:71], a[188:191], v[164:167], v[68:71]
    v_max_u32 v214, v214, v95
    v_cmp_eq_u32 vcc, -1, v214
    v_mfma_f32_16x16x32_bf16 v[72:75], a[188:191], v[168:171], v[72:75]
    v_mfma_f32_16x16x32_bf16 v[76:79], a[188:191], v[172:175], v[76:79]
    s_nop 1
    s_cbranch_vccnz slow_60
back_61:
    v_mfma_f32_16x16x32_bf16 v[16:19], a[192:195], v[80:83], v[16:19]
    v_mfma_f32_16x16x32_bf16 v[20:23], a[192:195], v[84:87], v[20:23]
    v_mfma_f32_16x16x32_bf16 v[24:27], a[192:195], v[88:91], v[24:27]
    v_mfma_f32_16x16x32_bf16 v[28:31], a[192:195], v[92:95], v[28:31]
    v_mfma_f32_16x16x32_bf16 v[32:35], a[196:199], v[80:83], v[32:35]
    v_mfma_f32_16x16x32_bf16 v[36:39], a[196:199], v[84:87], v[36:39]
    v_mfma_f32_16x16x32_bf16 v[40:43], a[196:199], v[88:91], v[40:43]
    v_mfma_f32_16x16x32_bf16 v[44:47], a[196:199], v[92:95], v[44:47]
    s_waitcnt vmcnt(8)
    v_mfma_f32_16x16x32_bf16 v[48:51], a[200:203], v[80:83], v[48:51]
    s_waitcnt lgkmcnt(0)
    s_add_u32 s70, s40, 655360
    s_cmp_ge_u32 s70, 1835008
    v_mfma_f32_16x16x32_bf16 v[52:55], a[200:203], v[84:87], v[52:55]
    s_cselect_b32 s71, 1835008, 0
    s_sub_u32 s70, s70, s71
    s_add_u32 m0, s51, 0
    v_mfma_f32_16x16x32_bf16 v[56:59], a[200:203], v[88:91], v[56:59]
    buffer_load_dwordx4 v228, s[16:19], s70 offen offset:0 lds
    buffer_load_dwordx4 v229, s[16:19], s70 offen offset:1024 lds
    buffer_load_dwordx4 v230, s[16:19], s70 offen offset:2048 lds
    v_mfma_f32_16x16x32_bf16 v[60:63], a[200:203], v[92:95], v[60:63]
    buffer_load_dwordx4 v231, s[16:19], s70 offen offset:3072 lds
    v_max3_u32 v214, v96, v97, v98
    v_max3_u32 v214, v214, v99, v100
    v_mfma_f32_16x16x32_bf16 v[64:67], a[204:207], v[80:83], v[64:67]
    v_max3_u32 v214, v214, v101, v102
    v_max3_u32 v214, v214, v103, v104
    v_max3_u32 v214, v214, v105, v106
    v_mfma_f32_16x16x32_bf16 v[68:71], a[204:207], v[84:87], v[68:71]
    v_max3_u32 v214, v214, v107, v108
    v_max3_u32 v214, v214, v109, v110
    v_max_u32_e64 v214, v214, v111
    v_mfma_f32_16x16x32_bf16 v[72:75], a[204:207], v[88:91], v[72:75]
    v_cmp_eq_u32 vcc, -1, v214
    v_mfma_f32_16x16x32_bf16 v[76:79], a[204:207], v[92:95], v[76:79]
    s_nop 2
    s_cbranch_vccnz slow_63
back_64:
    s_nop 0
    v_mfma_f32_16x16x32_bf16 v[16:19], a[208:211], v[96:99], v[16:19]
    v_mfma_f32_16x16x32_bf16 v[20:23], a[208:211], v[100:103], v[20:23]
    v_mfma_f32_16x16x32_bf16 v[24:27], a[208:211], v[104:107], v[24:27]
    v_mfma_f32_16x16x32_bf16 v[28:31], a[208:211], v[108:111], v[28:31]
    v_mfma_f32_16x16x32_bf16 v[32:35], a[212:215], v[96:99], v[32:35]
    v_mfma_f32_16x16x32_bf16 v[36:39], a[212:215], v[100:103], v[36:39]
    v_mfma_f32_16x16x32_bf16 v[40:43], a[212:215], v[104:107], v[40:43]
    v_mfma_f32_16x16x32_bf16 v[44:47], a[212:215], v[108:111], v[44:47]
    s_waitcnt vmcnt(8)
    s_nop 0
    v_mfma_f32_16x16x32_bf16 v[48:51], a[216:219], v[96:99], v[48:51]
    s_add_u32 s70, s40, 786432
    s_cmp_ge_u32 s70, 1835008
    s_cselect_b32 s71, 1835008, 0
    v_mfma_f32_16x16x32_bf16 v[52:55], a[216:219], v[100:103], v[52:55]
    s_sub_u32 s70, s70, s71
    s_add_u32 m0, s51, 4096
    s_nop 0
    buffer_load_dwordx4 v228, s[16:19], s70 offen offset:0 lds
    v_mfma_f32_16x16x32_bf16 v[56:59], a[216:219], v[104:107], v[56:59]
    buffer_load_dwordx4 v229, s[16:19], s70 offen offset:1024 lds
    buffer_load_dwordx4 v230, s[16:19], s70 offen offset:2048 lds
    buffer_load_dwordx4 v231, s[16:19], s70 offen offset:3072 lds
    v_mfma_f32_16x16x32_bf16 v[60:63], a[216:219], v[108:111], v[60:63]
    v_max3_u32 v214, v112, v113, v114
    v_max3_u32 v214, v214, v115, v116
    v_max3_u32 v214, v214, v117, v118
    v_mfma_f32_16x16x32_bf16 v[64:67], a[220:223], v[96:99], v[64:67]
    v_max3_u32 v214, v214, v119, v120
    v_max3_u32 v214, v214, v121, v122
    v_max3_u32 v214, v214, v123, v124
    v_mfma_f32_16x16x32_bf16 v[68:71], a[220:223], v[100:103], v[68:71]
    v_max3_u32 v214, v214, v125, v126
    v_max_u32 v214, v214, v127
    v_cmp_eq_u32 vcc, -1, v214
    v_mfma_f32_16x16x32_bf16 v[72:75], a[220:223], v[104:107], v[72:75]
    v_mfma_f32_16x16x32_bf16 v[76:79], a[220:223], v[108:111], v[76:79]
    s_nop 1
    s_cbranch_vccnz slow_66
back_67:
    v_mfma_f32_16x16x32_bf16 v[16:19], a[224:227], v[112:115], v[16:19]
    v_mfma_f32_16x16x32_bf16 v[20:23], a[224:227], v[116:119], v[20:23]
    v_mfma_f32_16x16x32_bf16 v[24:27], a[224:227], v[120:123], v[24:27]
    v_mfma_f32_16x16x32_bf16 v[28:31], a[224:227], v[124:127], v[28:31]
    v_mfma_f32_16x16x32_bf16 v[32:35], a[228:231], v[112:115], v[32:35]
    v_mfma_f32_16x16x32_bf16 v[36:39], a[228:231], v[116:119], v[36:39]
    v_mfma_f32_16x16x32_bf16 v[40:43], a[228:231], v[120:123], v[40:43]
    v_mfma_f32_16x16x32_bf16 v[44:47], a[228:231], v[124:127], v[44:47]
    s_waitcnt vmcnt(8)
    s_nop 0
    v_mfma_f32_16x16x32_bf16 v[48:51], a[232:235], v[112:115], v[48:51]
    s_add_u32 s70, s40, 917504
    s_cmp_ge_u32 s70, 1835008
    s_cselect_b32 s71, 1835008, 0
    v_mfma_f32_16x16x32_bf16 v[52:55], a[232:235], v[116:119], v[52:55]
    s_sub_u32 s70, s70, s71
    s_add_u32 m0, s51, 8192
    s_nop 0
    buffer_load_dwordx4 v228, s[16:19], s70 offen offset:0 lds
    v_mfma_f32_16x16x32_bf16 v[56:59], a[232:235], v[120:123], v[56:59]
    buffer_load_dwordx4 v229, s[16:19], s70 offen offset:1024 lds
    buffer_load_dwordx4 v230, s[16:19], s70 offen offset:2048 lds
    buffer_load_dwordx4 v231, s[16:19], s70 offen offset:3072 lds
    v_mfma_f32_16x16x32_bf16 v[60:63], a[232:235], v[124:127], v[60:63]
    v_max3_u32 v214, v128, v129, v130
    v_max3_u32 v214, v214, v131, v132
    v_max3_u32 v214, v214, v133, v134
    v_mfma_f32_16x16x32_bf16 v[64:67], a[236:239], v[112:115], v[64:67]
    v_max3_u32 v214, v214, v135, v136
    v_max3_u32 v214, v214, v137, v138
    v_max3_u32 v214, v214, v139, v140
    v_mfma_f32_16x16x32_bf16 v[68:71], a[236:239], v[116:119], v[68:71]
    v_max3_u32 v214, v214, v141, v142
    v_max_u32 v214, v214, v143
    v_cmp_eq_u32 vcc, -1, v214
    v_mfma_f32_16x16x32_bf16 v[72:75], a[236:239], v[120:123], v[72:75]
    v_mfma_f32_16x16x32_bf16 v[76:79], a[236:239], v[124:127], v[76:79]
    s_nop 1
    s_cbranch_vccnz slow_69
back_70:
    v_mfma_f32_16x16x32_bf16 v[16:19], a[240:243], v[128:131], v[16:19]
    v_mfma_f32_16x16x32_bf16 v[20:23], a[240:243], v[132:135], v[20:23]
    v_mfma_f32_16x16x32_bf16 v[24:27], a[240:243], v[136:139], v[24:27]
    v_mfma_f32_16x16x32_bf16 v[28:31], a[240:243], v[140:143], v[28:31]
    v_mfma_f32_16x16x32_bf16 v[32:35], a[244:247], v[128:131], v[32:35]
    v_mfma_f32_16x16x32_bf16 v[36:39], a[244:247], v[132:135], v[36:39]
    v_mfma_f32_16x16x32_bf16 v[40:43], a[244:247], v[136:139], v[40:43]
    v_mfma_f32_16x16x32_bf16 v[44:47], a[244:247], v[140:143], v[44:47]
    v_mfma_f32_16x16x32_bf16 v[48:51], a[248:251], v[128:131], v[48:51]
    v_mfma_f32_16x16x32_bf16 v[52:55], a[248:251], v[132:135], v[52:55]
    v_mfma_f32_16x16x32_bf16 v[56:59], a[248:251], v[136:139], v[56:59]
    v_mfma_f32_16x16x32_bf16 v[60:63], a[248:251], v[140:143], v[60:63]
    v_mfma_f32_16x16x32_bf16 v[64:67], a[252:255], v[128:131], v[64:67]
    v_mfma_f32_16x16x32_bf16 v[68:71], a[252:255], v[132:135], v[68:71]
    v_mfma_f32_16x16x32_bf16 v[72:75], a[252:255], v[136:139], v[72:75]
    v_mfma_f32_16x16x32_bf16 v[76:79], a[252:255], v[140:143], v[76:79]
    v_and_b32_e64 v4, 15, v1
    v_mul_u32_u24 v4, 272, v4
    v_lshrrev_b32_e64 v5, 4, v1
    v_lshl_add_u32 v4, v5, 4, v4
    s_mul_i32 s66, s28, 17408
    s_add_u32 s66, s66, 1024
    v_add_u32_e64 v4, s66, v4
    ds_write_b128 v4, v[16:19] offset:0
    ds_write_b128 v4, v[20:23] offset:4352
    ds_write_b128 v4, v[24:27] offset:8704
    ds_write_b128 v4, v[28:31] offset:13056
    ds_write_b128 v4, v[32:35] offset:64
    ds_write_b128 v4, v[36:39] offset:4416
    ds_write_b128 v4, v[40:43] offset:8768
    ds_write_b128 v4, v[44:47] offset:13120
    ds_write_b128 v4, v[48:51] offset:128
    ds_write_b128 v4, v[52:55] offset:4480
    ds_write_b128 v4, v[56:59] offset:8832
    ds_write_b128 v4, v[60:63] offset:13184
    ds_write_b128 v4, v[64:67] offset:192
    ds_write_b128 v4, v[68:71] offset:4544
    ds_write_b128 v4, v[72:75] offset:8896
    ds_write_b128 v4, v[76:79] offset:13248
    v_mul_u32_u24 v4, 272, v1
    s_lshl_b32 s66, s28, 6
    s_add_u32 s66, s66, 1024
    v_add_u32_e64 v4, s66, v4
    s_lshl_b32 s66, s34, 3
    s_lshl_b32 s70, s28, 1
    s_add_u32 s66, s66, s70
    s_mul_i32 s66, s66, 7168
    s_mul_i32 s70, s33, 896
    s_add_u32 s66, s66, s70
    s_add_u32 s66, s66, 6291456
    v_lshl_add_u32 v5, v1, 4, s66
    v_mov_b32_e64 v6, 1073741824
    v_cmp_gt_u32 vcc, 56, v1
    s_nop 1
    v_cndmask_b32 v5, v6, v5, vcc
    v_mov_b32 v100, 0xbdd2d3e8
    v_mov_b32 v101, 0xbdd2d3e8
    v_mov_b32 v102, 0xc0135761
    v_mov_b32 v103, 0xc0135761
    s_waitcnt lgkmcnt(0)
    s_barrier
    ds_read_b128 v[16:19], v4 offset:0
    ds_read_b128 v[20:23], v4 offset:16
    ds_read_b128 v[24:27], v4 offset:17408
    ds_read_b128 v[28:31], v4 offset:17424
    ds_read_b128 v[32:35], v4 offset:34816
    ds_read_b128 v[36:39], v4 offset:34832
    ds_read_b128 v[40:43], v4 offset:52224
    ds_read_b128 v[44:47], v4 offset:52240
    ds_read_b128 v[48:51], v4 offset:32
    ds_read_b128 v[52:55], v4 offset:48
    ds_read_b128 v[56:59], v4 offset:17440
    ds_read_b128 v[60:63], v4 offset:17456
    ds_read_b128 v[64:67], v4 offset:34848
    ds_read_b128 v[68:71], v4 offset:34864
    ds_read_b128 v[72:75], v4 offset:52256
    ds_read_b128 v[76:79], v4 offset:52272
    s_lshl_b32 s80, s72, 16
    s_and_b32 s81, s72, 0xffff0000
    s_lshl_b32 s82, s73, 16
    s_and_b32 s83, s73, 0xffff0000
    s_lshl_b32 s84, s74, 16
    s_and_b32 s85, s74, 0xffff0000
    s_lshl_b32 s86, s75, 16
    s_and_b32 s87, s75, 0xffff0000
    s_lshl_b32 s88, s76, 16
    s_and_b32 s89, s76, 0xffff0000
    s_lshl_b32 s90, s77, 16
    s_and_b32 s91, s77, 0xffff0000
    s_lshl_b32 s92, s78, 16
    s_and_b32 s93, s78, 0xffff0000
    s_lshl_b32 s94, s79, 16
    s_and_b32 s95, s79, 0xffff0000
    s_waitcnt lgkmcnt(8)
    s_nop 0
    v_pk_add_f32 v[16:17], v[16:17], v[24:25]
    v_pk_add_f32 v[32:33], v[32:33], v[40:41]
    v_pk_add_f32 v[18:19], v[18:19], v[26:27]
    v_pk_add_f32 v[34:35], v[34:35], v[42:43]
    v_pk_add_f32 v[20:21], v[20:21], v[28:29]
    v_pk_add_f32 v[36:37], v[36:37], v[44:45]
    v_pk_add_f32 v[22:23], v[22:23], v[30:31]
    v_pk_add_f32 v[38:39], v[38:39], v[46:47]
    v_pk_add_f32 v[16:17], v[16:17], v[32:33]
    v_pk_add_f32 v[18:19], v[18:19], v[34:35]
    v_pk_add_f32 v[20:21], v[20:21], v[36:37]
    v_pk_add_f32 v[22:23], v[22:23], v[38:39]
    v_cvt_pk_bf16_f32 v80, v16, v17
    v_cvt_pk_bf16_f32 v81, v18, v19
    v_cvt_pk_bf16_f32 v82, v20, v21
    v_cvt_pk_bf16_f32 v83, v22, v23
    v_lshlrev_b32_e64 v16, 16, v80
    v_and_b32 v17, 0xffff0000, v80
    v_lshlrev_b32_e64 v18, 16, v81
    v_and_b32 v19, 0xffff0000, v81
    v_lshlrev_b32_e64 v20, 16, v82
    v_and_b32 v21, 0xffff0000, v82
    v_lshlrev_b32_e64 v22, 16, v83
    v_and_b32 v23, 0xffff0000, v83
    v_pk_add_f32 v[16:17], v[16:17], s[80:81]
    v_pk_add_f32 v[18:19], v[18:19], s[82:83]
    v_pk_add_f32 v[20:21], v[20:21], s[84:85]
    v_pk_add_f32 v[22:23], v[22:23], s[86:87]
    v_cvt_pk_bf16_f32 v80, v16, v17
    v_cvt_pk_bf16_f32 v81, v18, v19
    v_cvt_pk_bf16_f32 v82, v20, v21
    v_cvt_pk_bf16_f32 v83, v22, v23
    v_lshlrev_b32_e64 v16, 16, v80
    v_and_b32 v17, 0xffff0000, v80
    v_lshlrev_b32_e64 v18, 16, v81
    v_and_b32 v19, 0xffff0000, v81
    v_lshlrev_b32_e64 v20, 16, v82
    v_and_b32 v21, 0xffff0000, v82
    v_lshlrev_b32_e64 v22, 16, v83
    v_and_b32 v23, 0xffff0000, v83
    v_pk_mul_f32 v[24:25], v[16:17], v[16:17]
    v_pk_mul_f32 v[26:27], v[18:19], v[18:19]
    v_pk_mul_f32 v[28:29], v[20:21], v[20:21]
    v_pk_mul_f32 v[30:31], v[22:23], v[22:23]
    v_pk_fma_f32 v[24:25], v[24:25], v[100:101], v[102:103]
    v_pk_fma_f32 v[26:27], v[26:27], v[100:101], v[102:103]
    v_pk_fma_f32 v[28:29], v[28:29], v[100:101], v[102:103]
    v_pk_fma_f32 v[30:31], v[30:31], v[100:101], v[102:103]
    v_pk_mul_f32 v[24:25], v[24:25], v[16:17]
    v_pk_mul_f32 v[26:27], v[26:27], v[18:19]
    v_pk_mul_f32 v[28:29], v[28:29], v[20:21]
    v_pk_mul_f32 v[30:31], v[30:31], v[22:23]
    v_exp_f32 v24, v24
    v_exp_f32 v25, v25
    v_exp_f32 v26, v26
    v_exp_f32 v27, v27
    v_exp_f32 v28, v28
    v_exp_f32 v29, v29
    v_exp_f32 v30, v30
    v_exp_f32 v31, v31
    v_pk_add_f32 v[24:25], v[24:25], 1.0 op_sel_hi:[1,0]
    v_pk_add_f32 v[26:27], v[26:27], 1.0 op_sel_hi:[1,0]
    v_pk_add_f32 v[28:29], v[28:29], 1.0 op_sel_hi:[1,0]
    v_pk_add_f32 v[30:31], v[30:31], 1.0 op_sel_hi:[1,0]
    v_rcp_f32 v24, v24
    v_rcp_f32 v25, v25
    v_rcp_f32 v26, v26
    v_rcp_f32 v27, v27
    v_rcp_f32 v28, v28
    v_rcp_f32 v29, v29
    v_rcp_f32 v30, v30
    v_rcp_f32 v31, v31
    v_pk_mul_f32 v[16:17], v[16:17], v[24:25]
    v_pk_mul_f32 v[18:19], v[18:19], v[26:27]
    v_pk_mul_f32 v[20:21], v[20:21], v[28:29]
    v_pk_mul_f32 v[22:23], v[22:23], v[30:31]
    v_cvt_pk_bf16_f32 v88, v16, v17
    v_cvt_pk_bf16_f32 v89, v18, v19
    v_cvt_pk_bf16_f32 v90, v20, v21
    v_cvt_pk_bf16_f32 v91, v22, v23
    buffer_store_dwordx4 v[88:91], v5, s[4:7], 0 offen sc1
    s_waitcnt lgkmcnt(0)
    s_nop 0
    v_pk_add_f32 v[48:49], v[48:49], v[56:57]
    v_pk_add_f32 v[64:65], v[64:65], v[72:73]
    v_pk_add_f32 v[50:51], v[50:51], v[58:59]
    v_pk_add_f32 v[66:67], v[66:67], v[74:75]
    v_pk_add_f32 v[52:53], v[52:53], v[60:61]
    v_pk_add_f32 v[68:69], v[68:69], v[76:77]
    v_pk_add_f32 v[54:55], v[54:55], v[62:63]
    v_pk_add_f32 v[70:71], v[70:71], v[78:79]
    v_pk_add_f32 v[48:49], v[48:49], v[64:65]
    v_pk_add_f32 v[50:51], v[50:51], v[66:67]
    v_pk_add_f32 v[52:53], v[52:53], v[68:69]
    v_pk_add_f32 v[54:55], v[54:55], v[70:71]
    v_cvt_pk_bf16_f32 v80, v48, v49
    v_cvt_pk_bf16_f32 v81, v50, v51
    v_cvt_pk_bf16_f32 v82, v52, v53
    v_cvt_pk_bf16_f32 v83, v54, v55
    v_lshlrev_b32_e64 v48, 16, v80
    v_and_b32 v49, 0xffff0000, v80
    v_lshlrev_b32_e64 v50, 16, v81
    v_and_b32 v51, 0xffff0000, v81
    v_lshlrev_b32_e64 v52, 16, v82
    v_and_b32 v53, 0xffff0000, v82
    v_lshlrev_b32_e64 v54, 16, v83
    v_and_b32 v55, 0xffff0000, v83
    v_pk_add_f32 v[48:49], v[48:49], s[88:89]
    v_pk_add_f32 v[50:51], v[50:51], s[90:91]
    v_pk_add_f32 v[52:53], v[52:53], s[92:93]
    v_pk_add_f32 v[54:55], v[54:55], s[94:95]
    v_cvt_pk_bf16_f32 v80, v48, v49
    v_cvt_pk_bf16_f32 v81, v50, v51
    v_cvt_pk_bf16_f32 v82, v52, v53
    v_cvt_pk_bf16_f32 v83, v54, v55
    v_lshlrev_b32_e64 v48, 16, v80
    v_and_b32 v49, 0xffff0000, v80
    v_lshlrev_b32_e64 v50, 16, v81
    v_and_b32 v51, 0xffff0000, v81
    v_lshlrev_b32_e64 v52, 16, v82
    v_and_b32 v53, 0xffff0000, v82
    v_lshlrev_b32_e64 v54, 16, v83
    v_and_b32 v55, 0xffff0000, v83
    v_pk_mul_f32 v[56:57], v[48:49], v[48:49]
    v_pk_mul_f32 v[58:59], v[50:51], v[50:51]
    v_pk_mul_f32 v[60:61], v[52:53], v[52:53]
    v_pk_mul_f32 v[62:63], v[54:55], v[54:55]
    v_pk_fma_f32 v[56:57], v[56:57], v[100:101], v[102:103]
    v_pk_fma_f32 v[58:59], v[58:59], v[100:101], v[102:103]
    v_pk_fma_f32 v[60:61], v[60:61], v[100:101], v[102:103]
    v_pk_fma_f32 v[62:63], v[62:63], v[100:101], v[102:103]
    v_pk_mul_f32 v[56:57], v[56:57], v[48:49]
    v_pk_mul_f32 v[58:59], v[58:59], v[50:51]
    v_pk_mul_f32 v[60:61], v[60:61], v[52:53]
    v_pk_mul_f32 v[62:63], v[62:63], v[54:55]
    v_exp_f32 v56, v56
    v_exp_f32 v57, v57
    v_exp_f32 v58, v58
    v_exp_f32 v59, v59
    v_exp_f32 v60, v60
    v_exp_f32 v61, v61
    v_exp_f32 v62, v62
    v_exp_f32 v63, v63
    v_pk_add_f32 v[56:57], v[56:57], 1.0 op_sel_hi:[1,0]
    v_pk_add_f32 v[58:59], v[58:59], 1.0 op_sel_hi:[1,0]
    v_pk_add_f32 v[60:61], v[60:61], 1.0 op_sel_hi:[1,0]
    v_pk_add_f32 v[62:63], v[62:63], 1.0 op_sel_hi:[1,0]
    v_rcp_f32 v56, v56
    v_rcp_f32 v57, v57
    v_rcp_f32 v58, v58
    v_rcp_f32 v59, v59
    v_rcp_f32 v60, v60
    v_rcp_f32 v61, v61
    v_rcp_f32 v62, v62
    v_rcp_f32 v63, v63
    v_pk_mul_f32 v[48:49], v[48:49], v[56:57]
    v_pk_mul_f32 v[50:51], v[50:51], v[58:59]
    v_pk_mul_f32 v[52:53], v[52:53], v[60:61]
    v_pk_mul_f32 v[54:55], v[54:55], v[62:63]
    v_cvt_pk_bf16_f32 v92, v48, v49
    v_cvt_pk_bf16_f32 v93, v50, v51
    v_cvt_pk_bf16_f32 v94, v52, v53
    v_cvt_pk_bf16_f32 v95, v54, v55
    v_add_u32 v5, 7168, v5
    buffer_store_dwordx4 v[92:95], v5, s[4:7], 0 offen sc1
    s_add_u32 s70, s40, 1048576
    s_cmp_ge_u32 s70, 1835008
    s_cselect_b32 s71, 1835008, 0
    s_sub_u32 s70, s70, s71
    s_add_u32 m0, s51, 12288
    s_nop 0
    buffer_load_dwordx4 v228, s[16:19], s70 offen offset:0 lds
    buffer_load_dwordx4 v229, s[16:19], s70 offen offset:1024 lds
    buffer_load_dwordx4 v230, s[16:19], s70 offen offset:2048 lds
    buffer_load_dwordx4 v231, s[16:19], s70 offen offset:3072 lds
    s_add_u32 s70, s40, 1179648
    s_cmp_ge_u32 s70, 1835008
    s_cselect_b32 s71, 1835008, 0
    s_sub_u32 s70, s70, s71
    s_add_u32 m0, s51, 16384
    s_nop 0
    buffer_load_dwordx4 v228, s[16:19], s70 offen offset:0 lds
    buffer_load_dwordx4 v229, s[16:19], s70 offen offset:1024 lds
    buffer_load_dwordx4 v230, s[16:19], s70 offen offset:2048 lds
    buffer_load_dwordx4 v231, s[16:19], s70 offen offset:3072 lds
    s_barrier
    s_add_u32 s70, s40, 1310720
    s_cmp_ge_u32 s70, 1835008
    s_cselect_b32 s71, 1835008, 0
    s_sub_u32 s70, s70, s71
    s_add_u32 m0, s50, 0
    s_nop 0
    buffer_load_dwordx4 v228, s[16:19], s70 offen offset:0 lds
    buffer_load_dwordx4 v229, s[16:19], s70 offen offset:1024 lds
    buffer_load_dwordx4 v230, s[16:19], s70 offen offset:2048 lds
    buffer_load_dwordx4 v231, s[16:19], s70 offen offset:3072 lds
    s_add_u32 s70, s40, 1441792
    s_cmp_ge_u32 s70, 1835008
    s_cselect_b32 s71, 1835008, 0
    s_sub_u32 s70, s70, s71
    s_add_u32 m0, s50, 4096
    s_nop 0
    buffer_load_dwordx4 v228, s[16:19], s70 offen offset:0 lds
    buffer_load_dwordx4 v229, s[16:19], s70 offen offset:1024 lds
    buffer_load_dwordx4 v230, s[16:19], s70 offen offset:2048 lds
    buffer_load_dwordx4 v231, s[16:19], s70 offen offset:3072 lds
    s_add_u32 s70, s40, 1572864
    s_cmp_ge_u32 s70, 1835008
    s_cselect_b32 s71, 1835008, 0
    s_sub_u32 s70, s70, s71
    s_add_u32 m0, s50, 8192
    s_nop 0
    buffer_load_dwordx4 v228, s[16:19], s70 offen offset:0 lds
    buffer_load_dwordx4 v229, s[16:19], s70 offen offset:1024 lds
    buffer_load_dwordx4 v230, s[16:19], s70 offen offset:2048 lds
    buffer_load_dwordx4 v231, s[16:19], s70 offen offset:3072 lds
    s_add_u32 s70, s40, 1703936
    s_cmp_ge_u32 s70, 1835008
    s_cselect_b32 s71, 1835008, 0
    s_sub_u32 s70, s70, s71
    s_add_u32 m0, s50, 12288
    s_nop 0
    buffer_load_dwordx4 v228, s[16:19], s70 offen offset:0 lds
    buffer_load_dwordx4 v229, s[16:19], s70 offen offset:1024 lds
    buffer_load_dwordx4 v230, s[16:19], s70 offen offset:2048 lds
    buffer_load_dwordx4 v231, s[16:19], s70 offen offset:3072 lds
    s_mul_i32 s66, s28, 401408
    s_mul_i32 s67, s33, 896
    s_add_u32 s66, s66, s67
    s_add_u32 s66, s66, 6291456
    v_lshrrev_b32 v4, 4, v1
    v_mul_u32_u24 v4, 7168, v4
    v_add_u32 v4, s66, v4
    v_and_b32 v5, 15, v1
    v_lshl_add_u32 v208, v5, 4, v4
    v_add_u32 v209, 768, v208
    v_mov_b32_e64 v4, 1073741824
    v_cmp_gt_u32 vcc, 8, v5
    s_nop 1
    v_cndmask_b32 v209, v4, v209, vcc
    s_add_u32 s70, s41, 0
    s_cmp_ge_u32 s70, 401408
    s_cselect_b32 s71, 401408, 0
    s_sub_u32 s70, s70, s71
    s_nop 0
    buffer_load_dwordx4 v[80:83], v208, s[4:7], s70 offen offset:0 sc1
    buffer_load_dwordx4 v[84:87], v208, s[4:7], s70 offen offset:256 sc1
    buffer_load_dwordx4 v[88:91], v208, s[4:7], s70 offen offset:512 sc1
    buffer_load_dwordx4 v[92:95], v209, s[4:7], s70 offen sc1
    s_add_u32 s70, s41, 28672
    s_cmp_ge_u32 s70, 401408
    s_cselect_b32 s71, 401408, 0
    s_sub_u32 s70, s70, s71
    s_nop 0
    buffer_load_dwordx4 v[96:99], v208, s[4:7], s70 offen offset:0 sc1
    buffer_load_dwordx4 v[100:103], v208, s[4:7], s70 offen offset:256 sc1
    buffer_load_dwordx4 v[104:107], v208, s[4:7], s70 offen offset:512 sc1
    buffer_load_dwordx4 v[108:111], v209, s[4:7], s70 offen sc1
    s_add_u32 s70, s41, 57344
    s_cmp_ge_u32 s70, 401408
    s_cselect_b32 s71, 401408, 0
    s_sub_u32 s70, s70, s71
    buffer_load_dwordx4 v[112:115], v208, s[4:7], s70 offen offset:0 sc1
    buffer_load_dwordx4 v[116:119], v208, s[4:7], s70 offen offset:256 sc1
    buffer_load_dwordx4 v[120:123], v208, s[4:7], s70 offen offset:512 sc1
    buffer_load_dwordx4 v[124:127], v209, s[4:7], s70 offen sc1
    s_waitcnt vmcnt(38)
    ds_read_b64_tr_b16 a[80:81], v248 offset:0
    ds_read_b64_tr_b16 a[82:83], v248 offset:512
    ds_read_b64_tr_b16 a[84:85], v249 offset:0
    ds_read_b64_tr_b16 a[86:87], v249 offset:512
    ds_read_b64_tr_b16 a[88:89], v250 offset:0
    ds_read_b64_tr_b16 a[90:91], v250 offset:512
    ds_read_b64_tr_b16 a[92:93], v251 offset:0
    ds_read_b64_tr_b16 a[94:95], v251 offset:512
    ds_read_b64_tr_b16 a[96:97], v248 offset:4096
    ds_read_b64_tr_b16 a[98:99], v248 offset:4608
    ds_read_b64_tr_b16 a[100:101], v249 offset:4096
    ds_read_b64_tr_b16 a[102:103], v249 offset:4608
    ds_read_b64_tr_b16 a[104:105], v250 offset:4096
    ds_read_b64_tr_b16 a[106:107], v250 offset:4608
    ds_read_b64_tr_b16 a[108:109], v251 offset:4096
    ds_read_b64_tr_b16 a[110:111], v251 offset:4608
    ds_read_b64_tr_b16 a[112:113], v248 offset:8192
    ds_read_b64_tr_b16 a[114:115], v248 offset:8704
    ds_read_b64_tr_b16 a[116:117], v249 offset:8192
    ds_read_b64_tr_b16 a[118:119], v249 offset:8704
    ds_read_b64_tr_b16 a[120:121], v250 offset:8192
    ds_read_b64_tr_b16 a[122:123], v250 offset:8704
    ds_read_b64_tr_b16 a[124:125], v251 offset:8192
    ds_read_b64_tr_b16 a[126:127], v251 offset:8704
    s_waitcnt vmcnt(28)
    s_nop 0
    ds_read_b64_tr_b16 a[128:129], v248 offset:12288
    ds_read_b64_tr_b16 a[130:131], v248 offset:12800
    ds_read_b64_tr_b16 a[132:133], v249 offset:12288
    ds_read_b64_tr_b16 a[134:135], v249 offset:12800
    ds_read_b64_tr_b16 a[136:137], v250 offset:12288
    ds_read_b64_tr_b16 a[138:139], v250 offset:12800
    ds_read_b64_tr_b16 a[140:141], v251 offset:12288
    ds_read_b64_tr_b16 a[142:143], v251 offset:12800
    ds_read_b64_tr_b16 a[144:145], v248 offset:16384
    ds_read_b64_tr_b16 a[146:147], v248 offset:16896
    ds_read_b64_tr_b16 a[148:149], v249 offset:16384
    ds_read_b64_tr_b16 a[150:151], v249 offset:16896
    ds_read_b64_tr_b16 a[152:153], v250 offset:16384
    ds_read_b64_tr_b16 a[154:155], v250 offset:16896
    ds_read_b64_tr_b16 a[156:157], v251 offset:16384
    ds_read_b64_tr_b16 a[158:159], v251 offset:16896
    s_waitcnt vmcnt(12)
    s_nop 0
    ds_read_b64_tr_b16 a[160:161], v244 offset:0
    ds_read_b64_tr_b16 a[162:163], v244 offset:512
    ds_read_b64_tr_b16 a[164:165], v245 offset:0
    ds_read_b64_tr_b16 a[166:167], v245 offset:512
    ds_read_b64_tr_b16 a[168:169], v246 offset:0
    ds_read_b64_tr_b16 a[170:171], v246 offset:512
    ds_read_b64_tr_b16 a[172:173], v247 offset:0
    ds_read_b64_tr_b16 a[174:175], v247 offset:512
    ds_read_b64_tr_b16 a[176:177], v244 offset:4096
    ds_read_b64_tr_b16 a[178:179], v244 offset:4608
    ds_read_b64_tr_b16 a[180:181], v245 offset:4096
    ds_read_b64_tr_b16 a[182:183], v245 offset:4608
    ds_read_b64_tr_b16 a[184:185], v246 offset:4096
    ds_read_b64_tr_b16 a[186:187], v246 offset:4608
    ds_read_b64_tr_b16 a[188:189], v247 offset:4096
    ds_read_b64_tr_b16 a[190:191], v247 offset:4608
    ds_read_b64_tr_b16 a[192:193], v244 offset:8192
    ds_read_b64_tr_b16 a[194:195], v244 offset:8704
    ds_read_b64_tr_b16 a[196:197], v245 offset:8192
    ds_read_b64_tr_b16 a[198:199], v245 offset:8704
    ds_read_b64_tr_b16 a[200:201], v246 offset:8192
    ds_read_b64_tr_b16 a[202:203], v246 offset:8704
    ds_read_b64_tr_b16 a[204:205], v247 offset:8192
    ds_read_b64_tr_b16 a[206:207], v247 offset:8704
    ds_read_b64_tr_b16 a[208:209], v244 offset:12288
    ds_read_b64_tr_b16 a[210:211], v244 offset:12800
    ds_read_b64_tr_b16 a[212:213], v245 offset:12288
    ds_read_b64_tr_b16 a[214:215], v245 offset:12800
    ds_read_b64_tr_b16 a[216:217], v246 offset:12288
    ds_read_b64_tr_b16 a[218:219], v246 offset:12800
    ds_read_b64_tr_b16 a[220:221], v247 offset:12288
    ds_read_b64_tr_b16 a[222:223], v247 offset:12800
    s_waitcnt lgkmcnt(0)
    s_branch noconv_6
noconv_4:
    s_add_u32 s70, s40, 0
    s_cmp_ge_u32 s70, 1835008
    s_cselect_b32 s71, 1835008, 0
    s_sub_u32 s70, s70, s71
    s_add_u32 m0, s51, 0
    s_nop 0
    buffer_load_dwordx4 v228, s[16:19], s70 offen offset:0 lds
    buffer_load_dwordx4 v229, s[16:19], s70 offen offset:1024 lds
    buffer_load_dwordx4 v230, s[16:19], s70 offen offset:2048 lds
    buffer_load_dwordx4 v231, s[16:19], s70 offen offset:3072 lds
    s_add_u32 s70, s40, 131072
    s_cmp_ge_u32 s70, 1835008
    s_cselect_b32 s71, 1835008, 0
    s_sub_u32 s70, s70, s71
    s_add_u32 m0, s51, 4096
    s_nop 0
    buffer_load_dwordx4 v228, s[16:19], s70 offen offset:0 lds
    buffer_load_dwordx4 v229, s[16:19], s70 offen offset:1024 lds
    buffer_load_dwordx4 v230, s[16:19], s70 offen offset:2048 lds
    buffer_load_dwordx4 v231, s[16:19], s70 offen offset:3072 lds
    s_add_u32 s70, s40, 262144
    s_cmp_ge_u32 s70, 1835008
    s_cselect_b32 s71, 1835008, 0
    s_sub_u32 s70, s70, s71
    s_add_u32 m0, s51, 8192
    s_nop 0
    buffer_load_dwordx4 v228, s[16:19], s70 offen offset:0 lds
    buffer_load_dwordx4 v229, s[16:19], s70 offen offset:1024 lds
    buffer_load_dwordx4 v230, s[16:19], s70 offen offset:2048 lds
    buffer_load_dwordx4 v231, s[16:19], s70 offen offset:3072 lds
    s_add_u32 s70, s40, 393216
    s_cmp_ge_u32 s70, 1835008
    s_cselect_b32 s71, 1835008, 0
    s_sub_u32 s70, s70, s71
    s_add_u32 m0, s51, 12288
    s_nop 0
    buffer_load_dwordx4 v228, s[16:19], s70 offen offset:0 lds
    buffer_load_dwordx4 v229, s[16:19], s70 offen offset:1024 lds
    buffer_load_dwordx4 v230, s[16:19], s70 offen offset:2048 lds
    buffer_load_dwordx4 v231, s[16:19], s70 offen offset:3072 lds
    s_add_u32 s70, s40, 524288
    s_cmp_ge_u32 s70, 1835008
    s_cselect_b32 s71, 1835008, 0
    s_sub_u32 s70, s70, s71
    s_add_u32 m0, s51, 16384
    s_nop 0
    buffer_load_dwordx4 v228, s[16:19], s70 offen offset:0 lds
    buffer_load_dwordx4 v229, s[16:19], s70 offen offset:1024 lds
    buffer_load_dwordx4 v230, s[16:19], s70 offen offset:2048 lds
    buffer_load_dwordx4 v231, s[16:19], s70 offen offset:3072 lds
    s_waitcnt vmcnt(0)
    s_nop 0
    ds_read_b64_tr_b16 a[0:1], v248 offset:0
    ds_read_b64_tr_b16 a[2:3], v248 offset:512
    ds_read_b64_tr_b16 a[4:5], v249 offset:0
    ds_read_b64_tr_b16 a[6:7], v249 offset:512
    ds_read_b64_tr_b16 a[8:9], v250 offset:0
    ds_read_b64_tr_b16 a[10:11], v250 offset:512
    ds_read_b64_tr_b16 a[12:13], v251 offset:0
    ds_read_b64_tr_b16 a[14:15], v251 offset:512
    ds_read_b64_tr_b16 a[16:17], v248 offset:4096
    ds_read_b64_tr_b16 a[18:19], v248 offset:4608
    ds_read_b64_tr_b16 a[20:21], v249 offset:4096
    ds_read_b64_tr_b16 a[22:23], v249 offset:4608
    ds_read_b64_tr_b16 a[24:25], v250 offset:4096
    ds_read_b64_tr_b16 a[26:27], v250 offset:4608
    ds_read_b64_tr_b16 a[28:29], v251 offset:4096
    ds_read_b64_tr_b16 a[30:31], v251 offset:4608
    ds_read_b64_tr_b16 a[32:33], v248 offset:8192
    ds_read_b64_tr_b16 a[34:35], v248 offset:8704
    ds_read_b64_tr_b16 a[36:37], v249 offset:8192
    ds_read_b64_tr_b16 a[38:39], v249 offset:8704
    ds_read_b64_tr_b16 a[40:41], v250 offset:8192
    ds_read_b64_tr_b16 a[42:43], v250 offset:8704
    ds_read_b64_tr_b16 a[44:45], v251 offset:8192
    ds_read_b64_tr_b16 a[46:47], v251 offset:8704
    ds_read_b64_tr_b16 a[48:49], v248 offset:12288
    ds_read_b64_tr_b16 a[50:51], v248 offset:12800
    ds_read_b64_tr_b16 a[52:53], v249 offset:12288
    ds_read_b64_tr_b16 a[54:55], v249 offset:12800
    ds_read_b64_tr_b16 a[56:57], v250 offset:12288
    ds_read_b64_tr_b16 a[58:59], v250 offset:12800
    ds_read_b64_tr_b16 a[60:61], v251 offset:12288
    ds_read_b64_tr_b16 a[62:63], v251 offset:12800
    ds_read_b64_tr_b16 a[64:65], v248 offset:16384
    ds_read_b64_tr_b16 a[66:67], v248 offset:16896
    ds_read_b64_tr_b16 a[68:69], v249 offset:16384
    ds_read_b64_tr_b16 a[70:71], v249 offset:16896
    ds_read_b64_tr_b16 a[72:73], v250 offset:16384
    ds_read_b64_tr_b16 a[74:75], v250 offset:16896
    ds_read_b64_tr_b16 a[76:77], v251 offset:16384
    ds_read_b64_tr_b16 a[78:79], v251 offset:16896
    s_waitcnt lgkmcnt(0)
noconv_5:
    s_add_u32 s70, s40, 655360
    s_cmp_ge_u32 s70, 1835008
    s_cselect_b32 s71, 1835008, 0
    s_sub_u32 s70, s70, s71
    s_add_u32 m0, s51, 0
    s_nop 0
    buffer_load_dwordx4 v228, s[16:19], s70 offen offset:0 lds
    buffer_load_dwordx4 v229, s[16:19], s70 offen offset:1024 lds
    buffer_load_dwordx4 v230, s[16:19], s70 offen offset:2048 lds
    buffer_load_dwordx4 v231, s[16:19], s70 offen offset:3072 lds
    s_add_u32 s70, s40, 786432
    s_cmp_ge_u32 s70, 1835008
    s_cselect_b32 s71, 1835008, 0
    s_sub_u32 s70, s70, s71
    s_add_u32 m0, s51, 4096
    s_nop 0
    buffer_load_dwordx4 v228, s[16:19], s70 offen offset:0 lds
    buffer_load_dwordx4 v229, s[16:19], s70 offen offset:1024 lds
    buffer_load_dwordx4 v230, s[16:19], s70 offen offset:2048 lds
    buffer_load_dwordx4 v231, s[16:19], s70 offen offset:3072 lds
    s_add_u32 s70, s40, 917504
    s_cmp_ge_u32 s70, 1835008
    s_cselect_b32 s71, 1835008, 0
    s_sub_u32 s70, s70, s71
    s_add_u32 m0, s51, 8192
    s_nop 0
    buffer_load_dwordx4 v228, s[16:19], s70 offen offset:0 lds
    buffer_load_dwordx4 v229, s[16:19], s70 offen offset:1024 lds
    buffer_load_dwordx4 v230, s[16:19], s70 offen offset:2048 lds
    buffer_load_dwordx4 v231, s[16:19], s70 offen offset:3072 lds
    s_add_u32 s70, s40, 1048576
    s_cmp_ge_u32 s70, 1835008
    s_cselect_b32 s71, 1835008, 0
    s_sub_u32 s70, s70, s71
    s_add_u32 m0, s51, 12288
    s_nop 0
    buffer_load_dwordx4 v228, s[16:19], s70 offen offset:0 lds
    buffer_load_dwordx4 v229, s[16:19], s70 offen offset:1024 lds
    buffer_load_dwordx4 v230, s[16:19], s70 offen offset:2048 lds
    buffer_load_dwordx4 v231, s[16:19], s70 offen offset:3072 lds
    s_add_u32 s70, s40, 1179648
    s_cmp_ge_u32 s70, 1835008
    s_cselect_b32 s71, 1835008, 0
    s_sub_u32 s70, s70, s71
    s_add_u32 m0, s51, 16384
    s_nop 0
    buffer_load_dwordx4 v228, s[16:19], s70 offen offset:0 lds
    buffer_load_dwordx4 v229, s[16:19], s70 offen offset:1024 lds
    buffer_load_dwordx4 v230, s[16:19], s70 offen offset:2048 lds
    buffer_load_dwordx4 v231, s[16:19], s70 offen offset:3072 lds
    s_add_u32 s70, s40, 1310720
    s_cmp_ge_u32 s70, 1835008
    s_cselect_b32 s71, 1835008, 0
    s_sub_u32 s70, s70, s71
    s_add_u32 m0, s50, 0
    s_nop 0
    s_nop 0
    buffer_load_dwordx4 v228, s[16:19], s70 offen offset:0 lds
    buffer_load_dwordx4 v229, s[16:19], s70 offen offset:1024 lds
    buffer_load_dwordx4 v230, s[16:19], s70 offen offset:2048 lds
    buffer_load_dwordx4 v231, s[16:19], s70 offen offset:3072 lds
    s_add_u32 s70, s40, 1441792
    s_cmp_ge_u32 s70, 1835008
    s_cselect_b32 s71, 1835008, 0
    s_sub_u32 s70, s70, s71
    s_add_u32 m0, s50, 4096
    s_nop 0
    buffer_load_dwordx4 v228, s[16:19], s70 offen offset:0 lds
    buffer_load_dwordx4 v229, s[16:19], s70 offen offset:1024 lds
    buffer_load_dwordx4 v230, s[16:19], s70 offen offset:2048 lds
    buffer_load_dwordx4 v231, s[16:19], s70 offen offset:3072 lds
    s_add_u32 s70, s40, 1572864
    s_cmp_ge_u32 s70, 1835008
    s_cselect_b32 s71, 1835008, 0
    s_sub_u32 s70, s70, s71
    s_add_u32 m0, s50, 8192
    s_nop 0
    buffer_load_dwordx4 v228, s[16:19], s70 offen offset:0 lds
    buffer_load_dwordx4 v229, s[16:19], s70 offen offset:1024 lds
    buffer_load_dwordx4 v230, s[16:19], s70 offen offset:2048 lds
    buffer_load_dwordx4 v231, s[16:19], s70 offen offset:3072 lds
    s_add_u32 s70, s40, 1703936
    s_cmp_ge_u32 s70, 1835008
    s_cselect_b32 s71, 1835008, 0
    s_sub_u32 s70, s70, s71
    s_add_u32 m0, s50, 12288
    s_nop 0
    buffer_load_dwordx4 v228, s[16:19], s70 offen offset:0 lds
    buffer_load_dwordx4 v229, s[16:19], s70 offen offset:1024 lds
    buffer_load_dwordx4 v230, s[16:19], s70 offen offset:2048 lds
    buffer_load_dwordx4 v231, s[16:19], s70 offen offset:3072 lds
    s_mul_i32 s66, s28, 401408
    s_mul_i32 s67, s33, 896
    s_add_u32 s66, s66, s67
    s_add_u32 s66, s66, 6291456
    v_lshrrev_b32 v4, 4, v1
    v_mul_u32_u24 v4, 7168, v4
    v_add_u32 v4, s66, v4
    v_and_b32 v5, 15, v1
    v_lshl_add_u32 v208, v5, 4, v4
    v_add_u32 v209, 768, v208
    v_mov_b32_e64 v4, 1073741824
    v_cmp_gt_u32 vcc, 8, v5
    s_nop 1
    v_cndmask_b32 v209, v4, v209, vcc
    s_add_u32 s70, s41, 0
    s_cmp_ge_u32 s70, 401408
    s_cselect_b32 s71, 401408, 0
    s_sub_u32 s70, s70, s71
    s_nop 0
    buffer_load_dwordx4 v[80:83], v208, s[4:7], s70 offen offset:0 sc1
    buffer_load_dwordx4 v[84:87], v208, s[4:7], s70 offen offset:256 sc1
    buffer_load_dwordx4 v[88:91], v208, s[4:7], s70 offen offset:512 sc1
    buffer_load_dwordx4 v[92:95], v209, s[4:7], s70 offen sc1
    s_add_u32 s70, s41, 28672
    s_cmp_ge_u32 s70, 401408
    s_cselect_b32 s71, 401408, 0
    s_sub_u32 s70, s70, s71
    s_nop 0
    buffer_load_dwordx4 v[96:99], v208, s[4:7], s70 offen offset:0 sc1
    buffer_load_dwordx4 v[100:103], v208, s[4:7], s70 offen offset:256 sc1
    buffer_load_dwordx4 v[104:107], v208, s[4:7], s70 offen offset:512 sc1
    buffer_load_dwordx4 v[108:111], v209, s[4:7], s70 offen sc1
    s_add_u32 s70, s41, 57344
    s_cmp_ge_u32 s70, 401408
    s_cselect_b32 s71, 401408, 0
    s_sub_u32 s70, s70, s71
    buffer_load_dwordx4 v[112:115], v208, s[4:7], s70 offen offset:0 sc1
    buffer_load_dwordx4 v[116:119], v208, s[4:7], s70 offen offset:256 sc1
    buffer_load_dwordx4 v[120:123], v208, s[4:7], s70 offen offset:512 sc1
    buffer_load_dwordx4 v[124:127], v209, s[4:7], s70 offen sc1
    s_waitcnt vmcnt(28)
    ds_read_b64_tr_b16 a[80:81], v248 offset:0
    ds_read_b64_tr_b16 a[82:83], v248 offset:512
    ds_read_b64_tr_b16 a[84:85], v249 offset:0
    ds_read_b64_tr_b16 a[86:87], v249 offset:512
    ds_read_b64_tr_b16 a[88:89], v250 offset:0
    ds_read_b64_tr_b16 a[90:91], v250 offset:512
    ds_read_b64_tr_b16 a[92:93], v251 offset:0
    ds_read_b64_tr_b16 a[94:95], v251 offset:512
    ds_read_b64_tr_b16 a[96:97], v248 offset:4096
    ds_read_b64_tr_b16 a[98:99], v248 offset:4608
    ds_read_b64_tr_b16 a[100:101], v249 offset:4096
    ds_read_b64_tr_b16 a[102:103], v249 offset:4608
    ds_read_b64_tr_b16 a[104:105], v250 offset:4096
    ds_read_b64_tr_b16 a[106:107], v250 offset:4608
    ds_read_b64_tr_b16 a[108:109], v251 offset:4096
    ds_read_b64_tr_b16 a[110:111], v251 offset:4608
    ds_read_b64_tr_b16 a[112:113], v248 offset:8192
    ds_read_b64_tr_b16 a[114:115], v248 offset:8704
    ds_read_b64_tr_b16 a[116:117], v249 offset:8192
    ds_read_b64_tr_b16 a[118:119], v249 offset:8704
    ds_read_b64_tr_b16 a[120:121], v250 offset:8192
    ds_read_b64_tr_b16 a[122:123], v250 offset:8704
    ds_read_b64_tr_b16 a[124:125], v251 offset:8192
    ds_read_b64_tr_b16 a[126:127], v251 offset:8704
    ds_read_b64_tr_b16 a[128:129], v248 offset:12288
    ds_read_b64_tr_b16 a[130:131], v248 offset:12800
    ds_read_b64_tr_b16 a[132:133], v249 offset:12288
    ds_read_b64_tr_b16 a[134:135], v249 offset:12800
    ds_read_b64_tr_b16 a[136:137], v250 offset:12288
    ds_read_b64_tr_b16 a[138:139], v250 offset:12800
    ds_read_b64_tr_b16 a[140:141], v251 offset:12288
    ds_read_b64_tr_b16 a[142:143], v251 offset:12800
    ds_read_b64_tr_b16 a[144:145], v248 offset:16384
    ds_read_b64_tr_b16 a[146:147], v248 offset:16896
    ds_read_b64_tr_b16 a[148:149], v249 offset:16384
    ds_read_b64_tr_b16 a[150:151], v249 offset:16896
    ds_read_b64_tr_b16 a[152:153], v250 offset:16384
    ds_read_b64_tr_b16 a[154:155], v250 offset:16896
    ds_read_b64_tr_b16 a[156:157], v251 offset:16384
    ds_read_b64_tr_b16 a[158:159], v251 offset:16896
    s_waitcnt vmcnt(12)
    s_nop 0
    ds_read_b64_tr_b16 a[160:161], v244 offset:0
    ds_read_b64_tr_b16 a[162:163], v244 offset:512
    ds_read_b64_tr_b16 a[164:165], v245 offset:0
    ds_read_b64_tr_b16 a[166:167], v245 offset:512
    ds_read_b64_tr_b16 a[168:169], v246 offset:0
    ds_read_b64_tr_b16 a[170:171], v246 offset:512
    ds_read_b64_tr_b16 a[172:173], v247 offset:0
    ds_read_b64_tr_b16 a[174:175], v247 offset:512
    ds_read_b64_tr_b16 a[176:177], v244 offset:4096
    ds_read_b64_tr_b16 a[178:179], v244 offset:4608
    ds_read_b64_tr_b16 a[180:181], v245 offset:4096
    ds_read_b64_tr_b16 a[182:183], v245 offset:4608
    ds_read_b64_tr_b16 a[184:185], v246 offset:4096
    ds_read_b64_tr_b16 a[186:187], v246 offset:4608
    ds_read_b64_tr_b16 a[188:189], v247 offset:4096
    ds_read_b64_tr_b16 a[190:191], v247 offset:4608
    ds_read_b64_tr_b16 a[192:193], v244 offset:8192
    ds_read_b64_tr_b16 a[194:195], v244 offset:8704
    ds_read_b64_tr_b16 a[196:197], v245 offset:8192
    ds_read_b64_tr_b16 a[198:199], v245 offset:8704
    ds_read_b64_tr_b16 a[200:201], v246 offset:8192
    ds_read_b64_tr_b16 a[202:203], v246 offset:8704
    ds_read_b64_tr_b16 a[204:205], v247 offset:8192
    ds_read_b64_tr_b16 a[206:207], v247 offset:8704
    ds_read_b64_tr_b16 a[208:209], v244 offset:12288
    ds_read_b64_tr_b16 a[210:211], v244 offset:12800
    ds_read_b64_tr_b16 a[212:213], v245 offset:12288
    ds_read_b64_tr_b16 a[214:215], v245 offset:12800
    ds_read_b64_tr_b16 a[216:217], v246 offset:12288
    ds_read_b64_tr_b16 a[218:219], v246 offset:12800
    ds_read_b64_tr_b16 a[220:221], v247 offset:12288
    ds_read_b64_tr_b16 a[222:223], v247 offset:12800
    s_waitcnt lgkmcnt(0)
noconv_6:
    s_barrier
    s_waitcnt vmcnt(8)
    s_add_u32 s70, s41, 86016
    s_cmp_ge_u32 s70, 401408
    s_cselect_b32 s71, 401408, 0
    s_sub_u32 s70, s70, s71
    buffer_load_dwordx4 v[128:131], v208, s[4:7], s70 offen offset:0 sc1
    buffer_load_dwordx4 v[132:135], v208, s[4:7], s70 offen offset:256 sc1
    buffer_load_dwordx4 v[136:139], v208, s[4:7], s70 offen offset:512 sc1
    buffer_load_dwordx4 v[140:143], v209, s[4:7], s70 offen sc1
    v_max3_u32 v214, v80, v81, v82
    v_max3_u32 v214, v214, v83, v84
    v_max3_u32 v214, v214, v85, v86
    v_max3_u32 v214, v214, v87, v88
    v_max3_u32 v214, v214, v89, v90
    v_max3_u32 v214, v214, v91, v92
    v_max3_u32 v214, v214, v93, v94
    v_max_u32 v214, v214, v95
    v_cmp_eq_u32 vcc, -1, v214
    s_nop 3
    s_cbranch_vccnz slow_74
back_75:
    v_mfma_f32_16x16x32_bf16 v[16:19], v[80:83], a[0:3], 0
    v_mfma_f32_16x16x32_bf16 v[32:35], v[84:87], a[0:3], 0
    v_mfma_f32_16x16x32_bf16 v[48:51], v[88:91], a[0:3], 0
    v_mfma_f32_16x16x32_bf16 v[64:67], v[92:95], a[0:3], 0
    v_mfma_f32_16x16x32_bf16 v[20:23], v[80:83], a[4:7], 0
    v_mfma_f32_16x16x32_bf16 v[36:39], v[84:87], a[4:7], 0
    v_mfma_f32_16x16x32_bf16 v[52:55], v[88:91], a[4:7], 0
    v_mfma_f32_16x16x32_bf16 v[68:71], v[92:95], a[4:7], 0
    s_waitcnt vmcnt(8)
    s_nop 0
    v_mfma_f32_16x16x32_bf16 v[24:27], v[80:83], a[8:11], 0
    s_add_u32 s70, s41, 114688
    s_cmp_ge_u32 s70, 401408
    s_cselect_b32 s71, 401408, 0
    v_mfma_f32_16x16x32_bf16 v[40:43], v[84:87], a[8:11], 0
    s_sub_u32 s70, s70, s71
    s_nop 0
    buffer_load_dwordx4 v[144:147], v208, s[4:7], s70 offen offset:0 sc1
    buffer_load_dwordx4 v[148:151], v208, s[4:7], s70 offen offset:256 sc1
    v_mfma_f32_16x16x32_bf16 v[56:59], v[88:91], a[8:11], 0
    buffer_load_dwordx4 v[152:155], v208, s[4:7], s70 offen offset:512 sc1
    buffer_load_dwordx4 v[156:159], v209, s[4:7], s70 offen sc1
    v_max3_u32 v214, v96, v97, v98
    v_mfma_f32_16x16x32_bf16 v[72:75], v[92:95], a[8:11], 0
    v_max3_u32 v214, v214, v99, v100
    v_max3_u32 v214, v214, v101, v102
    v_max3_u32 v214, v214, v103, v104
    v_mfma_f32_16x16x32_bf16 v[28:31], v[80:83], a[12:15], 0
    v_max3_u32 v214, v214, v105, v106
    v_max3_u32 v214, v214, v107, v108
    v_max3_u32 v214, v214, v109, v110
    v_mfma_f32_16x16x32_bf16 v[44:47], v[84:87], a[12:15], 0
    v_max_u32 v214, v214, v111
    v_cmp_eq_u32 vcc, -1, v214
    v_mfma_f32_16x16x32_bf16 v[60:63], v[88:91], a[12:15], 0
    v_mfma_f32_16x16x32_bf16 v[76:79], v[92:95], a[12:15], 0
    s_nop 1
    s_cbranch_vccnz slow_77
back_78:
    v_mfma_f32_16x16x32_bf16 v[16:19], v[96:99], a[16:19], v[16:19]
    v_mfma_f32_16x16x32_bf16 v[32:35], v[100:103], a[16:19], v[32:35]
    v_mfma_f32_16x16x32_bf16 v[48:51], v[104:107], a[16:19], v[48:51]
    v_mfma_f32_16x16x32_bf16 v[64:67], v[108:111], a[16:19], v[64:67]
    v_mfma_f32_16x16x32_bf16 v[20:23], v[96:99], a[20:23], v[20:23]
    v_mfma_f32_16x16x32_bf16 v[36:39], v[100:103], a[20:23], v[36:39]
    v_mfma_f32_16x16x32_bf16 v[52:55], v[104:107], a[20:23], v[52:55]
    v_mfma_f32_16x16x32_bf16 v[68:71], v[108:111], a[20:23], v[68:71]
    s_waitcnt vmcnt(8)
    s_nop 0
    v_mfma_f32_16x16x32_bf16 v[24:27], v[96:99], a[24:27], v[24:27]
    s_add_u32 s70, s41, 143360
    s_cmp_ge_u32 s70, 401408
    s_cselect_b32 s71, 401408, 0
    v_mfma_f32_16x16x32_bf16 v[40:43], v[100:103], a[24:27], v[40:43]
    s_sub_u32 s70, s70, s71
    s_nop 0
    buffer_load_dwordx4 v[160:163], v208, s[4:7], s70 offen offset:0 sc1
    buffer_load_dwordx4 v[164:167], v208, s[4:7], s70 offen offset:256 sc1
    v_mfma_f32_16x16x32_bf16 v[56:59], v[104:107], a[24:27], v[56:59]
    buffer_load_dwordx4 v[168:171], v208, s[4:7], s70 offen offset:512 sc1
    buffer_load_dwordx4 v[172:175], v209, s[4:7], s70 offen sc1
    v_max3_u32 v214, v112, v113, v114
    v_mfma_f32_16x16x32_bf16 v[72:75], v[108:111], a[24:27], v[72:75]
    v_max3_u32 v214, v214, v115, v116
    v_max3_u32 v214, v214, v117, v118
    v_max3_u32 v214, v214, v119, v120
    v_mfma_f32_16x16x32_bf16 v[28:31], v[96:99], a[28:31], v[28:31]
    v_max3_u32 v214, v214, v121, v122
    v_max3_u32 v214, v214, v123, v124
    v_max3_u32 v214, v214, v125, v126
    v_mfma_f32_16x16x32_bf16 v[44:47], v[100:103], a[28:31], v[44:47]
    v_max_u32 v214, v214, v127
    v_cmp_eq_u32 vcc, -1, v214
    v_mfma_f32_16x16x32_bf16 v[60:63], v[104:107], a[28:31], v[60:63]
    v_mfma_f32_16x16x32_bf16 v[76:79], v[108:111], a[28:31], v[76:79]
    s_nop 1
    s_cbranch_vccnz slow_80
back_81:
    v_mfma_f32_16x16x32_bf16 v[16:19], v[112:115], a[32:35], v[16:19]
    v_mfma_f32_16x16x32_bf16 v[32:35], v[116:119], a[32:35], v[32:35]
    v_mfma_f32_16x16x32_bf16 v[48:51], v[120:123], a[32:35], v[48:51]
    v_mfma_f32_16x16x32_bf16 v[64:67], v[124:127], a[32:35], v[64:67]
    v_mfma_f32_16x16x32_bf16 v[20:23], v[112:115], a[36:39], v[20:23]
    v_mfma_f32_16x16x32_bf16 v[36:39], v[116:119], a[36:39], v[36:39]
    v_mfma_f32_16x16x32_bf16 v[52:55], v[120:123], a[36:39], v[52:55]
    v_mfma_f32_16x16x32_bf16 v[68:71], v[124:127], a[36:39], v[68:71]
    s_waitcnt vmcnt(8)
    s_nop 0
    v_mfma_f32_16x16x32_bf16 v[24:27], v[112:115], a[40:43], v[24:27]
    s_add_u32 s70, s41, 172032
    s_cmp_ge_u32 s70, 401408
    s_cselect_b32 s71, 401408, 0
    v_mfma_f32_16x16x32_bf16 v[40:43], v[116:119], a[40:43], v[40:43]
    s_sub_u32 s70, s70, s71
    s_nop 0
    buffer_load_dwordx4 v[80:83], v208, s[4:7], s70 offen offset:0 sc1
    buffer_load_dwordx4 v[84:87], v208, s[4:7], s70 offen offset:256 sc1
    v_mfma_f32_16x16x32_bf16 v[56:59], v[120:123], a[40:43], v[56:59]
    buffer_load_dwordx4 v[88:91], v208, s[4:7], s70 offen offset:512 sc1
    buffer_load_dwordx4 v[92:95], v209, s[4:7], s70 offen sc1
    v_max3_u32 v214, v128, v129, v130
    v_mfma_f32_16x16x32_bf16 v[72:75], v[124:127], a[40:43], v[72:75]
    v_max3_u32 v214, v214, v131, v132
    v_max3_u32 v214, v214, v133, v134
    v_max3_u32 v214, v214, v135, v136
    v_mfma_f32_16x16x32_bf16 v[28:31], v[112:115], a[44:47], v[28:31]
    v_max3_u32 v214, v214, v137, v138
    v_max3_u32 v214, v214, v139, v140
    v_max3_u32 v214, v214, v141, v142
    v_mfma_f32_16x16x32_bf16 v[44:47], v[116:119], a[44:47], v[44:47]
    v_max_u32 v214, v214, v143
    v_cmp_eq_u32 vcc, -1, v214
    v_mfma_f32_16x16x32_bf16 v[60:63], v[120:123], a[44:47], v[60:63]
    v_mfma_f32_16x16x32_bf16 v[76:79], v[124:127], a[44:47], v[76:79]
    s_nop 1
    s_cbranch_vccnz slow_83
back_84:
    v_mfma_f32_16x16x32_bf16 v[16:19], v[128:131], a[48:51], v[16:19]
    v_mfma_f32_16x16x32_bf16 v[32:35], v[132:135], a[48:51], v[32:35]
    v_mfma_f32_16x16x32_bf16 v[48:51], v[136:139], a[48:51], v[48:51]
    v_mfma_f32_16x16x32_bf16 v[64:67], v[140:143], a[48:51], v[64:67]
    v_mfma_f32_16x16x32_bf16 v[20:23], v[128:131], a[52:55], v[20:23]
    v_mfma_f32_16x16x32_bf16 v[36:39], v[132:135], a[52:55], v[36:39]
    v_mfma_f32_16x16x32_bf16 v[52:55], v[136:139], a[52:55], v[52:55]
    v_mfma_f32_16x16x32_bf16 v[68:71], v[140:143], a[52:55], v[68:71]
    s_waitcnt vmcnt(8)
    s_nop 0
    v_mfma_f32_16x16x32_bf16 v[24:27], v[128:131], a[56:59], v[24:27]
    s_add_u32 s70, s41, 200704
    s_cmp_ge_u32 s70, 401408
    s_cselect_b32 s71, 401408, 0
    v_mfma_f32_16x16x32_bf16 v[40:43], v[132:135], a[56:59], v[40:43]
    s_sub_u32 s70, s70, s71
    s_nop 0
    buffer_load_dwordx4 v[96:99], v208, s[4:7], s70 offen offset:0 sc1
    buffer_load_dwordx4 v[100:103], v208, s[4:7], s70 offen offset:256 sc1
    v_mfma_f32_16x16x32_bf16 v[56:59], v[136:139], a[56:59], v[56:59]
    buffer_load_dwordx4 v[104:107], v208, s[4:7], s70 offen offset:512 sc1
    buffer_load_dwordx4 v[108:111], v209, s[4:7], s70 offen sc1
    v_max3_u32 v214, v144, v145, v146
    v_mfma_f32_16x16x32_bf16 v[72:75], v[140:143], a[56:59], v[72:75]
    v_max3_u32 v214, v214, v147, v148
    v_max3_u32 v214, v214, v149, v150
    v_max3_u32 v214, v214, v151, v152
    v_mfma_f32_16x16x32_bf16 v[28:31], v[128:131], a[60:63], v[28:31]
    v_max3_u32 v214, v214, v153, v154
    v_max3_u32 v214, v214, v155, v156
    v_max3_u32 v214, v214, v157, v158
    v_mfma_f32_16x16x32_bf16 v[44:47], v[132:135], a[60:63], v[44:47]
    v_max_u32 v214, v214, v159
    v_cmp_eq_u32 vcc, -1, v214
    v_mfma_f32_16x16x32_bf16 v[60:63], v[136:139], a[60:63], v[60:63]
    v_mfma_f32_16x16x32_bf16 v[76:79], v[140:143], a[60:63], v[76:79]
    s_nop 1
    s_cbranch_vccnz slow_86
back_87:
    v_mfma_f32_16x16x32_bf16 v[16:19], v[144:147], a[64:67], v[16:19]
    v_mfma_f32_16x16x32_bf16 v[32:35], v[148:151], a[64:67], v[32:35]
    v_mfma_f32_16x16x32_bf16 v[48:51], v[152:155], a[64:67], v[48:51]
    v_mfma_f32_16x16x32_bf16 v[64:67], v[156:159], a[64:67], v[64:67]
    v_mfma_f32_16x16x32_bf16 v[20:23], v[144:147], a[68:71], v[20:23]
    v_mfma_f32_16x16x32_bf16 v[36:39], v[148:151], a[68:71], v[36:39]
    v_mfma_f32_16x16x32_bf16 v[52:55], v[152:155], a[68:71], v[52:55]
    v_mfma_f32_16x16x32_bf16 v[68:71], v[156:159], a[68:71], v[68:71]
    s_waitcnt vmcnt(8)
    s_nop 0
    v_mfma_f32_16x16x32_bf16 v[24:27], v[144:147], a[72:75], v[24:27]
    s_add_u32 s70, s41, 229376
    s_cmp_ge_u32 s70, 401408
    s_cselect_b32 s71, 401408, 0
    v_mfma_f32_16x16x32_bf16 v[40:43], v[148:151], a[72:75], v[40:43]
    s_sub_u32 s70, s70, s71
    s_nop 0
    buffer_load_dwordx4 v[112:115], v208, s[4:7], s70 offen offset:0 sc1
    buffer_load_dwordx4 v[116:119], v208, s[4:7], s70 offen offset:256 sc1
    v_mfma_f32_16x16x32_bf16 v[56:59], v[152:155], a[72:75], v[56:59]
    buffer_load_dwordx4 v[120:123], v208, s[4:7], s70 offen offset:512 sc1
    buffer_load_dwordx4 v[124:127], v209, s[4:7], s70 offen sc1
    v_max3_u32 v214, v160, v161, v162
    v_mfma_f32_16x16x32_bf16 v[72:75], v[156:159], a[72:75], v[72:75]
    v_max3_u32 v214, v214, v163, v164
    v_max3_u32 v214, v214, v165, v166
    v_max3_u32 v214, v214, v167, v168
    v_mfma_f32_16x16x32_bf16 v[28:31], v[144:147], a[76:79], v[28:31]
    v_max3_u32 v214, v214, v169, v170
    v_max3_u32 v214, v214, v171, v172
    v_max3_u32 v214, v214, v173, v174
    v_mfma_f32_16x16x32_bf16 v[44:47], v[148:151], a[76:79], v[44:47]
    v_max_u32 v214, v214, v175
    v_cmp_eq_u32 vcc, -1, v214
    v_mfma_f32_16x16x32_bf16 v[60:63], v[152:155], a[76:79], v[60:63]
    v_mfma_f32_16x16x32_bf16 v[76:79], v[156:159], a[76:79], v[76:79]
    s_nop 1
    s_cbranch_vccnz slow_89
back_90:
    v_mfma_f32_16x16x32_bf16 v[16:19], v[160:163], a[80:83], v[16:19]
    v_mfma_f32_16x16x32_bf16 v[32:35], v[164:167], a[80:83], v[32:35]
    v_mfma_f32_16x16x32_bf16 v[48:51], v[168:171], a[80:83], v[48:51]
    v_mfma_f32_16x16x32_bf16 v[64:67], v[172:175], a[80:83], v[64:67]
    v_mfma_f32_16x16x32_bf16 v[20:23], v[160:163], a[84:87], v[20:23]
    v_mfma_f32_16x16x32_bf16 v[36:39], v[164:167], a[84:87], v[36:39]
    v_mfma_f32_16x16x32_bf16 v[52:55], v[168:171], a[84:87], v[52:55]
    v_mfma_f32_16x16x32_bf16 v[68:71], v[172:175], a[84:87], v[68:71]
    s_waitcnt vmcnt(8)
    s_nop 0
    v_mfma_f32_16x16x32_bf16 v[24:27], v[160:163], a[88:91], v[24:27]
    s_add_u32 s70, s41, 258048
    s_cmp_ge_u32 s70, 401408
    s_cselect_b32 s71, 401408, 0
    v_mfma_f32_16x16x32_bf16 v[40:43], v[164:167], a[88:91], v[40:43]
    s_sub_u32 s70, s70, s71
    s_nop 0
    buffer_load_dwordx4 v[128:131], v208, s[4:7], s70 offen offset:0 sc1
    buffer_load_dwordx4 v[132:135], v208, s[4:7], s70 offen offset:256 sc1
    v_mfma_f32_16x16x32_bf16 v[56:59], v[168:171], a[88:91], v[56:59]
    buffer_load_dwordx4 v[136:139], v208, s[4:7], s70 offen offset:512 sc1
    buffer_load_dwordx4 v[140:143], v209, s[4:7], s70 offen sc1
    v_max3_u32 v214, v80, v81, v82
    v_mfma_f32_16x16x32_bf16 v[72:75], v[172:175], a[88:91], v[72:75]
    v_max3_u32 v214, v214, v83, v84
    v_max3_u32 v214, v214, v85, v86
    v_max3_u32 v214, v214, v87, v88
    v_mfma_f32_16x16x32_bf16 v[28:31], v[160:163], a[92:95], v[28:31]
    v_max3_u32 v214, v214, v89, v90
    v_max3_u32 v214, v214, v91, v92
    v_max3_u32 v214, v214, v93, v94
    v_mfma_f32_16x16x32_bf16 v[44:47], v[164:167], a[92:95], v[44:47]
    v_max_u32 v214, v214, v95
    v_cmp_eq_u32 vcc, -1, v214
    v_mfma_f32_16x16x32_bf16 v[60:63], v[168:171], a[92:95], v[60:63]
    v_mfma_f32_16x16x32_bf16 v[76:79], v[172:175], a[92:95], v[76:79]
    s_nop 1
    s_cbranch_vccnz slow_92
back_93:
    v_mfma_f32_16x16x32_bf16 v[16:19], v[80:83], a[96:99], v[16:19]
    v_mfma_f32_16x16x32_bf16 v[32:35], v[84:87], a[96:99], v[32:35]
    v_mfma_f32_16x16x32_bf16 v[48:51], v[88:91], a[96:99], v[48:51]
    v_mfma_f32_16x16x32_bf16 v[64:67], v[92:95], a[96:99], v[64:67]
    v_mfma_f32_16x16x32_bf16 v[20:23], v[80:83], a[100:103], v[20:23]
    v_mfma_f32_16x16x32_bf16 v[36:39], v[84:87], a[100:103], v[36:39]
    v_mfma_f32_16x16x32_bf16 v[52:55], v[88:91], a[100:103], v[52:55]
    v_mfma_f32_16x16x32_bf16 v[68:71], v[92:95], a[100:103], v[68:71]
    s_waitcnt vmcnt(8)
    s_nop 0
    v_mfma_f32_16x16x32_bf16 v[24:27], v[80:83], a[104:107], v[24:27]
    s_add_u32 s70, s41, 286720
    s_cmp_ge_u32 s70, 401408
    s_cselect_b32 s71, 401408, 0
    v_mfma_f32_16x16x32_bf16 v[40:43], v[84:87], a[104:107], v[40:43]
    s_sub_u32 s70, s70, s71
    s_nop 0
    buffer_load_dwordx4 v[144:147], v208, s[4:7], s70 offen offset:0 sc1
    buffer_load_dwordx4 v[148:151], v208, s[4:7], s70 offen offset:256 sc1
    v_mfma_f32_16x16x32_bf16 v[56:59], v[88:91], a[104:107], v[56:59]
    buffer_load_dwordx4 v[152:155], v208, s[4:7], s70 offen offset:512 sc1
    buffer_load_dwordx4 v[156:159], v209, s[4:7], s70 offen sc1
    v_max3_u32 v214, v96, v97, v98
    v_mfma_f32_16x16x32_bf16 v[72:75], v[92:95], a[104:107], v[72:75]
    v_max3_u32 v214, v214, v99, v100
    v_max3_u32 v214, v214, v101, v102
    v_max3_u32 v214, v214, v103, v104
    v_mfma_f32_16x16x32_bf16 v[28:31], v[80:83], a[108:111], v[28:31]
    v_max3_u32 v214, v214, v105, v106
    v_max3_u32 v214, v214, v107, v108
    v_max3_u32 v214, v214, v109, v110
    v_mfma_f32_16x16x32_bf16 v[44:47], v[84:87], a[108:111], v[44:47]
    v_max_u32 v214, v214, v111
    v_cmp_eq_u32 vcc, -1, v214
    v_mfma_f32_16x16x32_bf16 v[60:63], v[88:91], a[108:111], v[60:63]
    v_mfma_f32_16x16x32_bf16 v[76:79], v[92:95], a[108:111], v[76:79]
    s_nop 1
    s_cbranch_vccnz slow_95
back_96:
    v_mfma_f32_16x16x32_bf16 v[16:19], v[96:99], a[112:115], v[16:19]
    v_mfma_f32_16x16x32_bf16 v[32:35], v[100:103], a[112:115], v[32:35]
    v_mfma_f32_16x16x32_bf16 v[48:51], v[104:107], a[112:115], v[48:51]
    v_mfma_f32_16x16x32_bf16 v[64:67], v[108:111], a[112:115], v[64:67]
    v_mfma_f32_16x16x32_bf16 v[20:23], v[96:99], a[116:119], v[20:23]
    v_mfma_f32_16x16x32_bf16 v[36:39], v[100:103], a[116:119], v[36:39]
    v_mfma_f32_16x16x32_bf16 v[52:55], v[104:107], a[116:119], v[52:55]
    v_mfma_f32_16x16x32_bf16 v[68:71], v[108:111], a[116:119], v[68:71]
    s_waitcnt vmcnt(8)
    s_nop 0
    v_mfma_f32_16x16x32_bf16 v[24:27], v[96:99], a[120:123], v[24:27]
    s_add_u32 s70, s41, 315392
    s_cmp_ge_u32 s70, 401408
    s_cselect_b32 s71, 401408, 0
    v_mfma_f32_16x16x32_bf16 v[40:43], v[100:103], a[120:123], v[40:43]
    s_sub_u32 s70, s70, s71
    s_nop 0
    buffer_load_dwordx4 v[160:163], v208, s[4:7], s70 offen offset:0 sc1
    buffer_load_dwordx4 v[164:167], v208, s[4:7], s70 offen offset:256 sc1
    v_mfma_f32_16x16x32_bf16 v[56:59], v[104:107], a[120:123], v[56:59]
    buffer_load_dwordx4 v[168:171], v208, s[4:7], s70 offen offset:512 sc1
    buffer_load_dwordx4 v[172:175], v209, s[4:7], s70 offen sc1
    v_max3_u32 v214, v112, v113, v114
    v_mfma_f32_16x16x32_bf16 v[72:75], v[108:111], a[120:123], v[72:75]
    v_max3_u32 v214, v214, v115, v116
    v_max3_u32 v214, v214, v117, v118
    v_max3_u32 v214, v214, v119, v120
    v_mfma_f32_16x16x32_bf16 v[28:31], v[96:99], a[124:127], v[28:31]
    v_max3_u32 v214, v214, v121, v122
    v_max3_u32 v214, v214, v123, v124
    v_max3_u32 v214, v214, v125, v126
    v_mfma_f32_16x16x32_bf16 v[44:47], v[100:103], a[124:127], v[44:47]
    v_max_u32 v214, v214, v127
    v_cmp_eq_u32 vcc, -1, v214
    v_mfma_f32_16x16x32_bf16 v[60:63], v[104:107], a[124:127], v[60:63]
    v_mfma_f32_16x16x32_bf16 v[76:79], v[108:111], a[124:127], v[76:79]
    s_nop 1
    s_cbranch_vccnz slow_98
back_99:
    v_mfma_f32_16x16x32_bf16 v[16:19], v[112:115], a[128:131], v[16:19]
    v_mfma_f32_16x16x32_bf16 v[32:35], v[116:119], a[128:131], v[32:35]
    v_mfma_f32_16x16x32_bf16 v[48:51], v[120:123], a[128:131], v[48:51]
    v_mfma_f32_16x16x32_bf16 v[64:67], v[124:127], a[128:131], v[64:67]
    v_mfma_f32_16x16x32_bf16 v[20:23], v[112:115], a[132:135], v[20:23]
    v_mfma_f32_16x16x32_bf16 v[36:39], v[116:119], a[132:135], v[36:39]
    v_mfma_f32_16x16x32_bf16 v[52:55], v[120:123], a[132:135], v[52:55]
    v_mfma_f32_16x16x32_bf16 v[68:71], v[124:127], a[132:135], v[68:71]
    s_waitcnt vmcnt(8)
    s_nop 0
    v_mfma_f32_16x16x32_bf16 v[24:27], v[112:115], a[136:139], v[24:27]
    s_add_u32 s70, s41, 344064
    s_cmp_ge_u32 s70, 401408
    s_cselect_b32 s71, 401408, 0
    v_mfma_f32_16x16x32_bf16 v[40:43], v[116:119], a[136:139], v[40:43]
    s_sub_u32 s70, s70, s71
    s_nop 0
    buffer_load_dwordx4 v[80:83], v208, s[4:7], s70 offen offset:0 sc1
    buffer_load_dwordx4 v[84:87], v208, s[4:7], s70 offen offset:256 sc1
    v_mfma_f32_16x16x32_bf16 v[56:59], v[120:123], a[136:139], v[56:59]
    buffer_load_dwordx4 v[88:91], v208, s[4:7], s70 offen offset:512 sc1
    buffer_load_dwordx4 v[92:95], v209, s[4:7], s70 offen sc1
    v_max3_u32 v214, v128, v129, v130
    v_mfma_f32_16x16x32_bf16 v[72:75], v[124:127], a[136:139], v[72:75]
    v_max3_u32 v214, v214, v131, v132
    v_max3_u32 v214, v214, v133, v134
    v_max3_u32 v214, v214, v135, v136
    v_mfma_f32_16x16x32_bf16 v[28:31], v[112:115], a[140:143], v[28:31]
    v_max3_u32 v214, v214, v137, v138
    v_max3_u32 v214, v214, v139, v140
    v_max3_u32 v214, v214, v141, v142
    v_mfma_f32_16x16x32_bf16 v[44:47], v[116:119], a[140:143], v[44:47]
    v_max_u32 v214, v214, v143
    v_cmp_eq_u32 vcc, -1, v214
    v_mfma_f32_16x16x32_bf16 v[60:63], v[120:123], a[140:143], v[60:63]
    v_mfma_f32_16x16x32_bf16 v[76:79], v[124:127], a[140:143], v[76:79]
    s_nop 1
    s_cbranch_vccnz slow_101
back_102:
    v_mfma_f32_16x16x32_bf16 v[16:19], v[128:131], a[144:147], v[16:19]
    v_mfma_f32_16x16x32_bf16 v[32:35], v[132:135], a[144:147], v[32:35]
    v_mfma_f32_16x16x32_bf16 v[48:51], v[136:139], a[144:147], v[48:51]
    v_mfma_f32_16x16x32_bf16 v[64:67], v[140:143], a[144:147], v[64:67]
    v_mfma_f32_16x16x32_bf16 v[20:23], v[128:131], a[148:151], v[20:23]
    v_mfma_f32_16x16x32_bf16 v[36:39], v[132:135], a[148:151], v[36:39]
    v_mfma_f32_16x16x32_bf16 v[52:55], v[136:139], a[148:151], v[52:55]
    v_mfma_f32_16x16x32_bf16 v[68:71], v[140:143], a[148:151], v[68:71]
    s_waitcnt vmcnt(8)
    s_nop 0
    v_mfma_f32_16x16x32_bf16 v[24:27], v[128:131], a[152:155], v[24:27]
    s_add_u32 s70, s41, 372736
    s_cmp_ge_u32 s70, 401408
    s_cselect_b32 s71, 401408, 0
    v_mfma_f32_16x16x32_bf16 v[40:43], v[132:135], a[152:155], v[40:43]
    s_sub_u32 s70, s70, s71
    s_nop 0
    buffer_load_dwordx4 v[96:99], v208, s[4:7], s70 offen offset:0 sc1
    buffer_load_dwordx4 v[100:103], v208, s[4:7], s70 offen offset:256 sc1
    v_mfma_f32_16x16x32_bf16 v[56:59], v[136:139], a[152:155], v[56:59]
    buffer_load_dwordx4 v[104:107], v208, s[4:7], s70 offen offset:512 sc1
    buffer_load_dwordx4 v[108:111], v209, s[4:7], s70 offen sc1
    v_max3_u32 v214, v144, v145, v146
    v_mfma_f32_16x16x32_bf16 v[72:75], v[140:143], a[152:155], v[72:75]
    v_max3_u32 v214, v214, v147, v148
    v_max3_u32 v214, v214, v149, v150
    v_max3_u32 v214, v214, v151, v152
    v_mfma_f32_16x16x32_bf16 v[28:31], v[128:131], a[156:159], v[28:31]
    v_max3_u32 v214, v214, v153, v154
    v_max3_u32 v214, v214, v155, v156
    v_max3_u32 v214, v214, v157, v158
    v_mfma_f32_16x16x32_bf16 v[44:47], v[132:135], a[156:159], v[44:47]
    v_max_u32 v214, v214, v159
    v_cmp_eq_u32 vcc, -1, v214
    v_mfma_f32_16x16x32_bf16 v[60:63], v[136:139], a[156:159], v[60:63]
    v_mfma_f32_16x16x32_bf16 v[76:79], v[140:143], a[156:159], v[76:79]
    s_nop 1
    s_cbranch_vccnz slow_104
back_105:
    v_mfma_f32_16x16x32_bf16 v[16:19], v[144:147], a[160:163], v[16:19]
    v_mfma_f32_16x16x32_bf16 v[32:35], v[148:151], a[160:163], v[32:35]
    v_mfma_f32_16x16x32_bf16 v[48:51], v[152:155], a[160:163], v[48:51]
    v_mfma_f32_16x16x32_bf16 v[64:67], v[156:159], a[160:163], v[64:67]
    v_mfma_f32_16x16x32_bf16 v[20:23], v[144:147], a[164:167], v[20:23]
    v_mfma_f32_16x16x32_bf16 v[36:39], v[148:151], a[164:167], v[36:39]
    v_mfma_f32_16x16x32_bf16 v[52:55], v[152:155], a[164:167], v[52:55]
    v_mfma_f32_16x16x32_bf16 v[68:71], v[156:159], a[164:167], v[68:71]
    s_waitcnt vmcnt(8)
    s_nop 0
    v_mfma_f32_16x16x32_bf16 v[24:27], v[144:147], a[168:171], v[24:27]
    buffer_load_dwordx4 v[196:199], v211, s[4:7], 0 offen sc1
    s_mov_b32 s70, 7168
    v_mfma_f32_16x16x32_bf16 v[40:43], v[148:151], a[168:171], v[40:43]
    buffer_load_dwordx4 v[200:203], v211, s[4:7], s70 offen sc1
    buffer_load_ushort v204, v212, s[24:27], 0 offen
    v_mfma_f32_16x16x32_bf16 v[56:59], v[152:155], a[168:171], v[56:59]
    buffer_load_ushort v205, v212, s[24:27], 0 offen offset:16
    v_max3_u32 v214, v160, v161, v162
    v_mfma_f32_16x16x32_bf16 v[72:75], v[156:159], a[168:171], v[72:75]
    v_max3_u32 v214, v214, v163, v164
    v_max3_u32 v214, v214, v165, v166
    v_mfma_f32_16x16x32_bf16 v[28:31], v[144:147], a[172:175], v[28:31]
    v_max3_u32 v214, v214, v167, v168
    v_max3_u32 v214, v214, v169, v170
    v_mfma_f32_16x16x32_bf16 v[44:47], v[148:151], a[172:175], v[44:47]
    v_max3_u32 v214, v214, v171, v172
    v_max3_u32 v214, v214, v173, v174
    v_mfma_f32_16x16x32_bf16 v[60:63], v[152:155], a[172:175], v[60:63]
    v_max_u32 v214, v214, v175
    v_cmp_eq_u32 vcc, -1, v214
    v_mfma_f32_16x16x32_bf16 v[76:79], v[156:159], a[172:175], v[76:79]
    s_nop 2
    s_cbranch_vccnz slow_107
back_108:
    v_mfma_f32_16x16x32_bf16 v[16:19], v[160:163], a[176:179], v[16:19]
    v_mfma_f32_16x16x32_bf16 v[32:35], v[164:167], a[176:179], v[32:35]
    v_mfma_f32_16x16x32_bf16 v[48:51], v[168:171], a[176:179], v[48:51]
    v_mfma_f32_16x16x32_bf16 v[64:67], v[172:175], a[176:179], v[64:67]
    v_mfma_f32_16x16x32_bf16 v[20:23], v[160:163], a[180:183], v[20:23]
    v_mfma_f32_16x16x32_bf16 v[36:39], v[164:167], a[180:183], v[36:39]
    v_mfma_f32_16x16x32_bf16 v[52:55], v[168:171], a[180:183], v[52:55]
    v_mfma_f32_16x16x32_bf16 v[68:71], v[172:175], a[180:183], v[68:71]
    s_waitcnt vmcnt(8)
    s_nop 0
    v_mfma_f32_16x16x32_bf16 v[24:27], v[160:163], a[184:187], v[24:27]
    v_max3_u32 v214, v80, v81, v82
    v_max3_u32 v214, v214, v83, v84
    v_mfma_f32_16x16x32_bf16 v[40:43], v[164:167], a[184:187], v[40:43]
    v_max3_u32 v214, v214, v85, v86
    v_max3_u32 v214, v214, v87, v88
    v_mfma_f32_16x16x32_bf16 v[56:59], v[168:171], a[184:187], v[56:59]
    v_max3_u32 v214, v214, v89, v90
    v_max3_u32 v214, v214, v91, v92
    v_mfma_f32_16x16x32_bf16 v[72:75], v[172:175], a[184:187], v[72:75]
    v_max3_u32 v214, v214, v93, v94
    v_max_u32_e64 v214, v214, v95
    v_mfma_f32_16x16x32_bf16 v[28:31], v[160:163], a[188:191], v[28:31]
    v_cmp_eq_u32 vcc, -1, v214
    v_mfma_f32_16x16x32_bf16 v[44:47], v[164:167], a[188:191], v[44:47]
    v_mfma_f32_16x16x32_bf16 v[60:63], v[168:171], a[188:191], v[60:63]
    v_mfma_f32_16x16x32_bf16 v[76:79], v[172:175], a[188:191], v[76:79]
    s_nop 0
    s_cbranch_vccnz slow_110
back_111:
    s_nop 0
    v_mfma_f32_16x16x32_bf16 v[16:19], v[80:83], a[192:195], v[16:19]
    v_mfma_f32_16x16x32_bf16 v[32:35], v[84:87], a[192:195], v[32:35]
    v_mfma_f32_16x16x32_bf16 v[48:51], v[88:91], a[192:195], v[48:51]
    v_mfma_f32_16x16x32_bf16 v[64:67], v[92:95], a[192:195], v[64:67]
    v_mfma_f32_16x16x32_bf16 v[20:23], v[80:83], a[196:199], v[20:23]
    v_mfma_f32_16x16x32_bf16 v[36:39], v[84:87], a[196:199], v[36:39]
    v_mfma_f32_16x16x32_bf16 v[52:55], v[88:91], a[196:199], v[52:55]
    v_mfma_f32_16x16x32_bf16 v[68:71], v[92:95], a[196:199], v[68:71]
    s_waitcnt vmcnt(4)
    s_nop 0
    v_mfma_f32_16x16x32_bf16 v[24:27], v[80:83], a[200:203], v[24:27]
    v_max3_u32 v214, v96, v97, v98
    v_max3_u32 v214, v214, v99, v100
    v_mfma_f32_16x16x32_bf16 v[40:43], v[84:87], a[200:203], v[40:43]
    v_max3_u32 v214, v214, v101, v102
    v_max3_u32 v214, v214, v103, v104
    v_mfma_f32_16x16x32_bf16 v[56:59], v[88:91], a[200:203], v[56:59]
    v_max3_u32 v214, v214, v105, v106
    v_max3_u32 v214, v214, v107, v108
    v_mfma_f32_16x16x32_bf16 v[72:75], v[92:95], a[200:203], v[72:75]
    v_max3_u32 v214, v214, v109, v110
    v_max_u32_e64 v214, v214, v111
    v_mfma_f32_16x16x32_bf16 v[28:31], v[80:83], a[204:207], v[28:31]
    v_cmp_eq_u32 vcc, -1, v214
    v_mfma_f32_16x16x32_bf16 v[44:47], v[84:87], a[204:207], v[44:47]
    v_mfma_f32_16x16x32_bf16 v[60:63], v[88:91], a[204:207], v[60:63]
    v_mfma_f32_16x16x32_bf16 v[76:79], v[92:95], a[204:207], v[76:79]
    s_nop 0
    s_cbranch_vccnz slow_113
back_114:
    s_nop 0
    v_mfma_f32_16x16x32_bf16 v[16:19], v[96:99], a[208:211], v[16:19]
    v_mfma_f32_16x16x32_bf16 v[32:35], v[100:103], a[208:211], v[32:35]
    v_mfma_f32_16x16x32_bf16 v[48:51], v[104:107], a[208:211], v[48:51]
    v_mfma_f32_16x16x32_bf16 v[64:67], v[108:111], a[208:211], v[64:67]
    v_mfma_f32_16x16x32_bf16 v[20:23], v[96:99], a[212:215], v[20:23]
    v_mfma_f32_16x16x32_bf16 v[36:39], v[100:103], a[212:215], v[36:39]
    v_mfma_f32_16x16x32_bf16 v[52:55], v[104:107], a[212:215], v[52:55]
    v_mfma_f32_16x16x32_bf16 v[68:71], v[108:111], a[212:215], v[68:71]
    v_mfma_f32_16x16x32_bf16 v[24:27], v[96:99], a[216:219], v[24:27]
    v_mfma_f32_16x16x32_bf16 v[40:43], v[100:103], a[216:219], v[40:43]
    v_mfma_f32_16x16x32_bf16 v[56:59], v[104:107], a[216:219], v[56:59]
    v_mfma_f32_16x16x32_bf16 v[72:75], v[108:111], a[216:219], v[72:75]
    v_mfma_f32_16x16x32_bf16 v[28:31], v[96:99], a[220:223], v[28:31]
    v_mfma_f32_16x16x32_bf16 v[44:47], v[100:103], a[220:223], v[44:47]
    v_mfma_f32_16x16x32_bf16 v[60:63], v[104:107], a[220:223], v[60:63]
    v_mfma_f32_16x16x32_bf16 v[76:79], v[108:111], a[220:223], v[76:79]
    v_and_b32_e64 v4, 15, v1
    v_mul_u32_u24 v4, 272, v4
    v_lshrrev_b32_e64 v5, 4, v1
    v_lshl_add_u32 v4, v5, 4, v4
    s_mul_i32 s66, s28, 17408
    s_add_u32 s66, s66, 1024
    v_add_u32_e64 v4, s66, v4
    ds_write_b128 v4, v[16:19] offset:0
    ds_write_b128 v4, v[20:23] offset:4352
    ds_write_b128 v4, v[24:27] offset:8704
    ds_write_b128 v4, v[28:31] offset:13056
    ds_write_b128 v4, v[32:35] offset:64
    ds_write_b128 v4, v[36:39] offset:4416
    ds_write_b128 v4, v[40:43] offset:8768
    ds_write_b128 v4, v[44:47] offset:13120
    ds_write_b128 v4, v[48:51] offset:128
    ds_write_b128 v4, v[52:55] offset:4480
    ds_write_b128 v4, v[56:59] offset:8832
    ds_write_b128 v4, v[60:63] offset:13184
    ds_write_b128 v4, v[64:67] offset:192
    ds_write_b128 v4, v[68:71] offset:4544
    ds_write_b128 v4, v[72:75] offset:8896
    ds_write_b128 v4, v[76:79] offset:13248
    v_lshrrev_b32 v4, 3, v1
    v_and_b32 v5, 7, v1
    s_lshl_b32 s66, s28, 4
    v_add_u32 v4, s66, v4
    v_mul_u32_u24 v6, 272, v4
    v_lshl_add_u32 v6, v5, 4, v6
    v_add_u32 v6, 1024, v6
    s_waitcnt lgkmcnt(0)
    s_barrier
    ds_read_b128 v[16:19], v6 offset:0
    ds_read_b128 v[20:23], v6 offset:112
    ds_read_b128 v[24:27], v6 offset:17408
    ds_read_b128 v[28:31], v6 offset:17520
    ds_read_b128 v[32:35], v6 offset:34816
    ds_read_b128 v[36:39], v6 offset:34928
    ds_read_b128 v[40:43], v6 offset:52224
    ds_read_b128 v[44:47], v6 offset:52336
    ds_read_b128 v[48:51], v6 offset:2176
    ds_read_b128 v[52:55], v6 offset:2288
    ds_read_b128 v[56:59], v6 offset:19584
    ds_read_b128 v[60:63], v6 offset:19696
    ds_read_b128 v[64:67], v6 offset:36992
    ds_read_b128 v[68:71], v6 offset:37104
    ds_read_b128 v[72:75], v6 offset:54400
    ds_read_b128 v[76:79], v6 offset:54512
    s_waitcnt vmcnt(0)
    v_lshlrev_b32 v106, 16, v204
    v_lshlrev_b32_e64 v96, 16, v196
    v_and_b32 v100, 0xffff0000, v196
    v_lshlrev_b32_e64 v97, 16, v197
    v_and_b32 v101, 0xffff0000, v197
    v_lshlrev_b32_e64 v98, 16, v198
    v_and_b32 v102, 0xffff0000, v198
    v_lshlrev_b32_e64 v99, 16, v199
    v_and_b32 v103, 0xffff0000, v199
    s_waitcnt lgkmcnt(8)
    s_nop 0
    v_pk_add_f32 v[16:17], v[16:17], v[24:25]
    v_pk_add_f32 v[32:33], v[32:33], v[40:41]
    v_pk_add_f32 v[18:19], v[18:19], v[26:27]
    v_pk_add_f32 v[34:35], v[34:35], v[42:43]
    v_pk_add_f32 v[20:21], v[20:21], v[28:29]
    v_pk_add_f32 v[36:37], v[36:37], v[44:45]
    v_pk_add_f32 v[22:23], v[22:23], v[30:31]
    v_pk_add_f32 v[38:39], v[38:39], v[46:47]
    v_pk_add_f32 v[16:17], v[16:17], v[32:33]
    v_pk_add_f32 v[18:19], v[18:19], v[34:35]
    v_pk_add_f32 v[20:21], v[20:21], v[36:37]
    v_pk_add_f32 v[22:23], v[22:23], v[38:39]
    v_cvt_pk_bf16_f32 v80, v16, v17
    v_cvt_pk_bf16_f32 v81, v18, v19
    v_cvt_pk_bf16_f32 v82, v20, v21
    v_cvt_pk_bf16_f32 v83, v22, v23
    v_lshlrev_b32_e64 v16, 16, v80
    v_and_b32 v17, 0xffff0000, v80
    v_lshlrev_b32_e64 v18, 16, v81
    v_and_b32 v19, 0xffff0000, v81
    v_lshlrev_b32_e64 v20, 16, v82
    v_and_b32 v21, 0xffff0000, v82
    v_lshlrev_b32_e64 v22, 16, v83
    v_and_b32 v23, 0xffff0000, v83
    v_pk_add_f32 v[16:17], v[16:17], v[106:107] op_sel:[0,0] op_sel_hi:[1,0]
    v_pk_add_f32 v[18:19], v[18:19], v[106:107] op_sel:[0,0] op_sel_hi:[1,0]
    v_pk_add_f32 v[20:21], v[20:21], v[106:107] op_sel:[0,0] op_sel_hi:[1,0]
    v_pk_add_f32 v[22:23], v[22:23], v[106:107] op_sel:[0,0] op_sel_hi:[1,0]
    v_cvt_pk_bf16_f32 v80, v16, v17
    v_cvt_pk_bf16_f32 v81, v18, v19
    v_cvt_pk_bf16_f32 v82, v20, v21
    v_cvt_pk_bf16_f32 v83, v22, v23
    v_lshlrev_b32_e64 v16, 16, v80
    v_and_b32 v17, 0xffff0000, v80
    v_lshlrev_b32_e64 v18, 16, v81
    v_and_b32 v19, 0xffff0000, v81
    v_lshlrev_b32_e64 v20, 16, v82
    v_and_b32 v21, 0xffff0000, v82
    v_lshlrev_b32_e64 v22, 16, v83
    v_and_b32 v23, 0xffff0000, v83
    v_pk_add_f32 v[16:17], v[16:17], v[96:97]
    v_pk_add_f32 v[18:19], v[18:19], v[98:99]
    v_pk_add_f32 v[20:21], v[20:21], v[100:101]
    v_pk_add_f32 v[22:23], v[22:23], v[102:103]
    v_cvt_pk_bf16_f32 v88, v16, v20
    v_cvt_pk_bf16_f32 v89, v17, v21
    v_cvt_pk_bf16_f32 v90, v18, v22
    v_cvt_pk_bf16_f32 v91, v19, v23
    buffer_store_dwordx4 v[88:91], v210, s[20:23], 0 offen
    v_lshlrev_b32 v106, 16, v205
    v_lshlrev_b32 v96, 16, v200
    v_and_b32 v100, 0xffff0000, v200
    v_lshlrev_b32_e64 v97, 16, v201
    v_and_b32 v101, 0xffff0000, v201
    v_lshlrev_b32_e64 v98, 16, v202
    v_and_b32 v102, 0xffff0000, v202
    v_lshlrev_b32_e64 v99, 16, v203
    v_and_b32 v103, 0xffff0000, v203
    s_waitcnt lgkmcnt(0)
    s_nop 0
    v_pk_add_f32 v[48:49], v[48:49], v[56:57]
    v_pk_add_f32 v[64:65], v[64:65], v[72:73]
    v_pk_add_f32 v[50:51], v[50:51], v[58:59]
    v_pk_add_f32 v[66:67], v[66:67], v[74:75]
    v_pk_add_f32 v[52:53], v[52:53], v[60:61]
    v_pk_add_f32 v[68:69], v[68:69], v[76:77]
    v_pk_add_f32 v[54:55], v[54:55], v[62:63]
    v_pk_add_f32 v[70:71], v[70:71], v[78:79]
    v_pk_add_f32 v[48:49], v[48:49], v[64:65]
    v_pk_add_f32 v[50:51], v[50:51], v[66:67]
    v_pk_add_f32 v[52:53], v[52:53], v[68:69]
    v_pk_add_f32 v[54:55], v[54:55], v[70:71]
    v_cvt_pk_bf16_f32 v80, v48, v49
    v_cvt_pk_bf16_f32 v81, v50, v51
    v_cvt_pk_bf16_f32 v82, v52, v53
    v_cvt_pk_bf16_f32 v83, v54, v55
    v_lshlrev_b32_e64 v48, 16, v80
    v_and_b32 v49, 0xffff0000, v80
    v_lshlrev_b32_e64 v50, 16, v81
    v_and_b32 v51, 0xffff0000, v81
    v_lshlrev_b32_e64 v52, 16, v82
    v_and_b32 v53, 0xffff0000, v82
    v_lshlrev_b32_e64 v54, 16, v83
    v_and_b32 v55, 0xffff0000, v83
    v_pk_add_f32 v[48:49], v[48:49], v[106:107] op_sel:[0,0] op_sel_hi:[1,0]
    v_pk_add_f32 v[50:51], v[50:51], v[106:107] op_sel:[0,0] op_sel_hi:[1,0]
    v_pk_add_f32 v[52:53], v[52:53], v[106:107] op_sel:[0,0] op_sel_hi:[1,0]
    v_pk_add_f32 v[54:55], v[54:55], v[106:107] op_sel:[0,0] op_sel_hi:[1,0]
    v_cvt_pk_bf16_f32 v80, v48, v49
    v_cvt_pk_bf16_f32 v81, v50, v51
    v_cvt_pk_bf16_f32 v82, v52, v53
    v_cvt_pk_bf16_f32 v83, v54, v55
    v_lshlrev_b32_e64 v48, 16, v80
    v_and_b32 v49, 0xffff0000, v80
    v_lshlrev_b32_e64 v50, 16, v81
    v_and_b32 v51, 0xffff0000, v81
    v_lshlrev_b32_e64 v52, 16, v82
    v_and_b32 v53, 0xffff0000, v82
    v_lshlrev_b32_e64 v54, 16, v83
    v_and_b32 v55, 0xffff0000, v83
    v_pk_add_f32 v[48:49], v[48:49], v[96:97]
    v_pk_add_f32 v[50:51], v[50:51], v[98:99]
    v_pk_add_f32 v[52:53], v[52:53], v[100:101]
    v_pk_add_f32 v[54:55], v[54:55], v[102:103]
    v_cvt_pk_bf16_f32 v92, v48, v52
    v_cvt_pk_bf16_f32 v93, v49, v53
    v_cvt_pk_bf16_f32 v94, v50, v54
    v_cvt_pk_bf16_f32 v95, v51, v55
    v_add_u32 v210, 7168, v210
    buffer_store_dwordx4 v[92:95], v210, s[20:23], 0 offen
end_1:
    s_endpgm
slow_24:
    s_mov_b32 s97, 0
sloop_26:
    s_add_u32 s70, s39, 0
    s_cmp_ge_u32 s70, 458752
    s_cselect_b32 s71, 458752, 0
    s_sub_u32 s70, s70, s71
    buffer_load_dwordx4 v[80:83], v208, s[4:7], s70 offen offset:0 sc1
    buffer_load_dwordx4 v[84:87], v208, s[4:7], s70 offen offset:256 sc1
    buffer_load_dwordx4 v[88:91], v208, s[4:7], s70 offen offset:512 sc1
    buffer_load_dwordx4 v[92:95], v209, s[4:7], s70 offen sc1
    s_waitcnt vmcnt(0)
    s_nop 0
    v_max3_u32 v214, v80, v81, v82
    v_max3_u32 v214, v214, v83, v84
    v_max3_u32 v214, v214, v85, v86
    v_max3_u32 v214, v214, v87, v88
    v_max3_u32 v214, v214, v89, v90
    v_max3_u32 v214, v214, v91, v92
    v_max3_u32 v214, v214, v93, v94
    v_max_u32_e64 v214, v214, v95
    v_cmp_eq_u32 vcc, -1, v214
    s_nop 3
    s_cbranch_vccz sdone_116
    s_add_u32 s97, s97, 1
    s_cmp_lt_u32 s97, 4000
    s_cbranch_scc1 sloop_26
sdone_116:
    s_add_u32 s70, s39, 28672
    s_cmp_ge_u32 s70, 458752
    s_cselect_b32 s71, 458752, 0
    s_sub_u32 s70, s70, s71
    buffer_load_dwordx4 v[96:99], v208, s[4:7], s70 offen offset:0 sc1
    buffer_load_dwordx4 v[100:103], v208, s[4:7], s70 offen offset:256 sc1
    buffer_load_dwordx4 v[104:107], v208, s[4:7], s70 offen offset:512 sc1
    buffer_load_dwordx4 v[108:111], v209, s[4:7], s70 offen sc1
    s_add_u32 s70, s39, 57344
    s_cmp_ge_u32 s70, 458752
    s_cselect_b32 s71, 458752, 0
    s_sub_u32 s70, s70, s71
    s_nop 0
    buffer_load_dwordx4 v[112:115], v208, s[4:7], s70 offen offset:0 sc1
    buffer_load_dwordx4 v[116:119], v208, s[4:7], s70 offen offset:256 sc1
    buffer_load_dwordx4 v[120:123], v208, s[4:7], s70 offen offset:512 sc1
    buffer_load_dwordx4 v[124:127], v209, s[4:7], s70 offen sc1
    s_add_u32 s70, s39, 86016
    s_cmp_ge_u32 s70, 458752
    s_cselect_b32 s71, 458752, 0
    s_sub_u32 s70, s70, s71
    buffer_load_dwordx4 v[128:131], v208, s[4:7], s70 offen offset:0 sc1
    buffer_load_dwordx4 v[132:135], v208, s[4:7], s70 offen offset:256 sc1
    buffer_load_dwordx4 v[136:139], v208, s[4:7], s70 offen offset:512 sc1
    buffer_load_dwordx4 v[140:143], v209, s[4:7], s70 offen sc1
    s_branch back_25
slow_27:
    s_mov_b32 s97, 0
sloop_29:
    s_add_u32 s70, s39, 28672
    s_cmp_ge_u32 s70, 458752
    s_cselect_b32 s71, 458752, 0
    s_sub_u32 s70, s70, s71
    buffer_load_dwordx4 v[96:99], v208, s[4:7], s70 offen offset:0 sc1
    buffer_load_dwordx4 v[100:103], v208, s[4:7], s70 offen offset:256 sc1
    buffer_load_dwordx4 v[104:107], v208, s[4:7], s70 offen offset:512 sc1
    buffer_load_dwordx4 v[108:111], v209, s[4:7], s70 offen sc1
    s_waitcnt vmcnt(0)
    s_nop 0
    v_max3_u32 v214, v96, v97, v98
    v_max3_u32 v214, v214, v99, v100
    v_max3_u32 v214, v214, v101, v102
    v_max3_u32 v214, v214, v103, v104
    v_max3_u32 v214, v214, v105, v106
    v_max3_u32 v214, v214, v107, v108
    v_max3_u32 v214, v214, v109, v110
    v_max_u32_e64 v214, v214, v111
    v_cmp_eq_u32 vcc, -1, v214
    s_nop 3
    s_cbranch_vccz sdone_117
    s_add_u32 s97, s97, 1
    s_cmp_lt_u32 s97, 4000
    s_cbranch_scc1 sloop_29
sdone_117:
    s_branch back_28
slow_30:
    s_mov_b32 s97, 0
sloop_32:
    s_add_u32 s70, s39, 57344
    s_cmp_ge_u32 s70, 458752
    s_cselect_b32 s71, 458752, 0
    s_sub_u32 s70, s70, s71
    buffer_load_dwordx4 v[112:115], v208, s[4:7], s70 offen offset:0 sc1
    buffer_load_dwordx4 v[116:119], v208, s[4:7], s70 offen offset:256 sc1
    buffer_load_dwordx4 v[120:123], v208, s[4:7], s70 offen offset:512 sc1
    buffer_load_dwordx4 v[124:127], v209, s[4:7], s70 offen sc1
    s_waitcnt vmcnt(0)
    s_nop 0
    v_max3_u32 v214, v112, v113, v114
    v_max3_u32 v214, v214, v115, v116
    v_max3_u32 v214, v214, v117, v118
    v_max3_u32 v214, v214, v119, v120
    v_max3_u32 v214, v214, v121, v122
    v_max3_u32 v214, v214, v123, v124
    v_max3_u32 v214, v214, v125, v126
    v_max_u32_e64 v214, v214, v127
    v_cmp_eq_u32 vcc, -1, v214
    s_nop 3
    s_cbranch_vccz sdone_118
    s_add_u32 s97, s97, 1
    s_cmp_lt_u32 s97, 4000
    s_cbranch_scc1 sloop_32
sdone_118:
    s_branch back_31
slow_33:
    s_mov_b32 s97, 0
sloop_35:
    s_add_u32 s70, s39, 86016
    s_cmp_ge_u32 s70, 458752
    s_cselect_b32 s71, 458752, 0
    s_sub_u32 s70, s70, s71
    buffer_load_dwordx4 v[128:131], v208, s[4:7], s70 offen offset:0 sc1
    buffer_load_dwordx4 v[132:135], v208, s[4:7], s70 offen offset:256 sc1
    buffer_load_dwordx4 v[136:139], v208, s[4:7], s70 offen offset:512 sc1
    buffer_load_dwordx4 v[140:143], v209, s[4:7], s70 offen sc1
    s_waitcnt vmcnt(0)
    s_nop 0
    v_max3_u32 v214, v128, v129, v130
    v_max3_u32 v214, v214, v131, v132
    v_max3_u32 v214, v214, v133, v134
    v_max3_u32 v214, v214, v135, v136
    v_max3_u32 v214, v214, v137, v138
    v_max3_u32 v214, v214, v139, v140
    v_max3_u32 v214, v214, v141, v142
    v_max_u32_e64 v214, v214, v143
    v_cmp_eq_u32 vcc, -1, v214
    s_nop 3
    s_cbranch_vccz sdone_119
    s_add_u32 s97, s97, 1
    s_cmp_lt_u32 s97, 4000
    s_cbranch_scc1 sloop_35
sdone_119:
    s_branch back_34
slow_36:
    s_mov_b32 s97, 0
sloop_38:
    s_add_u32 s70, s39, 114688
    s_cmp_ge_u32 s70, 458752
    s_cselect_b32 s71, 458752, 0
    s_sub_u32 s70, s70, s71
    buffer_load_dwordx4 v[144:147], v208, s[4:7], s70 offen offset:0 sc1
    buffer_load_dwordx4 v[148:151], v208, s[4:7], s70 offen offset:256 sc1
    buffer_load_dwordx4 v[152:155], v208, s[4:7], s70 offen offset:512 sc1
    buffer_load_dwordx4 v[156:159], v209, s[4:7], s70 offen sc1
    s_waitcnt vmcnt(0)
    s_nop 0
    v_max3_u32 v214, v144, v145, v146
    v_max3_u32 v214, v214, v147, v148
    v_max3_u32 v214, v214, v149, v150
    v_max3_u32 v214, v214, v151, v152
    v_max3_u32 v214, v214, v153, v154
    v_max3_u32 v214, v214, v155, v156
    v_max3_u32 v214, v214, v157, v158
    v_max_u32_e64 v214, v214, v159
    v_cmp_eq_u32 vcc, -1, v214
    s_nop 3
    s_cbranch_vccz sdone_120
    s_add_u32 s97, s97, 1
    s_cmp_lt_u32 s97, 4000
    s_cbranch_scc1 sloop_38
sdone_120:
    s_branch back_37
slow_39:
    s_mov_b32 s97, 0
sloop_41:
    s_add_u32 s70, s39, 143360
    s_cmp_ge_u32 s70, 458752
    s_cselect_b32 s71, 458752, 0
    s_sub_u32 s70, s70, s71
    buffer_load_dwordx4 v[160:163], v208, s[4:7], s70 offen offset:0 sc1
    buffer_load_dwordx4 v[164:167], v208, s[4:7], s70 offen offset:256 sc1
    buffer_load_dwordx4 v[168:171], v208, s[4:7], s70 offen offset:512 sc1
    buffer_load_dwordx4 v[172:175], v209, s[4:7], s70 offen sc1
    s_waitcnt vmcnt(0)
    s_nop 0
    v_max3_u32 v214, v160, v161, v162
    v_max3_u32 v214, v214, v163, v164
    v_max3_u32 v214, v214, v165, v166
    v_max3_u32 v214, v214, v167, v168
    v_max3_u32 v214, v214, v169, v170
    v_max3_u32 v214, v214, v171, v172
    v_max3_u32 v214, v214, v173, v174
    v_max_u32_e64 v214, v214, v175
    v_cmp_eq_u32 vcc, -1, v214
    s_nop 3
    s_cbranch_vccz sdone_121
    s_add_u32 s97, s97, 1
    s_cmp_lt_u32 s97, 4000
    s_cbranch_scc1 sloop_41
sdone_121:
    s_branch back_40
slow_42:
    s_mov_b32 s97, 0
sloop_44:
    s_add_u32 s70, s39, 172032
    s_cmp_ge_u32 s70, 458752
    s_cselect_b32 s71, 458752, 0
    s_sub_u32 s70, s70, s71
    buffer_load_dwordx4 v[80:83], v208, s[4:7], s70 offen offset:0 sc1
    buffer_load_dwordx4 v[84:87], v208, s[4:7], s70 offen offset:256 sc1
    buffer_load_dwordx4 v[88:91], v208, s[4:7], s70 offen offset:512 sc1
    buffer_load_dwordx4 v[92:95], v209, s[4:7], s70 offen sc1
    s_waitcnt vmcnt(0)
    s_nop 0
    v_max3_u32 v214, v80, v81, v82
    v_max3_u32 v214, v214, v83, v84
    v_max3_u32 v214, v214, v85, v86
    v_max3_u32 v214, v214, v87, v88
    v_max3_u32 v214, v214, v89, v90
    v_max3_u32 v214, v214, v91, v92
    v_max3_u32 v214, v214, v93, v94
    v_max_u32_e64 v214, v214, v95
    v_cmp_eq_u32 vcc, -1, v214
    s_nop 3
    s_cbranch_vccz sdone_122
    s_add_u32 s97, s97, 1
    s_cmp_lt_u32 s97, 4000
    s_cbranch_scc1 sloop_44
sdone_122:
    s_branch back_43
slow_45:
    s_mov_b32 s97, 0
sloop_47:
    s_add_u32 s70, s39, 200704
    s_cmp_ge_u32 s70, 458752
    s_cselect_b32 s71, 458752, 0
    s_sub_u32 s70, s70, s71
    buffer_load_dwordx4 v[96:99], v208, s[4:7], s70 offen offset:0 sc1
    buffer_load_dwordx4 v[100:103], v208, s[4:7], s70 offen offset:256 sc1
    buffer_load_dwordx4 v[104:107], v208, s[4:7], s70 offen offset:512 sc1
    buffer_load_dwordx4 v[108:111], v209, s[4:7], s70 offen sc1
    s_waitcnt vmcnt(0)
    s_nop 0
    v_max3_u32 v214, v96, v97, v98
    v_max3_u32 v214, v214, v99, v100
    v_max3_u32 v214, v214, v101, v102
    v_max3_u32 v214, v214, v103, v104
    v_max3_u32 v214, v214, v105, v106
    v_max3_u32 v214, v214, v107, v108
    v_max3_u32 v214, v214, v109, v110
    v_max_u32_e64 v214, v214, v111
    v_cmp_eq_u32 vcc, -1, v214
    s_nop 3
    s_cbranch_vccz sdone_123
    s_add_u32 s97, s97, 1
    s_cmp_lt_u32 s97, 4000
    s_cbranch_scc1 sloop_47
sdone_123:
    s_branch back_46
slow_48:
    s_mov_b32 s97, 0
sloop_50:
    s_add_u32 s70, s39, 229376
    s_cmp_ge_u32 s70, 458752
    s_cselect_b32 s71, 458752, 0
    s_sub_u32 s70, s70, s71
    buffer_load_dwordx4 v[112:115], v208, s[4:7], s70 offen offset:0 sc1
    buffer_load_dwordx4 v[116:119], v208, s[4:7], s70 offen offset:256 sc1
    buffer_load_dwordx4 v[120:123], v208, s[4:7], s70 offen offset:512 sc1
    buffer_load_dwordx4 v[124:127], v209, s[4:7], s70 offen sc1
    s_waitcnt vmcnt(0)
    s_nop 0
    v_max3_u32 v214, v112, v113, v114
    v_max3_u32 v214, v214, v115, v116
    v_max3_u32 v214, v214, v117, v118
    v_max3_u32 v214, v214, v119, v120
    v_max3_u32 v214, v214, v121, v122
    v_max3_u32 v214, v214, v123, v124
    v_max3_u32 v214, v214, v125, v126
    v_max_u32_e64 v214, v214, v127
    v_cmp_eq_u32 vcc, -1, v214
    s_nop 3
    s_cbranch_vccz sdone_124
    s_add_u32 s97, s97, 1
    s_cmp_lt_u32 s97, 4000
    s_cbranch_scc1 sloop_50
sdone_124:
    s_branch back_49
slow_51:
    s_mov_b32 s97, 0
sloop_53:
    s_add_u32 s70, s39, 258048
    s_cmp_ge_u32 s70, 458752
    s_cselect_b32 s71, 458752, 0
    s_sub_u32 s70, s70, s71
    buffer_load_dwordx4 v[128:131], v208, s[4:7], s70 offen offset:0 sc1
    buffer_load_dwordx4 v[132:135], v208, s[4:7], s70 offen offset:256 sc1
    buffer_load_dwordx4 v[136:139], v208, s[4:7], s70 offen offset:512 sc1
    buffer_load_dwordx4 v[140:143], v209, s[4:7], s70 offen sc1
    s_waitcnt vmcnt(0)
    s_nop 0
    v_max3_u32 v214, v128, v129, v130
    v_max3_u32 v214, v214, v131, v132
    v_max3_u32 v214, v214, v133, v134
    v_max3_u32 v214, v214, v135, v136
    v_max3_u32 v214, v214, v137, v138
    v_max3_u32 v214, v214, v139, v140
    v_max3_u32 v214, v214, v141, v142
    v_max_u32_e64 v214, v214, v143
    v_cmp_eq_u32 vcc, -1, v214
    s_nop 3
    s_cbranch_vccz sdone_125
    s_add_u32 s97, s97, 1
    s_cmp_lt_u32 s97, 4000
    s_cbranch_scc1 sloop_53
sdone_125:
    s_branch back_52
slow_54:
    s_mov_b32 s97, 0
sloop_56:
    s_add_u32 s70, s39, 286720
    s_cmp_ge_u32 s70, 458752
    s_cselect_b32 s71, 458752, 0
    s_sub_u32 s70, s70, s71
    buffer_load_dwordx4 v[144:147], v208, s[4:7], s70 offen offset:0 sc1
    buffer_load_dwordx4 v[148:151], v208, s[4:7], s70 offen offset:256 sc1
    buffer_load_dwordx4 v[152:155], v208, s[4:7], s70 offen offset:512 sc1
    buffer_load_dwordx4 v[156:159], v209, s[4:7], s70 offen sc1
    s_waitcnt vmcnt(0)
    s_nop 0
    v_max3_u32 v214, v144, v145, v146
    v_max3_u32 v214, v214, v147, v148
    v_max3_u32 v214, v214, v149, v150
    v_max3_u32 v214, v214, v151, v152
    v_max3_u32 v214, v214, v153, v154
    v_max3_u32 v214, v214, v155, v156
    v_max3_u32 v214, v214, v157, v158
    v_max_u32_e64 v214, v214, v159
    v_cmp_eq_u32 vcc, -1, v214
    s_nop 3
    s_cbranch_vccz sdone_126
    s_add_u32 s97, s97, 1
    s_cmp_lt_u32 s97, 4000
    s_cbranch_scc1 sloop_56
sdone_126:
    s_branch back_55
slow_57:
    s_mov_b32 s97, 0
sloop_59:
    s_add_u32 s70, s39, 315392
    s_cmp_ge_u32 s70, 458752
    s_cselect_b32 s71, 458752, 0
    s_sub_u32 s70, s70, s71
    buffer_load_dwordx4 v[160:163], v208, s[4:7], s70 offen offset:0 sc1
    buffer_load_dwordx4 v[164:167], v208, s[4:7], s70 offen offset:256 sc1
    buffer_load_dwordx4 v[168:171], v208, s[4:7], s70 offen offset:512 sc1
    buffer_load_dwordx4 v[172:175], v209, s[4:7], s70 offen sc1
    s_waitcnt vmcnt(0)
    s_nop 0
    v_max3_u32 v214, v160, v161, v162
    v_max3_u32 v214, v214, v163, v164
    v_max3_u32 v214, v214, v165, v166
    v_max3_u32 v214, v214, v167, v168
    v_max3_u32 v214, v214, v169, v170
    v_max3_u32 v214, v214, v171, v172
    v_max3_u32 v214, v214, v173, v174
    v_max_u32_e64 v214, v214, v175
    v_cmp_eq_u32 vcc, -1, v214
    s_nop 3
    s_cbranch_vccz sdone_127
    s_add_u32 s97, s97, 1
    s_cmp_lt_u32 s97, 4000
    s_cbranch_scc1 sloop_59
sdone_127:
    s_branch back_58
slow_60:
    s_mov_b32 s97, 0
sloop_62:
    s_add_u32 s70, s39, 344064
    s_cmp_ge_u32 s70, 458752
    s_cselect_b32 s71, 458752, 0
    s_sub_u32 s70, s70, s71
    buffer_load_dwordx4 v[80:83], v208, s[4:7], s70 offen offset:0 sc1
    buffer_load_dwordx4 v[84:87], v208, s[4:7], s70 offen offset:256 sc1
    buffer_load_dwordx4 v[88:91], v208, s[4:7], s70 offen offset:512 sc1
    buffer_load_dwordx4 v[92:95], v209, s[4:7], s70 offen sc1
    s_waitcnt vmcnt(0)
    s_nop 0
    v_max3_u32 v214, v80, v81, v82
    v_max3_u32 v214, v214, v83, v84
    v_max3_u32 v214, v214, v85, v86
    v_max3_u32 v214, v214, v87, v88
    v_max3_u32 v214, v214, v89, v90
    v_max3_u32 v214, v214, v91, v92
    v_max3_u32 v214, v214, v93, v94
    v_max_u32_e64 v214, v214, v95
    v_cmp_eq_u32 vcc, -1, v214
    s_nop 3
    s_cbranch_vccz sdone_128
    s_add_u32 s97, s97, 1
    s_cmp_lt_u32 s97, 4000
    s_cbranch_scc1 sloop_62
sdone_128:
    s_branch back_61
slow_63:
    s_mov_b32 s97, 0
sloop_65:
    s_add_u32 s70, s39, 372736
    s_cmp_ge_u32 s70, 458752
    s_cselect_b32 s71, 458752, 0
    s_sub_u32 s70, s70, s71
    buffer_load_dwordx4 v[96:99], v208, s[4:7], s70 offen offset:0 sc1
    buffer_load_dwordx4 v[100:103], v208, s[4:7], s70 offen offset:256 sc1
    buffer_load_dwordx4 v[104:107], v208, s[4:7], s70 offen offset:512 sc1
    buffer_load_dwordx4 v[108:111], v209, s[4:7], s70 offen sc1
    s_waitcnt vmcnt(0)
    s_nop 0
    v_max3_u32 v214, v96, v97, v98
    v_max3_u32 v214, v214, v99, v100
    v_max3_u32 v214, v214, v101, v102
    v_max3_u32 v214, v214, v103, v104
    v_max3_u32 v214, v214, v105, v106
    v_max3_u32 v214, v214, v107, v108
    v_max3_u32 v214, v214, v109, v110
    v_max_u32_e64 v214, v214, v111
    v_cmp_eq_u32 vcc, -1, v214
    s_nop 3
    s_cbranch_vccz sdone_129
    s_add_u32 s97, s97, 1
    s_cmp_lt_u32 s97, 4000
    s_cbranch_scc1 sloop_65
sdone_129:
    s_branch back_64
slow_66:
    s_mov_b32 s97, 0
sloop_68:
    s_add_u32 s70, s39, 401408
    s_cmp_ge_u32 s70, 458752
    s_cselect_b32 s71, 458752, 0
    s_sub_u32 s70, s70, s71
    buffer_load_dwordx4 v[112:115], v208, s[4:7], s70 offen offset:0 sc1
    buffer_load_dwordx4 v[116:119], v208, s[4:7], s70 offen offset:256 sc1
    buffer_load_dwordx4 v[120:123], v208, s[4:7], s70 offen offset:512 sc1
    buffer_load_dwordx4 v[124:127], v209, s[4:7], s70 offen sc1
    s_waitcnt vmcnt(0)
    s_nop 0
    v_max3_u32 v214, v112, v113, v114
    v_max3_u32 v214, v214, v115, v116
    v_max3_u32 v214, v214, v117, v118
    v_max3_u32 v214, v214, v119, v120
    v_max3_u32 v214, v214, v121, v122
    v_max3_u32 v214, v214, v123, v124
    v_max3_u32 v214, v214, v125, v126
    v_max_u32_e64 v214, v214, v127
    v_cmp_eq_u32 vcc, -1, v214
    s_nop 3
    s_cbranch_vccz sdone_130
    s_add_u32 s97, s97, 1
    s_cmp_lt_u32 s97, 4000
    s_cbranch_scc1 sloop_68
sdone_130:
    s_branch back_67
slow_69:
    s_mov_b32 s97, 0
sloop_71:
    s_add_u32 s70, s39, 430080
    s_cmp_ge_u32 s70, 458752
    s_cselect_b32 s71, 458752, 0
    s_sub_u32 s70, s70, s71
    buffer_load_dwordx4 v[128:131], v208, s[4:7], s70 offen offset:0 sc1
    buffer_load_dwordx4 v[132:135], v208, s[4:7], s70 offen offset:256 sc1
    buffer_load_dwordx4 v[136:139], v208, s[4:7], s70 offen offset:512 sc1
    buffer_load_dwordx4 v[140:143], v209, s[4:7], s70 offen sc1
    s_waitcnt vmcnt(0)
    s_nop 0
    v_max3_u32 v214, v128, v129, v130
    v_max3_u32 v214, v214, v131, v132
    v_max3_u32 v214, v214, v133, v134
    v_max3_u32 v214, v214, v135, v136
    v_max3_u32 v214, v214, v137, v138
    v_max3_u32 v214, v214, v139, v140
    v_max3_u32 v214, v214, v141, v142
    v_max_u32_e64 v214, v214, v143
    v_cmp_eq_u32 vcc, -1, v214
    s_nop 3
    s_cbranch_vccz sdone_131
    s_add_u32 s97, s97, 1
    s_cmp_lt_u32 s97, 4000
    s_cbranch_scc1 sloop_71
sdone_131:
    s_branch back_70
slow_74:
    s_mov_b32 s97, 0
sloop_76:
    s_add_u32 s70, s41, 0
    s_cmp_ge_u32 s70, 401408
    s_cselect_b32 s71, 401408, 0
    s_sub_u32 s70, s70, s71
    buffer_load_dwordx4 v[80:83], v208, s[4:7], s70 offen offset:0 sc1
    buffer_load_dwordx4 v[84:87], v208, s[4:7], s70 offen offset:256 sc1
    buffer_load_dwordx4 v[88:91], v208, s[4:7], s70 offen offset:512 sc1
    buffer_load_dwordx4 v[92:95], v209, s[4:7], s70 offen sc1
    s_waitcnt vmcnt(0)
    v_max3_u32 v214, v80, v81, v82
    v_max3_u32 v214, v214, v83, v84
    v_max3_u32 v214, v214, v85, v86
    v_max3_u32 v214, v214, v87, v88
    v_max3_u32 v214, v214, v89, v90
    v_max3_u32 v214, v214, v91, v92
    v_max3_u32 v214, v214, v93, v94
    v_max_u32_e64 v214, v214, v95
    v_cmp_eq_u32 vcc, -1, v214
    s_nop 3
    s_cbranch_vccz sdone_132
    s_add_u32 s97, s97, 1
    s_cmp_lt_u32 s97, 4000
    s_cbranch_scc1 sloop_76
sdone_132:
    s_add_u32 s70, s41, 28672
    s_cmp_ge_u32 s70, 401408
    s_cselect_b32 s71, 401408, 0
    s_sub_u32 s70, s70, s71
    buffer_load_dwordx4 v[96:99], v208, s[4:7], s70 offen offset:0 sc1
    buffer_load_dwordx4 v[100:103], v208, s[4:7], s70 offen offset:256 sc1
    buffer_load_dwordx4 v[104:107], v208, s[4:7], s70 offen offset:512 sc1
    buffer_load_dwordx4 v[108:111], v209, s[4:7], s70 offen sc1
    s_add_u32 s70, s41, 57344
    s_cmp_ge_u32 s70, 401408
    s_cselect_b32 s71, 401408, 0
    s_sub_u32 s70, s70, s71
    s_nop 0
    buffer_load_dwordx4 v[112:115], v208, s[4:7], s70 offen offset:0 sc1
    buffer_load_dwordx4 v[116:119], v208, s[4:7], s70 offen offset:256 sc1
    buffer_load_dwordx4 v[120:123], v208, s[4:7], s70 offen offset:512 sc1
    buffer_load_dwordx4 v[124:127], v209, s[4:7], s70 offen sc1
    s_add_u32 s70, s41, 86016
    s_cmp_ge_u32 s70, 401408
    s_cselect_b32 s71, 401408, 0
    s_sub_u32 s70, s70, s71
    buffer_load_dwordx4 v[128:131], v208, s[4:7], s70 offen offset:0 sc1
    buffer_load_dwordx4 v[132:135], v208, s[4:7], s70 offen offset:256 sc1
    buffer_load_dwordx4 v[136:139], v208, s[4:7], s70 offen offset:512 sc1
    buffer_load_dwordx4 v[140:143], v209, s[4:7], s70 offen sc1
    s_branch back_75
slow_77:
    s_mov_b32 s97, 0
sloop_79:
    s_add_u32 s70, s41, 28672
    s_cmp_ge_u32 s70, 401408
    s_cselect_b32 s71, 401408, 0
    s_sub_u32 s70, s70, s71
    buffer_load_dwordx4 v[96:99], v208, s[4:7], s70 offen offset:0 sc1
    buffer_load_dwordx4 v[100:103], v208, s[4:7], s70 offen offset:256 sc1
    buffer_load_dwordx4 v[104:107], v208, s[4:7], s70 offen offset:512 sc1
    buffer_load_dwordx4 v[108:111], v209, s[4:7], s70 offen sc1
    s_waitcnt vmcnt(0)
    s_nop 0
    v_max3_u32 v214, v96, v97, v98
    v_max3_u32 v214, v214, v99, v100
    v_max3_u32 v214, v214, v101, v102
    v_max3_u32 v214, v214, v103, v104
    v_max3_u32 v214, v214, v105, v106
    v_max3_u32 v214, v214, v107, v108
    v_max3_u32 v214, v214, v109, v110
    v_max_u32_e64 v214, v214, v111
    v_cmp_eq_u32 vcc, -1, v214
    s_nop 3
    s_cbranch_vccz sdone_133
    s_add_u32 s97, s97, 1
    s_cmp_lt_u32 s97, 4000
    s_cbranch_scc1 sloop_79
sdone_133:
    s_branch back_78
slow_80:
    s_mov_b32 s97, 0
sloop_82:
    s_add_u32 s70, s41, 57344
    s_cmp_ge_u32 s70, 401408
    s_cselect_b32 s71, 401408, 0
    s_sub_u32 s70, s70, s71
    buffer_load_dwordx4 v[112:115], v208, s[4:7], s70 offen offset:0 sc1
    buffer_load_dwordx4 v[116:119], v208, s[4:7], s70 offen offset:256 sc1
    buffer_load_dwordx4 v[120:123], v208, s[4:7], s70 offen offset:512 sc1
    buffer_load_dwordx4 v[124:127], v209, s[4:7], s70 offen sc1
    s_waitcnt vmcnt(0)
    s_nop 0
    v_max3_u32 v214, v112, v113, v114
    v_max3_u32 v214, v214, v115, v116
    v_max3_u32 v214, v214, v117, v118
    v_max3_u32 v214, v214, v119, v120
    v_max3_u32 v214, v214, v121, v122
    v_max3_u32 v214, v214, v123, v124
    v_max3_u32 v214, v214, v125, v126
    v_max_u32_e64 v214, v214, v127
    v_cmp_eq_u32 vcc, -1, v214
    s_nop 3
    s_cbranch_vccz sdone_134
    s_add_u32 s97, s97, 1
    s_cmp_lt_u32 s97, 4000
    s_cbranch_scc1 sloop_82
sdone_134:
    s_branch back_81
slow_83:
    s_mov_b32 s97, 0
sloop_85:
    s_add_u32 s70, s41, 86016
    s_cmp_ge_u32 s70, 401408
    s_cselect_b32 s71, 401408, 0
    s_sub_u32 s70, s70, s71
    buffer_load_dwordx4 v[128:131], v208, s[4:7], s70 offen offset:0 sc1
    buffer_load_dwordx4 v[132:135], v208, s[4:7], s70 offen offset:256 sc1
    buffer_load_dwordx4 v[136:139], v208, s[4:7], s70 offen offset:512 sc1
    buffer_load_dwordx4 v[140:143], v209, s[4:7], s70 offen sc1
    s_waitcnt vmcnt(0)
    s_nop 0
    v_max3_u32 v214, v128, v129, v130
    v_max3_u32 v214, v214, v131, v132
    v_max3_u32 v214, v214, v133, v134
    v_max3_u32 v214, v214, v135, v136
    v_max3_u32 v214, v214, v137, v138
    v_max3_u32 v214, v214, v139, v140
    v_max3_u32 v214, v214, v141, v142
    v_max_u32_e64 v214, v214, v143
    v_cmp_eq_u32 vcc, -1, v214
    s_nop 3
    s_cbranch_vccz sdone_135
    s_add_u32 s97, s97, 1
    s_cmp_lt_u32 s97, 4000
    s_cbranch_scc1 sloop_85
sdone_135:
    s_branch back_84
slow_86:
    s_mov_b32 s97, 0
sloop_88:
    s_add_u32 s70, s41, 114688
    s_cmp_ge_u32 s70, 401408
    s_cselect_b32 s71, 401408, 0
    s_sub_u32 s70, s70, s71
    buffer_load_dwordx4 v[144:147], v208, s[4:7], s70 offen offset:0 sc1
    buffer_load_dwordx4 v[148:151], v208, s[4:7], s70 offen offset:256 sc1
    buffer_load_dwordx4 v[152:155], v208, s[4:7], s70 offen offset:512 sc1
    buffer_load_dwordx4 v[156:159], v209, s[4:7], s70 offen sc1
    s_waitcnt vmcnt(0)
    s_nop 0
    v_max3_u32 v214, v144, v145, v146
    v_max3_u32 v214, v214, v147, v148
    v_max3_u32 v214, v214, v149, v150
    v_max3_u32 v214, v214, v151, v152
    v_max3_u32 v214, v214, v153, v154
    v_max3_u32 v214, v214, v155, v156
    v_max3_u32 v214, v214, v157, v158
    v_max_u32_e64 v214, v214, v159
    v_cmp_eq_u32 vcc, -1, v214
    s_nop 3
    s_cbranch_vccz sdone_136
    s_add_u32 s97, s97, 1
    s_cmp_lt_u32 s97, 4000
    s_cbranch_scc1 sloop_88
sdone_136:
    s_branch back_87
slow_89:
    s_mov_b32 s97, 0
sloop_91:
    s_add_u32 s70, s41, 143360
    s_cmp_ge_u32 s70, 401408
    s_cselect_b32 s71, 401408, 0
    s_sub_u32 s70, s70, s71
    buffer_load_dwordx4 v[160:163], v208, s[4:7], s70 offen offset:0 sc1
    buffer_load_dwordx4 v[164:167], v208, s[4:7], s70 offen offset:256 sc1
    buffer_load_dwordx4 v[168:171], v208, s[4:7], s70 offen offset:512 sc1
    buffer_load_dwordx4 v[172:175], v209, s[4:7], s70 offen sc1
    s_waitcnt vmcnt(0)
    s_nop 0
    v_max3_u32 v214, v160, v161, v162
    v_max3_u32 v214, v214, v163, v164
    v_max3_u32 v214, v214, v165, v166
    v_max3_u32 v214, v214, v167, v168
    v_max3_u32 v214, v214, v169, v170
    v_max3_u32 v214, v214, v171, v172
    v_max3_u32 v214, v214, v173, v174
    v_max_u32_e64 v214, v214, v175
    v_cmp_eq_u32 vcc, -1, v214
    s_nop 3
    s_cbranch_vccz sdone_137
    s_add_u32 s97, s97, 1
    s_cmp_lt_u32 s97, 4000
    s_cbranch_scc1 sloop_91
sdone_137:
    s_branch back_90
slow_92:
    s_mov_b32 s97, 0
sloop_94:
    s_add_u32 s70, s41, 172032
    s_cmp_ge_u32 s70, 401408
    s_cselect_b32 s71, 401408, 0
    s_sub_u32 s70, s70, s71
    buffer_load_dwordx4 v[80:83], v208, s[4:7], s70 offen offset:0 sc1
    buffer_load_dwordx4 v[84:87], v208, s[4:7], s70 offen offset:256 sc1
    buffer_load_dwordx4 v[88:91], v208, s[4:7], s70 offen offset:512 sc1
    buffer_load_dwordx4 v[92:95], v209, s[4:7], s70 offen sc1
    s_waitcnt vmcnt(0)
    s_nop 0
    v_max3_u32 v214, v80, v81, v82
    v_max3_u32 v214, v214, v83, v84
    v_max3_u32 v214, v214, v85, v86
    v_max3_u32 v214, v214, v87, v88
    v_max3_u32 v214, v214, v89, v90
    v_max3_u32 v214, v214, v91, v92
    v_max3_u32 v214, v214, v93, v94
    v_max_u32_e64 v214, v214, v95
    v_cmp_eq_u32 vcc, -1, v214
    s_nop 3
    s_cbranch_vccz sdone_138
    s_add_u32 s97, s97, 1
    s_cmp_lt_u32 s97, 4000
    s_cbranch_scc1 sloop_94
sdone_138:
    s_branch back_93
slow_95:
    s_mov_b32 s97, 0
sloop_97:
    s_add_u32 s70, s41, 200704
    s_cmp_ge_u32 s70, 401408
    s_cselect_b32 s71, 401408, 0
    s_sub_u32 s70, s70, s71
    buffer_load_dwordx4 v[96:99], v208, s[4:7], s70 offen offset:0 sc1
    buffer_load_dwordx4 v[100:103], v208, s[4:7], s70 offen offset:256 sc1
    buffer_load_dwordx4 v[104:107], v208, s[4:7], s70 offen offset:512 sc1
    buffer_load_dwordx4 v[108:111], v209, s[4:7], s70 offen sc1
    s_waitcnt vmcnt(0)
    s_nop 0
    v_max3_u32 v214, v96, v97, v98
    v_max3_u32 v214, v214, v99, v100
    v_max3_u32 v214, v214, v101, v102
    v_max3_u32 v214, v214, v103, v104
    v_max3_u32 v214, v214, v105, v106
    v_max3_u32 v214, v214, v107, v108
    v_max3_u32 v214, v214, v109, v110
    v_max_u32_e64 v214, v214, v111
    v_cmp_eq_u32 vcc, -1, v214
    s_nop 3
    s_cbranch_vccz sdone_139
    s_add_u32 s97, s97, 1
    s_cmp_lt_u32 s97, 4000
    s_cbranch_scc1 sloop_97
sdone_139:
    s_branch back_96
slow_98:
    s_mov_b32 s97, 0
sloop_100:
    s_add_u32 s70, s41, 229376
    s_cmp_ge_u32 s70, 401408
    s_cselect_b32 s71, 401408, 0
    s_sub_u32 s70, s70, s71
    buffer_load_dwordx4 v[112:115], v208, s[4:7], s70 offen offset:0 sc1
    buffer_load_dwordx4 v[116:119], v208, s[4:7], s70 offen offset:256 sc1
    buffer_load_dwordx4 v[120:123], v208, s[4:7], s70 offen offset:512 sc1
    buffer_load_dwordx4 v[124:127], v209, s[4:7], s70 offen sc1
    s_waitcnt vmcnt(0)
    s_nop 0
    v_max3_u32 v214, v112, v113, v114
    v_max3_u32 v214, v214, v115, v116
    v_max3_u32 v214, v214, v117, v118
    v_max3_u32 v214, v214, v119, v120
    v_max3_u32 v214, v214, v121, v122
    v_max3_u32 v214, v214, v123, v124
    v_max3_u32 v214, v214, v125, v126
    v_max_u32_e64 v214, v214, v127
    v_cmp_eq_u32 vcc, -1, v214
    s_nop 3
    s_cbranch_vccz sdone_140
    s_add_u32 s97, s97, 1
    s_cmp_lt_u32 s97, 4000
    s_cbranch_scc1 sloop_100
sdone_140:
    s_branch back_99
slow_101:
    s_mov_b32 s97, 0
sloop_103:
    s_add_u32 s70, s41, 258048
    s_cmp_ge_u32 s70, 401408
    s_cselect_b32 s71, 401408, 0
    s_sub_u32 s70, s70, s71
    buffer_load_dwordx4 v[128:131], v208, s[4:7], s70 offen offset:0 sc1
    buffer_load_dwordx4 v[132:135], v208, s[4:7], s70 offen offset:256 sc1
    buffer_load_dwordx4 v[136:139], v208, s[4:7], s70 offen offset:512 sc1
    buffer_load_dwordx4 v[140:143], v209, s[4:7], s70 offen sc1
    s_waitcnt vmcnt(0)
    s_nop 0
    v_max3_u32 v214, v128, v129, v130
    v_max3_u32 v214, v214, v131, v132
    v_max3_u32 v214, v214, v133, v134
    v_max3_u32 v214, v214, v135, v136
    v_max3_u32 v214, v214, v137, v138
    v_max3_u32 v214, v214, v139, v140
    v_max3_u32 v214, v214, v141, v142
    v_max_u32_e64 v214, v214, v143
    v_cmp_eq_u32 vcc, -1, v214
    s_nop 3
    s_cbranch_vccz sdone_141
    s_add_u32 s97, s97, 1
    s_cmp_lt_u32 s97, 4000
    s_cbranch_scc1 sloop_103
sdone_141:
    s_branch back_102
slow_104:
    s_mov_b32 s97, 0
sloop_106:
    s_add_u32 s70, s41, 286720
    s_cmp_ge_u32 s70, 401408
    s_cselect_b32 s71, 401408, 0
    s_sub_u32 s70, s70, s71
    buffer_load_dwordx4 v[144:147], v208, s[4:7], s70 offen offset:0 sc1
    buffer_load_dwordx4 v[148:151], v208, s[4:7], s70 offen offset:256 sc1
    buffer_load_dwordx4 v[152:155], v208, s[4:7], s70 offen offset:512 sc1
    buffer_load_dwordx4 v[156:159], v209, s[4:7], s70 offen sc1
    s_waitcnt vmcnt(0)
    s_nop 0
    v_max3_u32 v214, v144, v145, v146
    v_max3_u32 v214, v214, v147, v148
    v_max3_u32 v214, v214, v149, v150
    v_max3_u32 v214, v214, v151, v152
    v_max3_u32 v214, v214, v153, v154
    v_max3_u32 v214, v214, v155, v156
    v_max3_u32 v214, v214, v157, v158
    v_max_u32_e64 v214, v214, v159
    v_cmp_eq_u32 vcc, -1, v214
    s_nop 3
    s_cbranch_vccz sdone_142
    s_add_u32 s97, s97, 1
    s_cmp_lt_u32 s97, 4000
    s_cbranch_scc1 sloop_106
sdone_142:
    s_branch back_105
slow_107:
    s_mov_b32 s97, 0
sloop_109:
    s_add_u32 s70, s41, 315392
    s_cmp_ge_u32 s70, 401408
    s_cselect_b32 s71, 401408, 0
    s_sub_u32 s70, s70, s71
    buffer_load_dwordx4 v[160:163], v208, s[4:7], s70 offen offset:0 sc1
    buffer_load_dwordx4 v[164:167], v208, s[4:7], s70 offen offset:256 sc1
    buffer_load_dwordx4 v[168:171], v208, s[4:7], s70 offen offset:512 sc1
    buffer_load_dwordx4 v[172:175], v209, s[4:7], s70 offen sc1
    s_waitcnt vmcnt(0)
    s_nop 0
    v_max3_u32 v214, v160, v161, v162
    v_max3_u32 v214, v214, v163, v164
    v_max3_u32 v214, v214, v165, v166
    v_max3_u32 v214, v214, v167, v168
    v_max3_u32 v214, v214, v169, v170
    v_max3_u32 v214, v214, v171, v172
    v_max3_u32 v214, v214, v173, v174
    v_max_u32_e64 v214, v214, v175
    v_cmp_eq_u32 vcc, -1, v214
    s_nop 3
    s_cbranch_vccz sdone_143
    s_add_u32 s97, s97, 1
    s_cmp_lt_u32 s97, 4000
    s_cbranch_scc1 sloop_109
sdone_143:
    s_branch back_108
slow_110:
    s_mov_b32 s97, 0
sloop_112:
    s_add_u32 s70, s41, 344064
    s_cmp_ge_u32 s70, 401408
    s_cselect_b32 s71, 401408, 0
    s_sub_u32 s70, s70, s71
    buffer_load_dwordx4 v[80:83], v208, s[4:7], s70 offen offset:0 sc1
    buffer_load_dwordx4 v[84:87], v208, s[4:7], s70 offen offset:256 sc1
    buffer_load_dwordx4 v[88:91], v208, s[4:7], s70 offen offset:512 sc1
    buffer_load_dwordx4 v[92:95], v209, s[4:7], s70 offen sc1
    s_waitcnt vmcnt(0)
    s_nop 0
    v_max3_u32 v214, v80, v81, v82
    v_max3_u32 v214, v214, v83, v84
    v_max3_u32 v214, v214, v85, v86
    v_max3_u32 v214, v214, v87, v88
    v_max3_u32 v214, v214, v89, v90
    v_max3_u32 v214, v214, v91, v92
    v_max3_u32 v214, v214, v93, v94
    v_max_u32_e64 v214, v214, v95
    v_cmp_eq_u32 vcc, -1, v214
    s_nop 3
    s_cbranch_vccz sdone_144
    s_add_u32 s97, s97, 1
    s_cmp_lt_u32 s97, 4000
    s_cbranch_scc1 sloop_112
sdone_144:
    s_branch back_111
slow_113:
    s_mov_b32 s97, 0
sloop_115:
    s_add_u32 s70, s41, 372736
    s_cmp_ge_u32 s70, 401408
    s_cselect_b32 s71, 401408, 0
    s_sub_u32 s70, s70, s71
    buffer_load_dwordx4 v[96:99], v208, s[4:7], s70 offen offset:0 sc1
    buffer_load_dwordx4 v[100:103], v208, s[4:7], s70 offen offset:256 sc1
    buffer_load_dwordx4 v[104:107], v208, s[4:7], s70 offen offset:512 sc1
    buffer_load_dwordx4 v[108:111], v209, s[4:7], s70 offen sc1
    s_waitcnt vmcnt(0)
    s_nop 0
    v_max3_u32 v214, v96, v97, v98
    v_max3_u32 v214, v214, v99, v100
    v_max3_u32 v214, v214, v101, v102
    v_max3_u32 v214, v214, v103, v104
    v_max3_u32 v214, v214, v105, v106
    v_max3_u32 v214, v214, v107, v108
    v_max3_u32 v214, v214, v109, v110
    v_max_u32_e64 v214, v214, v111
    v_cmp_eq_u32 vcc, -1, v214
    s_nop 3
    s_cbranch_vccz sdone_145
    s_add_u32 s97, s97, 1
    s_cmp_lt_u32 s97, 4000
    s_cbranch_scc1 sloop_115
sdone_145:
    s_branch back_114
kcode_end:
.p2align 4
.type ktab_idx,@object
ktab_idx:
.short 1280, 1280, 1280, 1280, 1278, 1278, 1278, 1278, 1278, 1278, 1278, 1276, 1276, 1276, 1276, 1536
.short 1278, 1278, 1278, 1276, 1276, 1276, 1276, 1276, 1276, 1276, 1276, 1276, 1274, 1274, 1274, 1536
.short 1276, 1276, 1276, 1276, 1274, 1274, 1274, 1274, 1274, 1274, 1274, 1272, 1272, 1272, 1272, 1536
.short 1274, 1274, 1274, 1272, 1272, 1272, 1272, 1272, 1272, 1272, 1272, 1272, 1270, 1270, 1270, 1536
.short 1272, 1272, 1272, 1272, 1270, 1270, 1270, 1270, 1270, 1270, 1270, 1268, 1268, 1268, 1268, 1536
.short 1270, 1270, 1270, 1268, 1268, 1268, 1268, 1268, 1268, 1268, 1268, 1268, 1266, 1266, 1266, 1536
.short 1268, 1268, 1268, 1268, 1266, 1266, 1266, 1266, 1266, 1266, 1266, 1264, 1264, 1264, 1264, 1536
.short 1266, 1266, 1266, 1264, 1264, 1264, 1264, 1264, 1264, 1264, 1264, 1264, 1262, 1262, 1262, 1536
.short 1264, 1264, 1264, 1264, 1262, 1262, 1262, 1262, 1262, 1262, 1262, 1260, 1260, 1260, 1260, 1536
.short 1262, 1262, 1262, 1260, 1260, 1260, 1260, 1260, 1260, 1260, 1260, 1260, 1258, 1258, 1258, 1536
.short 1260, 1260, 1260, 1260, 1258, 1258, 1258, 1258, 1258, 1258, 1258, 1256, 1256, 1256, 1256, 1536
.short 1258, 1258, 1258, 1256, 1256, 1256, 1256, 1256, 1256, 1256, 1256, 1256, 1254, 1254, 1254, 1536
.short 1256, 1256, 1256, 1256, 1254, 1254, 1254, 1254, 1254, 1254, 1254, 1252, 1252, 1252, 1252, 1536
.short 1254, 1254, 1254, 1252, 1252, 1252, 1252, 1252, 1252, 1252, 1252, 1252, 1250, 1250, 1250, 1536
.short 1252, 1252, 1252, 1252, 1250, 1250, 1250, 1250, 1250, 1250, 1250, 1248, 1248, 1248, 1248, 1536
.short 1250, 1250, 1250, 1248, 1248, 1248, 1248, 1248, 1248, 1248, 1248, 1248, 1246, 1246, 1246, 1536
.short 1248, 1248, 1248, 1248, 1246, 1246, 1246, 1246, 1246, 1246, 1246, 1244, 1244, 1244, 1244, 1536
.short 1246, 1246, 1246, 1244, 1244, 1244, 1244, 1244, 1244, 1244, 1244, 1244, 1242, 1242, 1242, 1536
.short 1244, 1244, 1244, 1244, 1242, 1242, 1242, 1242, 1242, 1242, 1242, 1240, 1240, 1240, 1240, 1536
.short 1242, 1242, 1242, 1240, 1240, 1240, 1240, 1240, 1240, 1240, 1240, 1240, 1238, 1238, 1238, 1536
.short 1240, 1240, 1240, 1240, 1238, 1238, 1238, 1238, 1238, 1238, 1238, 1236, 1236, 1236, 1236, 1536
.short 1238, 1238, 1238, 1236, 1236, 1236, 1236, 1236, 1236, 1236, 1236, 1236, 1234, 1234, 1234, 1536
.short 1236, 1236, 1236, 1236, 1234, 1234, 1234, 1234, 1234, 1234, 1234, 1232, 1232, 1232, 1232, 1536
.short 1234, 1234, 1234, 1232, 1232, 1232, 1232, 1232, 1232, 1232, 1232, 1232, 1230, 1230, 1230, 1536
.short 1232, 1232, 1232, 1232, 1230, 1230, 1230, 1230, 1230, 1230, 1230, 1228, 1228, 1228, 1228, 1536
.short 1230, 1230, 1230, 1228, 1228, 1228, 1228, 1228, 1228, 1228, 1228, 1228, 1226, 1226, 1226, 1536
.short 1228, 1228, 1228, 1228, 1226, 1226, 1226, 1226, 1226, 1226, 1226, 1224, 1224, 1224, 1224, 1536
.short 1226, 1226, 1226, 1224, 1224, 1224, 1224, 1224, 1224, 1224, 1224, 1224, 1222, 1222, 1222, 1536
.short 1224, 1224, 1224, 1224, 1222, 1222, 1222, 1222, 1222, 1222, 1222, 1220, 1220, 1220, 1220, 1536
.short 1222, 1222, 1222, 1220, 1220, 1220, 1220, 1220, 1220, 1220, 1220, 1220, 1218, 1218, 1218, 1536
.short 1220, 1220, 1220, 1220, 1218, 1218, 1218, 1218, 1218, 1218, 1218, 1216, 1216, 1216, 1216, 1536
.short 1218, 1218, 1218, 1216, 1216, 1216, 1216, 1216, 1216, 1216, 1216, 1216, 1214, 1214, 1214, 1536
.short 1216, 1216, 1216, 1216, 1214, 1214, 1214, 1214, 1214, 1214, 1214, 1212, 1212, 1212, 1212, 1536
.short 1214, 1214, 1214, 1212, 1212, 1212, 1212, 1212, 1212, 1212, 1212, 1212, 1210, 1210, 1210, 1536
.short 1212, 1212, 1212, 1212, 1210, 1210, 1210, 1210, 1210, 1210, 1210, 1208, 1208, 1208, 1208, 1536
.short 1210, 1210, 1210, 1208, 1208, 1208, 1208, 1208, 1208, 1208, 1208, 1208, 1206, 1206, 1206, 1536
.short 1208, 1208, 1208, 1208, 1206, 1206, 1206, 1206, 1206, 1206, 1206, 1204, 1204, 1204, 1204, 1536
.short 1206, 1206, 1206, 1204, 1204, 1204, 1204, 1204, 1204, 1204, 1204, 1204, 1202, 1202, 1202, 1536
.short 1204, 1204, 1204, 1204, 1202, 1202, 1202, 1202, 1202, 1202, 1202, 1200, 1200, 1200, 1200, 1536
.short 1202, 1202, 1202, 1200, 1200, 1200, 1200, 1200, 1200, 1200, 1200, 1200, 1198, 1198, 1198, 1536
.short 1200, 1200, 1200, 1200, 1198, 1198, 1198, 1198, 1198, 1198, 1198, 1196, 1196, 1196, 1196, 1536
.short 1198, 1198, 1198, 1196, 1196, 1196, 1196, 1196, 1196, 1196, 1196, 1196, 1194, 1194, 1194, 1536
.short 1196, 1196, 1196, 1196, 1194, 1194, 1194, 1194, 1194, 1194, 1194, 1192, 1192, 1192, 1192, 1536
.short 1194, 1194, 1194, 1192, 1192, 1192, 1192, 1192, 1192, 1192, 1192, 1192, 1190, 1190, 1190, 1536
.short 1192, 1192, 1192, 1192, 1190, 1190, 1190, 1190, 1190, 1190, 1190, 1188, 1188, 1188, 1188, 1536
.short 1190, 1190, 1190, 1188, 1188, 1188, 1188, 1188, 1188, 1188, 1188, 1188, 1186, 1186, 1186, 1536
.short 1188, 1188, 1188, 1188, 1186, 1186, 1186, 1186, 1186, 1186, 1186, 1184, 1184, 1184, 1184, 1536
.short 1186, 1186, 1186, 1184, 1184, 1184, 1184, 1184, 1184, 1184, 1184, 1184, 1182, 1182, 1182, 1536
.short 1184, 1184, 1184, 1184, 1182, 1182, 1182, 1182, 1182, 1182, 1182, 1180, 1180, 1180, 1180, 1536
.short 1182, 1182, 1182, 1180, 1180, 1180, 1180, 1180, 1180, 1180, 1180, 1180, 1178, 1178, 1178, 1536
.short 1180, 1180, 1180, 1180, 1178, 1178, 1178, 1178, 1178, 1178, 1178, 1176, 1176, 1176, 1176, 1536
.short 1178, 1178, 1178, 1176, 1176, 1176, 1176, 1176, 1176, 1176, 1176, 1176, 1174, 1174, 1174, 1536
.short 1176, 1176, 1176, 1176, 1174, 1174, 1174, 1174, 1174, 1174, 1174, 1172, 1172, 1172, 1172, 1536
.short 1174, 1174, 1174, 1172, 1172, 1172, 1172, 1172, 1172, 1172, 1172, 1172, 1170, 1170, 1170, 1536
.short 1172, 1172, 1172, 1172, 1170, 1170, 1170, 1170, 1170, 1170, 1170, 1168, 1168, 1168, 1168, 1536
.short 1170, 1170, 1170, 1168, 1168, 1168, 1168, 1168, 1168, 1168, 1168, 1168, 1166, 1166, 1166, 1536
.short 1168, 1168, 1168, 1168, 1166, 1166, 1166, 1166, 1166, 1166, 1166, 1164, 1164, 1164, 1164, 1536
.short 1166, 1166, 1166, 1164, 1164, 1164, 1164, 1164, 1164, 1164, 1164, 1164, 1162, 1162, 1162, 1536
.short 1164, 1164, 1164, 1164, 1162, 1162, 1162, 1162, 1162, 1162, 1162, 1160, 1160, 1160, 1160, 1536
.short 1162, 1162, 1162, 1160, 1160, 1160, 1160, 1160, 1160, 1160, 1160, 1160, 1158, 1158, 1158, 1536
.short 1160, 1160, 1160, 1160, 1158, 1158, 1158, 1158, 1158, 1158, 1158, 1156, 1156, 1156, 1156, 1536
.short 1158, 1158, 1158, 1156, 1156, 1156, 1156, 1156, 1156, 1156, 1156, 1156, 1154, 1154, 1154, 1536
.short 1156, 1156, 1156, 1156, 1154, 1154, 1154, 1154, 1154, 1154, 1154, 1152, 1152, 1152, 1152, 1536
.short 1154, 1154, 1154, 1152, 1152, 1152, 1152, 1152, 1152, 1152, 1152, 1152, 1150, 1150, 1150, 1536
.short 1152, 1152, 1152, 1152, 1150, 1150, 1150, 1150, 1150, 1150, 1150, 1148, 1148, 1148, 1148, 1536
.short 1150, 1150, 1150, 1148, 1148, 1148, 1148, 1148, 1148, 1148, 1148, 1148, 1146, 1146, 1146, 1536
.short 1148, 1148, 1148, 1148, 1146, 1146, 1146, 1146, 1146, 1146, 1146, 1144, 1144, 1144, 1144, 1536
.short 1146, 1146, 1146, 1144, 1144, 1144, 1144, 1144, 1144, 1144, 1144, 1144, 1142, 1142, 1142, 1536
.short 1144, 1144, 1144, 1144, 1142, 1142, 1142, 1142, 1142, 1142, 1142, 1140, 1140, 1140, 1140, 1536
.short 1142, 1142, 1142, 1140, 1140, 1140, 1140, 1140, 1140, 1140, 1140, 1140, 1138, 1138, 1138, 1536
.short 1140, 1140, 1140, 1140, 1138, 1138, 1138, 1138, 1138, 1138, 1138, 1136, 1136, 1136, 1136, 1536
.short 1138, 1138, 1138, 1136, 1136, 1136, 1136, 1136, 1136, 1136, 1136, 1136, 1134, 1134, 1134, 1536
.short 1136, 1136, 1136, 1136, 1134, 1134, 1134, 1134, 1134, 1134, 1134, 1132, 1132, 1132, 1132, 1536
.short 1134, 1134, 1134, 1132, 1132, 1132, 1132, 1132, 1132, 1132, 1132, 1132, 1130, 1130, 1130, 1536
.short 1132, 1132, 1132, 1132, 1130, 1130, 1130, 1130, 1130, 1130, 1130, 1128, 1128, 1128, 1128, 1536
.short 1130, 1130, 1130, 1128, 1128, 1128, 1128, 1128, 1128, 1128, 1128, 1128, 1126, 1126, 1126, 1536
.short 1128, 1128, 1128, 1128, 1126, 1126, 1126, 1126, 1126, 1126, 1126, 1124, 1124, 1124, 1124, 1536
.short 1126, 1126, 1126, 1124, 1124, 1124, 1124, 1124, 1124, 1124, 1124, 1124, 1122, 1122, 1122, 1536
.short 1124, 1124, 1124, 1124, 1122, 1122, 1122, 1122, 1122, 1122, 1122, 1120, 1120, 1120, 1120, 1536
.short 1122, 1122, 1122, 1120, 1120, 1120, 1120, 1120, 1120, 1120, 1120, 1120, 1118, 1118, 1118, 1536
.short 1120, 1120, 1120, 1120, 1118, 1118, 1118, 1118, 1118, 1118, 1118, 1116, 1116, 1116, 1116, 1536
.short 1118, 1118, 1118, 1116, 1116, 1116, 1116, 1116, 1116, 1116, 1116, 1116, 1114, 1114, 1114, 1536
.short 1116, 1116, 1116, 1116, 1114, 1114, 1114, 1114, 1114, 1114, 1114, 1112, 1112, 1112, 1112, 1536
.short 1114, 1114, 1114, 1112, 1112, 1112, 1112, 1112, 1112, 1112, 1112, 1112, 1110, 1110, 1110, 1536
.short 1112, 1112, 1112, 1112, 1110, 1110, 1110, 1110, 1110, 1110, 1110, 1108, 1108, 1108, 1108, 1536
.short 1110, 1110, 1110, 1108, 1108, 1108, 1108, 1108, 1108, 1108, 1108, 1108, 1106, 1106, 1106, 1536
.short 1108, 1108, 1108, 1108, 1106, 1106, 1106, 1106, 1106, 1106, 1106, 1104, 1104, 1104, 1104, 1536
.short 1106, 1106, 1106, 1104, 1104, 1104, 1104, 1104, 1104, 1104, 1104, 1104, 1102, 1102, 1102, 1536
.short 1104, 1104, 1104, 1104, 1102, 1102, 1102, 1102, 1102, 1102, 1102, 1100, 1100, 1100, 1100, 1536
.short 1102, 1102, 1102, 1100, 1100, 1100, 1100, 1100, 1100, 1100, 1100, 1100, 1098, 1098, 1098, 1536
.short 1100, 1100, 1100, 1100, 1098, 1098, 1098, 1098, 1098, 1098, 1098, 1096, 1096, 1096, 1096, 1536
.short 1098, 1098, 1098, 1096, 1096, 1096, 1096, 1096, 1096, 1096, 1096, 1096, 1094, 1094, 1094, 1536
.short 1096, 1096, 1096, 1096, 1094, 1094, 1094, 1094, 1094, 1094, 1094, 1092, 1092, 1092, 1092, 1536
.short 1094, 1094, 1094, 1092, 1092, 1092, 1092, 1092, 1092, 1092, 1092, 1092, 1090, 1090, 1090, 1536
.short 1092, 1092, 1092, 1092, 1090, 1090, 1090, 1090, 1090, 1090, 1090, 1088, 1088, 1088, 1088, 1536
.short 1090, 1090, 1090, 1088, 1088, 1088, 1088, 1088, 1088, 1088, 1088, 1088, 1086, 1086, 1086, 1536
.short 1088, 1088, 1088, 1088, 1086, 1086, 1086, 1086, 1086, 1086, 1086, 1084, 1084, 1084, 1084, 1536
.short 1086, 1086, 1086, 1084, 1084, 1084, 1084, 1084, 1084, 1084, 1084, 1084, 1082, 1082, 1082, 1536
.short 1084, 1084, 1084, 1084, 1082, 1082, 1082, 1082, 1082, 1082, 1082, 1080, 1080, 1080, 1080, 1536
.short 1082, 1082, 1082, 1080, 1080, 1080, 1080, 1080, 1080, 1080, 1080, 1080, 1078, 1078, 1078, 1536
.short 1080, 1080, 1080, 1080, 1078, 1078, 1078, 1078, 1078, 1078, 1078, 1076, 1076, 1076, 1076, 1536
.short 1078, 1078, 1078, 1076, 1076, 1076, 1076, 1076, 1076, 1076, 1076, 1076, 1074, 1074, 1074, 1536
.short 1076, 1076, 1076, 1076, 1074, 1074, 1074, 1074, 1074, 1074, 1074, 1072, 1072, 1072, 1072, 1536
.short 1074, 1074, 1074, 1072, 1072, 1072, 1072, 1072, 1072, 1072, 1072, 1072, 1070, 1070, 1070, 1536
.short 1072, 1072, 1072, 1072, 1070, 1070, 1070, 1070, 1070, 1070, 1070, 1068, 1068, 1068, 1068, 1536
.short 1070, 1070, 1070, 1068, 1068, 1068, 1068, 1068, 1068, 1068, 1068, 1068, 1066, 1066, 1066, 1536
.short 1068, 1068, 1068, 1068, 1066, 1066, 1066, 1066, 1066, 1066, 1066, 1064, 1064, 1064, 1064, 1536
.short 1066, 1066, 1066, 1064, 1064, 1064, 1064, 1064, 1064, 1064, 1064, 1064, 1062, 1062, 1062, 1536
.short 1064, 1064, 1064, 1064, 1062, 1062, 1062, 1062, 1062, 1062, 1062, 1060, 1060, 1060, 1060, 1536
.short 1062, 1062, 1062, 1060, 1060, 1060, 1060, 1060, 1060, 1060, 1060, 1060, 1058, 1058, 1058, 1536
.short 1060, 1060, 1060, 1060, 1058, 1058, 1058, 1058, 1058, 1058, 1058, 1056, 1056, 1056, 1056, 1536
.short 1058, 1058, 1058, 1056, 1056, 1056, 1056, 1056, 1056, 1056, 1056, 1056, 1054, 1054, 1054, 1536
.short 1056, 1056, 1056, 1056, 1054, 1054, 1054, 1054, 1054, 1054, 1054, 1052, 1052, 1052, 1052, 1536
.short 1054, 1054, 1054, 1052, 1052, 1052, 1052, 1052, 1052, 1052, 1052, 1052, 1050, 1050, 1050, 1536
.short 1052, 1052, 1052, 1052, 1050, 1050, 1050, 1050, 1050, 1050, 1050, 1048, 1048, 1048, 1048, 1536
.short 1050, 1050, 1050, 1048, 1048, 1048, 1048, 1048, 1048, 1048, 1048, 1048, 1046, 1046, 1046, 1536
.short 1048, 1048, 1048, 1048, 1046, 1046, 1046, 1046, 1046, 1046, 1046, 1044, 1044, 1044, 1044, 1536
.short 1046, 1046, 1046, 1044, 1044, 1044, 1044, 1044, 1044, 1044, 1044, 1044, 1042, 1042, 1042, 1536
.short 1044, 1044, 1044, 1044, 1042, 1042, 1042, 1042, 1042, 1042, 1042, 1040, 1040, 1040, 1040, 1536
.short 1042, 1042, 1042, 1040, 1040, 1040, 1040, 1040, 1040, 1040, 1040, 1040, 1038, 1038, 1038, 1536
.short 1040, 1040, 1040, 1040, 1038, 1038, 1038, 1038, 1038, 1038, 1038, 1036, 1036, 1036, 1036, 1536
.short 1038, 1038, 1038, 1036, 1036, 1036, 1036, 1036, 1036, 1036, 1036, 1036, 1034, 1034, 1034, 1536
.short 1036, 1036, 1036, 1036, 1034, 1034, 1034, 1034, 1034, 1034, 1034, 1032, 1032, 1032, 1032, 1536
.short 1034, 1034, 1034, 1032, 1032, 1032, 1032, 1032, 1032, 1032, 1032, 1032, 1030, 1030, 1030, 1536
.short 1032, 1032, 1032, 1032, 1030, 1030, 1030, 1030, 1030, 1030, 1030, 1028, 1028, 1028, 1028, 1536
.short 1030, 1030, 1030, 1028, 1028, 1028, 1028, 1028, 1028, 1028, 1028, 1028, 1026, 1026, 1026, 1536
.short 1028, 1028, 1028, 1028, 1026, 1026, 1026, 1026, 1026, 1026, 1026, 1024, 1024, 1024, 1024, 1536
.short 1026, 1026, 1026, 1024, 1024, 1024, 1024, 1024, 1024, 1024, 1022, 1022, 1022, 990, 990, 1536
.short 1024, 1024, 1022, 1022, 1022, 990, 990, 990, 990, 990, 1020, 1020, 1020, 988, 988, 1536
.short 990, 990, 1020, 1020, 1020, 988, 988, 988, 988, 988, 1018, 1018, 1018, 986, 986, 1536
.short 988, 988, 1018, 1018, 1018, 986, 986, 986, 986, 986, 1016, 1016, 1016, 984, 984, 1536
.short 986, 986, 1016, 1016, 1016, 984, 984, 984, 984, 984, 1014, 1014, 1014, 982, 982, 1536
.short 984, 984, 1014, 1014, 1014, 982, 982, 982, 982, 982, 1012, 1012, 1012, 980, 980, 1536
.short 982, 982, 1012, 1012, 1012, 980, 980, 980, 980, 980, 1010, 1010, 1010, 978, 978, 1536
.short 980, 980, 1010, 1010, 1010, 978, 978, 978, 978, 978, 1008, 1008, 1008, 976, 976, 1536
.short 978, 978, 1008, 1008, 1008, 976, 976, 976, 976, 976, 1006, 1006, 1006, 974, 974, 1536
.short 976, 976, 1006, 1006, 1006, 974, 974, 974, 974, 974, 1004, 1004, 1004, 972, 972, 1536
.short 974, 974, 1004, 1004, 1004, 972, 972, 972, 972, 972, 1002, 1002, 1002, 970, 970, 1536
.short 972, 972, 1002, 1002, 1002, 970, 970, 970, 970, 970, 1000, 1000, 1000, 968, 968, 1536
.short 970, 970, 1000, 1000, 1000, 968, 968, 968, 968, 968, 998, 998, 998, 966, 966, 1536
.short 968, 968, 998, 998, 998, 966, 966, 966, 966, 966, 996, 996, 996, 964, 964, 1536
.short 966, 966, 996, 996, 996, 964, 964, 964, 964, 964, 994, 994, 994, 962, 962, 1536
.short 964, 964, 994, 994, 994, 962, 962, 962, 962, 962, 992, 992, 992, 960, 960, 1536
.short 962, 962, 992, 992, 992, 960, 960, 960, 960, 960, 958, 958, 958, 926, 926, 1536
.short 960, 960, 958, 958, 958, 926, 926, 926, 926, 926, 956, 956, 956, 924, 924, 1536
.short 926, 926, 956, 956, 956, 924, 924, 924, 924, 924, 954, 954, 954, 922, 922, 1536
.short 924, 924, 954, 954, 954, 922, 922, 922, 922, 922, 952, 952, 952, 920, 920, 1536
.short 922, 922, 952, 952, 952, 920, 920, 920, 920, 920, 950, 950, 950, 918, 918, 1536
.short 920, 920, 950, 950, 950, 918, 918, 918, 918, 918, 948, 948, 948, 916, 916, 1536
.short 918, 918, 948, 948, 948, 916, 916, 916, 916, 916, 946, 946, 946, 914, 914, 1536
.short 916, 916, 946, 946, 946, 914, 914, 914, 914, 914, 944, 944, 944, 912, 912, 1536
.short 914, 914, 944, 944, 944, 912, 912, 912, 912, 912, 942, 942, 942, 910, 910, 1536
.short 912, 912, 942, 942, 942, 910, 910, 910, 910, 910, 940, 940, 940, 908, 908, 1536
.short 910, 910, 940, 940, 940, 908, 908, 908, 908, 908, 938, 938, 938, 906, 906, 1536
.short 908, 908, 938, 938, 938, 906, 906, 906, 906, 906, 936, 936, 936, 904, 904, 1536
.short 906, 906, 936, 936, 936, 904, 904, 904, 904, 904, 934, 934, 934, 902, 902, 1536
.short 904, 904, 934, 934, 934, 902, 902, 902, 902, 902, 932, 932, 932, 900, 900, 1536
.short 902, 902, 932, 932, 932, 900, 900, 900, 900, 900, 930, 930, 930, 898, 898, 1536
.short 900, 900, 930, 930, 930, 898, 898, 898, 898, 898, 928, 928, 928, 896, 896, 1536
.short 898, 898, 928, 928, 928, 896, 896, 896, 896, 896, 894, 894, 894, 862, 862, 1536
.short 896, 896, 894, 894, 894, 862, 862, 862, 862, 862, 892, 892, 892, 860, 860, 1536
.short 862, 862, 892, 892, 892, 860, 860, 860, 860, 860, 890, 890, 890, 858, 858, 1536
.short 860, 860, 890, 890, 890, 858, 858, 858, 858, 858, 888, 888, 888, 856, 856, 1536
.short 858, 858, 888, 888, 888, 856, 856, 856, 856, 856, 886, 886, 886, 854, 854, 1536
.short 856, 856, 886, 886, 886, 854, 854, 854, 854, 854, 884, 884, 884, 852, 852, 1536
.short 854, 854, 884, 884, 884, 852, 852, 852, 852, 852, 882, 882, 882, 850, 850, 1536
.short 852, 852, 882, 882, 882, 850, 850, 850, 850, 850, 880, 880, 880, 848, 848, 1536
.short 850, 850, 880, 880, 880, 848, 848, 848, 848, 848, 878, 878, 878, 846, 846, 1536
.short 848, 848, 878, 878, 878, 846, 846, 846, 846, 846, 876, 876, 876, 844, 844, 1536
.short 846, 846, 876, 876, 876, 844, 844, 844, 844, 844, 874, 874, 874, 842, 842, 1536
.short 844, 844, 874, 874, 874, 842, 842, 842, 842, 842, 872, 872, 872, 840, 840, 1536
.short 842, 842, 872, 872, 872, 840, 840, 840, 840, 840, 870, 870, 870, 838, 838, 1536
.short 840, 840, 870, 870, 870, 838, 838, 838, 838, 838, 868, 868, 868, 836, 836, 1536
.short 838, 838, 868, 868, 868, 836, 836, 836, 836, 836, 866, 866, 866, 834, 834, 1536
.short 836, 836, 866, 866, 866, 834, 834, 834, 834, 834, 864, 864, 864, 832, 832, 1536
.short 834, 834, 864, 864, 864, 832, 832, 832, 832, 832, 830, 830, 830, 798, 798, 1536
.short 832, 832, 830, 830, 830, 798, 798, 798, 798, 798, 828, 828, 828, 796, 796, 1536
.short 798, 798, 828, 828, 828, 796, 796, 796, 796, 796, 826, 826, 826, 794, 794, 1536
.short 796, 796, 826, 826, 826, 794, 794, 794, 794, 794, 824, 824, 824, 792, 792, 1536
.short 794, 794, 824, 824, 824, 792, 792, 792, 792, 792, 822, 822, 822, 790, 790, 1536
.short 792, 792, 822, 822, 822, 790, 790, 790, 790, 790, 820, 820, 820, 788, 788, 1536
.short 790, 790, 820, 820, 820, 788, 788, 788, 788, 788, 818, 818, 818, 786, 786, 1536
.short 788, 788, 818, 818, 818, 786, 786, 786, 786, 786, 816, 816, 816, 784, 784, 1536
.short 786, 786, 816, 816, 816, 784, 784, 784, 784, 784, 814, 814, 814, 782, 782, 1536
.short 784, 784, 814, 814, 814, 782, 782, 782, 782, 782, 812, 812, 812, 780, 780, 1536
.short 782, 782, 812, 812, 812, 780, 780, 780, 780, 780, 810, 810, 810, 778, 778, 1536
.short 780, 780, 810, 810, 810, 778, 778, 778, 778, 778, 808, 808, 808, 776, 776, 1536
.short 778, 778, 808, 808, 808, 776, 776, 776, 776, 776, 806, 806, 806, 774, 774, 1536
.short 776, 776, 806, 806, 806, 774, 774, 774, 774, 774, 804, 804, 804, 772, 772, 1536
.short 774, 774, 804, 804, 804, 772, 772, 772, 772, 772, 802, 802, 802, 770, 770, 1536
.short 772, 772, 802, 802, 802, 770, 770, 770, 770, 770, 800, 800, 800, 768, 768, 1536
.short 770, 770, 800, 800, 800, 768, 768, 768, 768, 766, 734, 734, 734, 702, 670, 1536
.short 768, 766, 734, 734, 734, 702, 670, 670, 670, 764, 732, 732, 732, 700, 668, 1536
.short 670, 764, 732, 732, 732, 700, 668, 668, 668, 762, 730, 730, 730, 698, 666, 1536
.short 668, 762, 730, 730, 730, 698, 666, 666, 666, 760, 728, 728, 728, 696, 664, 1536
.short 666, 760, 728, 728, 728, 696, 664, 664, 664, 758, 726, 726, 726, 694, 662, 1536
.short 664, 758, 726, 726, 726, 694, 662, 662, 662, 756, 724, 724, 724, 692, 660, 1536
.short 662, 756, 724, 724, 724, 692, 660, 660, 660, 754, 722, 722, 722, 690, 658, 1536
.short 660, 754, 722, 722, 722, 690, 658, 658, 658, 752, 720, 720, 720, 688, 656, 1536
.short 658, 752, 720, 720, 720, 688, 656, 656, 656, 750, 718, 718, 718, 686, 654, 1536
.short 656, 750, 718, 718, 718, 686, 654, 654, 654, 748, 716, 716, 716, 684, 652, 1536
.short 654, 748, 716, 716, 716, 684, 652, 652, 652, 746, 714, 714, 714, 682, 650, 1536
.short 652, 746, 714, 714, 714, 682, 650, 650, 650, 744, 712, 712, 712, 680, 648, 1536
.short 650, 744, 712, 712, 712, 680, 648, 648, 648, 742, 710, 710, 710, 678, 646, 1536
.short 648, 742, 710, 710, 710, 678, 646, 646, 646, 740, 708, 708, 708, 676, 644, 1536
.short 646, 740, 708, 708, 708, 676, 644, 644, 644, 738, 706, 706, 706, 674, 642, 1536
.short 644, 738, 706, 706, 706, 674, 642, 642, 642, 736, 704, 704, 704, 672, 640, 1536
.short 642, 736, 704, 704, 704, 672, 640, 640, 640, 638, 606, 606, 606, 574, 542, 1536
.short 640, 638, 606, 606, 606, 574, 542, 542, 542, 636, 604, 604, 604, 572, 540, 1536
.short 542, 636, 604, 604, 604, 572, 540, 540, 540, 634, 602, 602, 602, 570, 538, 1536
.short 540, 634, 602, 602, 602, 570, 538, 538, 538, 632, 600, 600, 600, 568, 536, 1536
.short 538, 632, 600, 600, 600, 568, 536, 536, 536, 630, 598, 598, 598, 566, 534, 1536
.short 536, 630, 598, 598, 598, 566, 534, 534, 534, 628, 596, 596, 596, 564, 532, 1536
.short 534, 628, 596, 596, 596, 564, 532, 532, 532, 626, 594, 594, 594, 562, 530, 1536
.short 532, 626, 594, 594, 594, 562, 530, 530, 530, 624, 592, 592, 592, 560, 528, 1536
.short 530, 624, 592, 592, 592, 560, 528, 528, 528, 622, 590, 590, 590, 558, 526, 1536
.short 528, 622, 590, 590, 590, 558, 526, 526, 526, 620, 588, 588, 588, 556, 524, 1536
.short 526, 620, 588, 588, 588, 556, 524, 524, 524, 618, 586, 586, 586, 554, 522, 1536
.short 524, 618, 586, 586, 586, 554, 522, 522, 522, 616, 584, 584, 584, 552, 520, 1536
.short 522, 616, 584, 584, 584, 552, 520, 520, 520, 614, 582, 582, 582, 550, 518, 1536
.short 520, 614, 582, 582, 582, 550, 518, 518, 518, 612, 580, 580, 580, 548, 516, 1536
.short 518, 612, 580, 580, 580, 548, 516, 516, 516, 610, 578, 578, 578, 546, 514, 1536
.short 516, 610, 578, 578, 578, 546, 514, 514, 514, 608, 576, 576, 576, 544, 512, 1536
.short 514, 608, 576, 576, 576, 544, 512, 512, 510, 478, 446, 414, 382, 350, 318, 1536
.short 510, 478, 446, 414, 382, 350, 318, 286, 508, 476, 444, 412, 380, 348, 316, 1536
.short 508, 476, 444, 412, 380, 348, 316, 284, 506, 474, 442, 410, 378, 346, 314, 1536
.short 506, 474, 442, 410, 378, 346, 314, 282, 504, 472, 440, 408, 376, 344, 312, 1536
.short 504, 472, 440, 408, 376, 344, 312, 280, 502, 470, 438, 406, 374, 342, 310, 1536
.short 502, 470, 438, 406, 374, 342, 310, 278, 500, 468, 436, 404, 372, 340, 308, 1536
.short 500, 468, 436, 404, 372, 340, 308, 276, 498, 466, 434, 402, 370, 338, 306, 1536
.short 498, 466, 434, 402, 370, 338, 306, 274, 496, 464, 432, 400, 368, 336, 304, 1536
.short 496, 464, 432, 400, 368, 336, 304, 272, 494, 462, 430, 398, 366, 334, 302, 1536
.short 494, 462, 430, 398, 366, 334, 302, 270, 492, 460, 428, 396, 364, 332, 300, 1536
.short 492, 460, 428, 396, 364, 332, 300, 268, 490, 458, 426, 394, 362, 330, 298, 1536
.short 490, 458, 426, 394, 362, 330, 298, 266, 488, 456, 424, 392, 360, 328, 296, 1536
.short 488, 456, 424, 392, 360, 328, 296, 264, 486, 454, 422, 390, 358, 326, 294, 1536
.short 486, 454, 422, 390, 358, 326, 294, 262, 484, 452, 420, 388, 356, 324, 292, 1536
.short 484, 452, 420, 388, 356, 324, 292, 260, 482, 450, 418, 386, 354, 322, 290, 1536
.short 482, 450, 418, 386, 354, 322, 290, 258, 480, 448, 416, 384, 352, 320, 288, 1536
.short 480, 448, 416, 384, 352, 320, 288, 256, 254, 222, 190, 158, 126, 94, 62, 1536
.short 254, 222, 190, 158, 126, 94, 62, 30, 252, 220, 188, 156, 124, 92, 60, 1536
.short 252, 220, 188, 156, 124, 92, 60, 28, 250, 218, 186, 154, 122, 90, 58, 1536
.short 250, 218, 186, 154, 122, 90, 58, 26, 248, 216, 184, 152, 120, 88, 56, 1536
.short 248, 216, 184, 152, 120, 88, 56, 24, 246, 214, 182, 150, 118, 86, 54, 1536
.short 246, 214, 182, 150, 118, 86, 54, 22, 244, 212, 180, 148, 116, 84, 52, 1536
.short 244, 212, 180, 148, 116, 84, 52, 20, 242, 210, 178, 146, 114, 82, 50, 1536
.short 242, 210, 178, 146, 114, 82, 50, 18, 240, 208, 176, 144, 112, 80, 48, 1536
.short 240, 208, 176, 144, 112, 80, 48, 16, 238, 206, 174, 142, 110, 78, 46, 1536
.short 238, 206, 174, 142, 110, 78, 46, 14, 236, 204, 172, 140, 108, 76, 44, 1536
.short 236, 204, 172, 140, 108, 76, 44, 12, 234, 202, 170, 138, 106, 74, 42, 1536
.short 234, 202, 170, 138, 106, 74, 42, 10, 232, 200, 168, 136, 104, 72, 40, 1536
.short 232, 200, 168, 136, 104, 72, 40, 8, 230, 198, 166, 134, 102, 70, 38, 1536
.short 230, 198, 166, 134, 102, 70, 38, 6, 228, 196, 164, 132, 100, 68, 36, 1536
.short 228, 196, 164, 132, 100, 68, 36, 4, 226, 194, 162, 130, 98, 66, 34, 1536
.short 226, 194, 162, 130, 98, 66, 34, 2, 224, 192, 160, 128, 96, 64, 32, 1536
.short 224, 192, 160, 128, 96, 64, 32, 0, 1536, 1536, 1536, 1536, 1536, 1536, 1536, 1536
.size ktab_idx, 8192
.section .rodata,"a"
.p2align 6
.amdhsa_kernel sequential_preLN__ssm_conv_s4d__mixer_token_mlp__prompt_kernel
  .amdhsa_next_free_vgpr 512
  .amdhsa_next_free_sgpr 102
  .amdhsa_accum_offset 256
  .amdhsa_group_segment_fixed_size 0
  .amdhsa_kernarg_size 120
  .amdhsa_user_sgpr_count 2
  .amdhsa_user_sgpr_kernarg_segment_ptr 1
  .amdhsa_system_sgpr_workgroup_id_x 1
  .amdhsa_float_denorm_mode_32 3
.end_amdhsa_kernel
```
